```python
import torch

def _softmax(x, axis=-1):
    return torch.softmax(x, dim=axis)
def _gelu(x):
    return torch.nn.functional.gelu(x, approximate="tanh")
def _silu(x):
    return torch.nn.functional.silu(x)
def _sigmoid(x):
    return torch.sigmoid(x)
def _layernorm(x, axis=-1, eps=1e-5):
    m = x.mean(dim=axis, keepdim=True)
    v = x.var(dim=axis, keepdim=True, unbiased=False)
    return (x - m) / torch.sqrt(v + eps)
def _scatter_add(tgt, idx, src, axis=0):
    return tgt.clone().index_add_(axis, idx, src)
def _segment_sum(src, seg, n):
    out = torch.zeros((n,) + src.shape[1:], dtype=src.dtype)
    return out.index_add_(0, seg, src)
def _pad(x, pw):
    flat = tuple(v for pair in reversed(pw) for v in pair)
    return torch.nn.functional.pad(x, flat)

kernel_name = 'standalone__gqa_block_cached__near_ridge'

def setup_inputs():

    _w = (lambda a: (lambda t: t.to(torch.bfloat16) if t.is_floating_point() else t)(torch.as_tensor(a)))
    B, Sq, D = 8, 240, 640
    Hq, Hkv, Sk, Dh = 32, 32, 1024, 192
    assert Hq % Hkv == 0, (Hq, Hkv)
    return {
        "x": _w((lambda *s: torch.randn(*s, dtype=torch.bfloat16) * 0.8)(B, Sq, D)),
        "k_cache": _w((lambda *s: torch.randn(*s, dtype=torch.bfloat16) * 0.8)(B, Hkv, Sk, Dh)),
        "v_cache": _w((lambda *s: torch.randn(*s, dtype=torch.bfloat16) * 0.05)(B, Hkv, Sk, Dh)),
        "wq": _w((lambda *s: torch.randn(*s, dtype=torch.bfloat16) * 0.8)(D, Hq * Dh) * (D ** -0.5)),
        "wo": _w((lambda *s: torch.randn(*s, dtype=torch.bfloat16) * 0.05)(Hq * Dh, D) * ((Hq * Dh) ** -0.5)),
    }

def reference(x, k_cache, v_cache, wq, wo):
    B, Sq, D = x.shape
    Hq, Dh = 32, 192
    Hkv = k_cache.shape[1]
    rep = Hq // Hkv
    q = (lambda x, *d: x.permute(*d))((x @ wq).reshape(B, Sq, Hq, Dh), 0, 2, 1, 3)
    k = (lambda x, n, axis: torch.repeat_interleave(x, n, dim=axis))(k_cache, rep, axis=1)
    v = (lambda x, n, axis: torch.repeat_interleave(x, n, dim=axis))(v_cache, rep, axis=1)
    scores = torch.einsum("bhqd,bhkd->bhqk", q, k) * (Dh ** -0.5)
    p = _softmax(scores, axis=-1)
    o = torch.einsum("bhqk,bhkd->bhqd", p, v)
    return (lambda x, *d: x.permute(*d))(o, 0, 2, 1, 3).reshape(B, Sq, Hq * Dh) @ wo
```

```asm
; @launch grid=(256,1,1) block=(256,1,1) lds=163840
.amdgcn_target "amdgcn-amd-amdhsa--gfx950"
.macro WL n
s_waitcnt lgkmcnt(\n)
.endm
.macro Ra d,a,o
ds_read_b128 a[\d:\d+3], v\a offset:\o
.endm
.macro Ta d,a,o
ds_read_b64_tr_b16 a[\d:\d+1], v\a offset:\o
.endm
.macro MvaaZ d,a,b
v_mfma_f32_16x16x32_bf16 v[\d:\d+3], a[\a:\a+3], a[\b:\b+3], 0
.endm
.macro Mvaa d,a,b
v_mfma_f32_16x16x32_bf16 v[\d:\d+3], a[\a:\a+3], a[\b:\b+3], v[\d:\d+3]
.endm
.macro CV d,a,b
v_cvt_pk_bf16_f32 v\d, v\a, v\b
.endm
.macro MvavZ d,a,b
v_mfma_f32_16x16x32_bf16 v[\d:\d+3], a[\a:\a+3], v[\b:\b+3], 0
.endm
.macro Mvav d,a,b
v_mfma_f32_16x16x32_bf16 v[\d:\d+3], a[\a:\a+3], v[\b:\b+3], v[\d:\d+3]
.endm
.macro EX d
v_exp_f32 v\d, v\d
.endm
.macro MvavC d,a,b,c
v_mfma_f32_16x16x32_bf16 v[\d:\d+3], a[\a:\a+3], v[\b:\b+3], v[\c:\c+3]
.endm
.macro MaavZ d,a,b
v_mfma_f32_16x16x32_bf16 a[\d:\d+3], a[\a:\a+3], v[\b:\b+3], 0
.endm
.macro Maav d,a,b
v_mfma_f32_16x16x32_bf16 a[\d:\d+3], a[\a:\a+3], v[\b:\b+3], a[\d:\d+3]
.endm
.macro Tv d,a,o
ds_read_b64_tr_b16 v[\d:\d+1], v\a offset:\o
.endm
.macro Rv d,a,o
ds_read_b128 v[\d:\d+3], v\a offset:\o
.endm
.macro Mvvv d,a,b
v_mfma_f32_16x16x32_bf16 v[\d:\d+3], v[\a:\a+3], v[\b:\b+3], v[\d:\d+3]
.endm
.macro MvvvZ d,a,b
v_mfma_f32_16x16x32_bf16 v[\d:\d+3], v[\a:\a+3], v[\b:\b+3], 0
.endm
.text
.globl standalone__gqa_block_cached__near_ridge_kernel
.p2align 12
.p2align 8
.type standalone__gqa_block_cached__near_ridge_kernel,@function
standalone__gqa_block_cached__near_ridge_kernel:
s_cmp_lt_u32 s2,256
s_cbranch_scc1 K1_go
s_endpgm
K1_go:
s_load_dwordx8 s[4:11],s[0:1],0
s_load_dwordx2 s[18:19],s[0:1],56
s_load_dwordx2 s[48:49],s[0:1],32
v_lshrrev_b32 v29,6,v0
v_and_b32 v30,63,v0
v_readfirstlane_b32 s40,v29
s_and_b32 s46,s2,1
s_lshl_b32 s46,s46,2
s_bfe_u32 s52,s2,0x20003
s_or_b32 s46,s46,s52
s_bfe_u32 s47,s2,0x20001
s_lshl_b32 s47,s47,3
s_lshr_b32 s52,s2,5
s_or_b32 s47,s47,s52
s_bfe_u32 s53,s2,0x10003
s_mul_i32 s53,s53,5
s_add_u32 s52,s52,s53
s_bfe_u32 s53,s2,0x10004
s_mul_i32 s53,s53,2
s_add_u32 s52,s52,s53
s_sub_u32 s53,s52,10
s_min_u32 s13,s52,s53
s_lshl_b32 s14,s13,7
s_mul_i32 s13,s13,786432
v_lshrrev_b32 v31,3,v30
v_and_b32 v32,6,v31
v_and_b32 v33,7,v30
v_xor_b32 v32,v32,v33
v_lshl_add_u32 v31,v29,6,v31
v_mul_u32_u24 v31,1280,v31
v_lshl_add_u32 v25,v32,4,v31
v_add_u32 v26,9216,v25
v_add_u32 v27,18432,v25
v_add_u32 v28,27648,v25
v_mul_u32_u24 v34,6144,v29
v_lshlrev_b32 v35,4,v29
v_add_u32 v31,0,v30
v_mul_u32_u24 v32,171,v31
v_lshrrev_b32 v32,12,v32
v_mul_u32_u24 v33,24,v32
v_sub_u32 v33,v31,v33
v_lshlrev_b32 v36,1,v32
v_and_b32 v36,4,v36
v_xor_b32 v33,v33,v36
v_add_u32 v36,v35,v32
v_mul_u32_u24 v36,12288,v36
v_lshl_add_u32 v33,v33,4,v36
v_subrev_u32 v22,0,v33
v_and_b32 v32,6,v32
v_xor_b32 v32,v32,v30
v_lshl_add_u32 v7,v32,4,v34
v_add_u32 v31,64,v30
v_mul_u32_u24 v32,171,v31
v_lshrrev_b32 v32,12,v32
v_mul_u32_u24 v33,24,v32
v_sub_u32 v33,v31,v33
v_lshlrev_b32 v36,1,v32
v_and_b32 v36,4,v36
v_xor_b32 v33,v33,v36
v_add_u32 v36,v35,v32
v_mul_u32_u24 v36,12288,v36
v_lshl_add_u32 v33,v33,4,v36
v_subrev_u32 v23,1024,v33
v_and_b32 v32,6,v32
v_xor_b32 v32,v32,v30
v_lshl_add_u32 v8,v32,4,v34
v_add_u32 v31,128,v30
v_mul_u32_u24 v32,171,v31
v_lshrrev_b32 v32,12,v32
v_mul_u32_u24 v33,24,v32
v_sub_u32 v33,v31,v33
v_lshlrev_b32 v36,1,v32
v_and_b32 v36,4,v36
v_xor_b32 v33,v33,v36
v_add_u32 v36,v35,v32
v_mul_u32_u24 v36,12288,v36
v_lshl_add_u32 v33,v33,4,v36
v_subrev_u32 v24,2048,v33
v_and_b32 v32,6,v32
v_xor_b32 v32,v32,v30
v_lshl_add_u32 v9,v32,4,v34
s_mul_i32 s41,s40,6144
s_lshl_b32 s42,s40,13
s_add_u32 s42,s42,98304
s_mul_i32 s52,s46,307200
s_mul_i32 s53,s47,384
s_lshl_b32 s54,s46,5
s_add_u32 s54,s54,s47
s_mul_i32 s54,s54,393216
s_mul_i32 s55,s46,2880
s_mul_i32 s56,s47,6
s_add_u32 s55,s55,s56
s_lshl_b32 s55,s55,10
s_mov_b32 s22,307200
s_mov_b32 s23,0x00020000
s_sub_u32 s26,7864320,s53
s_mov_b32 s27,0x00020000
s_mov_b32 s30,393216
s_mov_b32 s31,0x00020000
s_mov_b32 s34,393216
s_mov_b32 s35,0x00020000
s_sub_u32 s38,23592960,s55
s_mov_b32 s39,0x00020000
WL 0
s_add_u32 s20,s4,s52
s_addc_u32 s21,s5,0
s_add_u32 s24,s10,s53
s_addc_u32 s25,s11,0
s_add_u32 s28,s6,s54
s_addc_u32 s29,s7,0
s_add_u32 s32,s8,s54
s_addc_u32 s33,s9,0
s_add_u32 s36,s18,s55
s_addc_u32 s37,s19,0
s_add_u32 m0,s42,0
s_add_u32 s43,s14,0
buffer_load_dwordx4 v25,s[20:23],s43 offen offset:0 lds
buffer_load_dwordx4 v26,s[20:23],s43 offen offset:1024 lds
s_add_u32 m0,s42,0
s_add_u32 s43,s14,0
buffer_load_dwordx4 v27,s[20:23],s43 offen offset:2048 lds
buffer_load_dwordx4 v28,s[20:23],s43 offen offset:3072 lds
s_add_u32 m0,s42,4096
s_add_u32 s43,s14,40960
buffer_load_dwordx4 v25,s[20:23],s43 offen offset:0 lds
buffer_load_dwordx4 v26,s[20:23],s43 offen offset:1024 lds
s_add_u32 m0,s42,4096
s_add_u32 s43,s14,40960
s_add_u32 s10,s14,128
s_sub_u32 s11,s10,1280
s_min_u32 s14,s10,s11
buffer_load_dwordx4 v27,s[20:23],s43 offen offset:2048 lds
buffer_load_dwordx4 v28,s[20:23],s43 offen offset:3072 lds
s_add_u32 m0,s41,0
s_add_u32 s43,s13,0
buffer_load_dwordx4 v22,s[24:27],s43 offen offset:0 lds
buffer_load_dwordx4 v23,s[24:27],s43 offen offset:1024 lds
buffer_load_dwordx4 v24,s[24:27],s43 offen offset:2048 lds
s_add_u32 m0,s41,3072
s_add_u32 s43,s13,98304
s_add_u32 s10,s13,786432
s_sub_u32 s11,s10,7864320
s_min_u32 s13,s10,s11
buffer_load_dwordx4 v22,s[24:27],s43 offen offset:0 lds
buffer_load_dwordx4 v23,s[24:27],s43 offen offset:1024 lds
buffer_load_dwordx4 v24,s[24:27],s43 offen offset:2048 lds
s_add_u32 s52,s18,23592960
s_addc_u32 s53,s19,0
s_load_dword s45,s[52:53],32768
s_mov_b32 s54,36864
s_mov_b32 s55,0x00020000
s_lshr_b32 s57,s2,3
s_mul_i32 s56,s57,52
s_lshr_b32 s56,s56,8
s_mul_i32 s58,s56,5
s_sub_u32 s57,s57,s58
s_lshl_b32 s59,s56,6
s_lshl_b32 s57,s57,1
s_lshl_b32 s57,s57,7
s_add_u32 s48,s48,s57
s_addc_u32 s49,s49,0
s_sub_u32 s50,7864320,s57
s_mov_b32 s51,0x00020000
s_bfe_u32 s4,s2,0x20001
s_mul_i32 s4,s4,1536
v_lshrrev_b32 v31,3,v30
v_and_b32 v32,6,v31
v_and_b32 v33,7,v30
v_xor_b32 v32,v32,v33
v_and_b32 v33,1,v29
v_lshl_add_u32 v31,v33,4,v31
v_add_u32 v31,s4,v31
v_mul_u32_u24 v31,1280,v31
v_lshl_add_u32 v31,v32,4,v31
v_lshrrev_b32 v33,1,v29
v_lshl_add_u32 v14,v33,7,v31
v_add_u32 v15,9216,v14
v_lshrrev_b32 v31,4,v30
v_and_b32 v32,15,v30
v_and_b32 v33,6,v32
v_xor_b32 v33,v33,v31
v_lshlrev_b32 v33,4,v33
v_lshl_add_u32 v20,v32,7,v33
v_add_u32 v20,s42,v20
v_xor_b32 v21,64,v20
v_mul_u32_u24 v1,384,v32
v_add_u32 v1,v1,v33
v_add_u32 v1,49152,v1
v_xor_b32 v2,64,v1
v_bfe_u32 v32,v30,2,2
v_lshl_add_u32 v33,v31,3,v32
v_mul_u32_u24 v33,384,v33
v_lshlrev_b32 v32,1,v32
v_and_b32 v32,4,v32
v_and_b32 v34,3,v30
v_xor_b32 v32,v32,v34
v_lshl_add_u32 v16,v32,4,v33
v_xor_b32 v17,64,v16
v_lshrrev_b32 v31,2,v30
v_and_b32 v32,6,v31
v_lshrrev_b32 v33,1,v34
v_xor_b32 v32,v32,v33
v_lshlrev_b32 v32,4,v32
v_and_b32 v33,1,v30
v_lshl_add_u32 v32,v33,3,v32
v_mul_u32_u24 v31,384,v31
v_add_u32 v3,v31,v32
v_add_u32 v3,49152,v3
v_xor_b32 v4,32,v3
v_xor_b32 v5,64,v3
v_xor_b32 v6,96,v3
v_mul_u32_u24 v10,786432,v29
v_lshl_add_u32 v10,v30,4,v10
v_lshlrev_b32 v12,2,v29
v_add_u32 v12,147456,v12
v_mov_b32 v13,147456
v_mov_b32 v31,0x3f803f80
v_accvgpr_write_b32 a240,v31
v_accvgpr_write_b32 a241,v31
v_accvgpr_write_b32 a242,v31
v_accvgpr_write_b32 a243,v31
s_mov_b32 s44,0x3dd53b95
s_mov_b32 s4,98304
s_mov_b32 s5,49152
s_mov_b32 s6,73728
s_mov_b32 s7,49152
s_add_u32 s12,s41,49152
s_add_u32 s15,s41,s12
v_mul_u32_u24 v31,60,v29
v_add_u32 v31,v31,v30
v_lshlrev_b32 v19,7,v31
v_subrev_u32 v31,10,v30
v_not_b32 v31,v31
v_and_b32 v31,0x40000000,v31
v_or_b32 v19,v19,v31
s_mul_i32 s101,s2,30720
s_add_u32 s101,s101,s50
s_sub_u32 s101,s101,7865600
s_mov_b32 s56,0
s_mov_b32 s57,4096
s_mov_b32 s58,196608
s_mov_b32 s59,200704
s_mov_b32 s60,393216
s_mov_b32 s61,397312
s_mov_b32 s62,589824
s_mov_b32 s63,593920
s_cmp_eq_u32 s40,3
s_cselect_b32 s62,0x7ff00000,s62
s_cselect_b32 s63,0x7ff00000,s63
s_mov_b64 vcc,1
s_bitcmp1_b32 s40,0
s_cbranch_scc1 K1_tr_n0_0
s_bitcmp1_b32 s40,1
s_cbranch_scc1 K1_tr_n1_0
s_bitcmp1_b32 s2,3
s_cbranch_scc1 K1_tr_n2_0
s_bitcmp1_b32 s2,4
s_cbranch_scc1 K1_tr_n3_0
s_bitcmp1_b32 s2,5
s_cbranch_scc1 K1_tr_n4_0
s_bitcmp1_b32 s2,6
s_cbranch_scc1 K1_tr_n5_0
s_bitcmp1_b32 s2,7
s_cbranch_scc1 K1_p133
s_branch K1_p117
K1_tr_n5_0:
s_bitcmp1_b32 s2,7
s_cbranch_scc1 K1_p141
s_branch K1_p125
K1_tr_n4_0:
s_bitcmp1_b32 s2,6
s_cbranch_scc1 K1_tr_n5_16
s_bitcmp1_b32 s2,7
s_cbranch_scc1 K1_p137
s_branch K1_p121
K1_tr_n5_16:
s_bitcmp1_b32 s2,7
s_cbranch_scc1 K1_p145
s_branch K1_p129
K1_tr_n3_0:
s_bitcmp1_b32 s2,5
s_cbranch_scc1 K1_tr_n4_8
s_bitcmp1_b32 s2,6
s_cbranch_scc1 K1_tr_n5_8
s_bitcmp1_b32 s2,7
s_cbranch_scc1 K1_p135
s_branch K1_p119
K1_tr_n5_8:
s_bitcmp1_b32 s2,7
s_cbranch_scc1 K1_p143
s_branch K1_p127
K1_tr_n4_8:
s_bitcmp1_b32 s2,6
s_cbranch_scc1 K1_tr_n5_24
s_bitcmp1_b32 s2,7
s_cbranch_scc1 K1_p139
s_branch K1_p123
K1_tr_n5_24:
s_bitcmp1_b32 s2,7
s_cbranch_scc1 K1_p115
s_branch K1_p131
K1_tr_n2_0:
s_bitcmp1_b32 s2,4
s_cbranch_scc1 K1_tr_n3_4
s_bitcmp1_b32 s2,5
s_cbranch_scc1 K1_tr_n4_4
s_bitcmp1_b32 s2,6
s_cbranch_scc1 K1_tr_n5_4
s_bitcmp1_b32 s2,7
s_cbranch_scc1 K1_p134
s_branch K1_p118
K1_tr_n5_4:
s_bitcmp1_b32 s2,7
s_cbranch_scc1 K1_p142
s_branch K1_p126
K1_tr_n4_4:
s_bitcmp1_b32 s2,6
s_cbranch_scc1 K1_tr_n5_20
s_bitcmp1_b32 s2,7
s_cbranch_scc1 K1_p138
s_branch K1_p122
K1_tr_n5_20:
s_bitcmp1_b32 s2,7
s_cbranch_scc1 K1_p114
s_branch K1_p130
K1_tr_n3_4:
s_bitcmp1_b32 s2,5
s_cbranch_scc1 K1_tr_n4_12
s_bitcmp1_b32 s2,6
s_cbranch_scc1 K1_tr_n5_12
s_bitcmp1_b32 s2,7
s_cbranch_scc1 K1_p136
s_branch K1_p120
K1_tr_n5_12:
s_bitcmp1_b32 s2,7
s_cbranch_scc1 K1_p144
s_branch K1_p128
K1_tr_n4_12:
s_bitcmp1_b32 s2,6
s_cbranch_scc1 K1_tr_n5_28
s_bitcmp1_b32 s2,7
s_cbranch_scc1 K1_p140
s_branch K1_p124
K1_tr_n5_28:
s_bitcmp1_b32 s2,7
s_cbranch_scc1 K1_p116
s_branch K1_p132
K1_tr_n1_0:
s_bitcmp1_b32 s2,3
s_cbranch_scc1 K1_tr_n2_2
s_bitcmp1_b32 s2,4
s_cbranch_scc1 K1_tr_n3_2
s_bitcmp1_b32 s2,5
s_cbranch_scc1 K1_tr_n4_2
s_bitcmp1_b32 s2,6
s_cbranch_scc1 K1_tr_n5_2
s_bitcmp1_b32 s2,7
s_cbranch_scc1 K1_p165
s_branch K1_p149
K1_tr_n5_2:
s_bitcmp1_b32 s2,7
s_cbranch_scc1 K1_p173
s_branch K1_p157
K1_tr_n4_2:
s_bitcmp1_b32 s2,6
s_cbranch_scc1 K1_tr_n5_18
s_bitcmp1_b32 s2,7
s_cbranch_scc1 K1_p169
s_branch K1_p153
K1_tr_n5_18:
s_bitcmp1_b32 s2,7
s_cbranch_scc1 K1_p177
s_branch K1_p161
K1_tr_n3_2:
s_bitcmp1_b32 s2,5
s_cbranch_scc1 K1_tr_n4_10
s_bitcmp1_b32 s2,6
s_cbranch_scc1 K1_tr_n5_10
s_bitcmp1_b32 s2,7
s_cbranch_scc1 K1_p167
s_branch K1_p151
K1_tr_n5_10:
s_bitcmp1_b32 s2,7
s_cbranch_scc1 K1_p175
s_branch K1_p159
K1_tr_n4_10:
s_bitcmp1_b32 s2,6
s_cbranch_scc1 K1_tr_n5_26
s_bitcmp1_b32 s2,7
s_cbranch_scc1 K1_p171
s_branch K1_p155
K1_tr_n5_26:
s_bitcmp1_b32 s2,7
s_cbranch_scc1 K1_p147
s_branch K1_p163
K1_tr_n2_2:
s_bitcmp1_b32 s2,4
s_cbranch_scc1 K1_tr_n3_6
s_bitcmp1_b32 s2,5
s_cbranch_scc1 K1_tr_n4_6
s_bitcmp1_b32 s2,6
s_cbranch_scc1 K1_tr_n5_6
s_bitcmp1_b32 s2,7
s_cbranch_scc1 K1_p166
s_branch K1_p150
K1_tr_n5_6:
s_bitcmp1_b32 s2,7
s_cbranch_scc1 K1_p174
s_branch K1_p158
K1_tr_n4_6:
s_bitcmp1_b32 s2,6
s_cbranch_scc1 K1_tr_n5_22
s_bitcmp1_b32 s2,7
s_cbranch_scc1 K1_p170
s_branch K1_p154
K1_tr_n5_22:
s_bitcmp1_b32 s2,7
s_cbranch_scc1 K1_p146
s_branch K1_p162
K1_tr_n3_6:
s_bitcmp1_b32 s2,5
s_cbranch_scc1 K1_tr_n4_14
s_bitcmp1_b32 s2,6
s_cbranch_scc1 K1_tr_n5_14
s_bitcmp1_b32 s2,7
s_cbranch_scc1 K1_p168
s_branch K1_p152
K1_tr_n5_14:
s_bitcmp1_b32 s2,7
s_cbranch_scc1 K1_p176
s_branch K1_p160
K1_tr_n4_14:
s_bitcmp1_b32 s2,6
s_cbranch_scc1 K1_tr_n5_30
s_bitcmp1_b32 s2,7
s_cbranch_scc1 K1_p172
s_branch K1_p156
K1_tr_n5_30:
s_bitcmp1_b32 s2,7
s_cbranch_scc1 K1_p148
s_branch K1_p164
K1_tr_n0_0:
s_bitcmp1_b32 s40,1
s_cbranch_scc1 K1_tr_n1_1
s_bitcmp1_b32 s2,3
s_cbranch_scc1 K1_tr_n2_1
s_bitcmp1_b32 s2,4
s_cbranch_scc1 K1_tr_n3_1
s_bitcmp1_b32 s2,5
s_cbranch_scc1 K1_tr_n4_1
s_bitcmp1_b32 s2,6
s_cbranch_scc1 K1_tr_n5_1
s_bitcmp1_b32 s2,7
s_cbranch_scc1 K1_p5
s_branch K1_p21
K1_tr_n5_1:
s_bitcmp1_b32 s2,7
s_cbranch_scc1 K1_p13
s_branch K1_p29
K1_tr_n4_1:
s_bitcmp1_b32 s2,6
s_cbranch_scc1 K1_tr_n5_17
s_bitcmp1_b32 s2,7
s_cbranch_scc1 K1_p9
s_branch K1_p25
K1_tr_n5_17:
s_bitcmp1_b32 s2,7
s_cbranch_scc1 K1_p17
s_branch K1_p1
K1_tr_n3_1:
s_bitcmp1_b32 s2,5
s_cbranch_scc1 K1_tr_n4_9
s_bitcmp1_b32 s2,6
s_cbranch_scc1 K1_tr_n5_9
s_bitcmp1_b32 s2,7
s_cbranch_scc1 K1_p7
s_branch K1_p23
K1_tr_n5_9:
s_bitcmp1_b32 s2,7
s_cbranch_scc1 K1_p15
s_branch K1_p31
K1_tr_n4_9:
s_bitcmp1_b32 s2,6
s_cbranch_scc1 K1_tr_n5_25
s_bitcmp1_b32 s2,7
s_cbranch_scc1 K1_p11
s_branch K1_p27
K1_tr_n5_25:
s_bitcmp1_b32 s2,7
s_cbranch_scc1 K1_p19
s_branch K1_p3
K1_tr_n2_1:
s_bitcmp1_b32 s2,4
s_cbranch_scc1 K1_tr_n3_5
s_bitcmp1_b32 s2,5
s_cbranch_scc1 K1_tr_n4_5
s_bitcmp1_b32 s2,6
s_cbranch_scc1 K1_tr_n5_5
s_bitcmp1_b32 s2,7
s_cbranch_scc1 K1_p6
s_branch K1_p22
K1_tr_n5_5:
s_bitcmp1_b32 s2,7
s_cbranch_scc1 K1_p14
s_branch K1_p30
K1_tr_n4_5:
s_bitcmp1_b32 s2,6
s_cbranch_scc1 K1_tr_n5_21
s_bitcmp1_b32 s2,7
s_cbranch_scc1 K1_p10
s_branch K1_p26
K1_tr_n5_21:
s_bitcmp1_b32 s2,7
s_cbranch_scc1 K1_p18
s_branch K1_p2
K1_tr_n3_5:
s_bitcmp1_b32 s2,5
s_cbranch_scc1 K1_tr_n4_13
s_bitcmp1_b32 s2,6
s_cbranch_scc1 K1_tr_n5_13
s_bitcmp1_b32 s2,7
s_cbranch_scc1 K1_p8
s_branch K1_p24
K1_tr_n5_13:
s_bitcmp1_b32 s2,7
s_cbranch_scc1 K1_p16
s_branch K1_p0
K1_tr_n4_13:
s_bitcmp1_b32 s2,6
s_cbranch_scc1 K1_tr_n5_29
s_bitcmp1_b32 s2,7
s_cbranch_scc1 K1_p12
s_branch K1_p28
K1_tr_n5_29:
s_bitcmp1_b32 s2,7
s_cbranch_scc1 K1_p20
s_branch K1_p4
K1_tr_n1_1:
s_bitcmp1_b32 s2,3
s_cbranch_scc1 K1_tr_n2_3
s_bitcmp1_b32 s2,4
s_cbranch_scc1 K1_tr_n3_3
s_bitcmp1_b32 s2,5
s_cbranch_scc1 K1_tr_n4_3
s_bitcmp1_b32 s2,6
s_cbranch_scc1 K1_tr_n5_3
s_bitcmp1_b32 s2,7
s_cbranch_scc1 K1_p37
s_branch K1_p53
K1_tr_n5_3:
s_bitcmp1_b32 s2,7
s_cbranch_scc1 K1_p45
s_branch K1_p61
K1_tr_n4_3:
s_bitcmp1_b32 s2,6
s_cbranch_scc1 K1_tr_n5_19
s_bitcmp1_b32 s2,7
s_cbranch_scc1 K1_p41
s_branch K1_p57
K1_tr_n5_19:
s_bitcmp1_b32 s2,7
s_cbranch_scc1 K1_p49
s_branch K1_p33
K1_tr_n3_3:
s_bitcmp1_b32 s2,5
s_cbranch_scc1 K1_tr_n4_11
s_bitcmp1_b32 s2,6
s_cbranch_scc1 K1_tr_n5_11
s_bitcmp1_b32 s2,7
s_cbranch_scc1 K1_p39
s_branch K1_p55
K1_tr_n5_11:
s_bitcmp1_b32 s2,7
s_cbranch_scc1 K1_p47
s_branch K1_p63
K1_tr_n4_11:
s_bitcmp1_b32 s2,6
s_cbranch_scc1 K1_tr_n5_27
s_bitcmp1_b32 s2,7
s_cbranch_scc1 K1_p43
s_branch K1_p59
K1_tr_n5_27:
s_bitcmp1_b32 s2,7
s_cbranch_scc1 K1_p51
s_branch K1_p35
K1_tr_n2_3:
s_bitcmp1_b32 s2,4
s_cbranch_scc1 K1_tr_n3_7
s_bitcmp1_b32 s2,5
s_cbranch_scc1 K1_tr_n4_7
s_bitcmp1_b32 s2,6
s_cbranch_scc1 K1_tr_n5_7
s_bitcmp1_b32 s2,7
s_cbranch_scc1 K1_p38
s_branch K1_p54
K1_tr_n5_7:
s_bitcmp1_b32 s2,7
s_cbranch_scc1 K1_p46
s_branch K1_p62
K1_tr_n4_7:
s_bitcmp1_b32 s2,6
s_cbranch_scc1 K1_tr_n5_23
s_bitcmp1_b32 s2,7
s_cbranch_scc1 K1_p42
s_branch K1_p58
K1_tr_n5_23:
s_bitcmp1_b32 s2,7
s_cbranch_scc1 K1_p50
s_branch K1_p34
K1_tr_n3_7:
s_bitcmp1_b32 s2,5
s_cbranch_scc1 K1_tr_n4_15
s_bitcmp1_b32 s2,6
s_cbranch_scc1 K1_tr_n5_15
s_bitcmp1_b32 s2,7
s_cbranch_scc1 K1_p40
s_branch K1_p56
K1_tr_n5_15:
s_bitcmp1_b32 s2,7
s_cbranch_scc1 K1_p48
s_branch K1_p32
K1_tr_n4_15:
s_bitcmp1_b32 s2,6
s_cbranch_scc1 K1_tr_n5_31
s_bitcmp1_b32 s2,7
s_cbranch_scc1 K1_p44
s_branch K1_p60
K1_tr_n5_31:
s_bitcmp1_b32 s2,7
s_cbranch_scc1 K1_p52
s_branch K1_p36
K1_tr:
s_mov_b64 vcc,0
s_cmp_eq_u32 s40,3
s_cbranch_scc1 K1_w3
WL 0
s_mul_i32 s45,s45,0x9e3779b1
s_add_u32 s45,s45,0x7f4a7c15
s_add_u32 m0,s42,32768
s_add_u32 s43,s14,0
buffer_load_dwordx4 v25,s[20:23],s43 offen offset:0 lds
K1_p0:
s_cbranch_vccnz K1_p64
buffer_load_dwordx4 v26,s[20:23],s43 offen offset:1024 lds
s_add_u32 m0,s42,32768
s_add_u32 s43,s14,0
buffer_load_dwordx4 v27,s[20:23],s43 offen offset:2048 lds
buffer_load_dwordx4 v28,s[20:23],s43 offen offset:3072 lds
s_add_u32 m0,s42,36864
s_add_u32 s43,s14,40960
buffer_load_dwordx4 v25,s[20:23],s43 offen offset:0 lds
buffer_load_dwordx4 v26,s[20:23],s43 offen offset:1024 lds
s_add_u32 m0,s42,36864
s_add_u32 s43,s14,40960
s_add_u32 s10,s14,128
s_sub_u32 s11,s10,1280
s_min_u32 s14,s10,s11
buffer_load_dwordx4 v27,s[20:23],s43 offen offset:2048 lds
buffer_load_dwordx4 v28,s[20:23],s43 offen offset:3072 lds
s_add_u32 m0,s41,24576
s_add_u32 s43,s13,0
buffer_load_dwordx4 v22,s[24:27],s43 offen offset:0 lds
buffer_load_dwordx4 v23,s[24:27],s43 offen offset:1024 lds
buffer_load_dwordx4 v24,s[24:27],s43 offen offset:2048 lds
s_add_u32 m0,s41,27648
s_add_u32 s43,s13,98304
s_add_u32 s10,s13,786432
s_sub_u32 s11,s10,7864320
s_min_u32 s13,s10,s11
buffer_load_dwordx4 v22,s[24:27],s43 offen offset:0 lds
buffer_load_dwordx4 v23,s[24:27],s43 offen offset:1024 lds
buffer_load_dwordx4 v24,s[24:27],s43 offen offset:2048 lds
s_waitcnt vmcnt(20)
Ra 0,20,0
Ra 16,21,0
Ra 4,20,2048
Ra 20,21,2048
K1_p1:
s_cbranch_vccnz K1_p65
Ra 8,20,4096
Ra 24,21,4096
Ra 12,20,6144
Ra 28,21,6144
s_waitcnt vmcnt(14)
s_barrier
Ta 208,16,0
Ta 210,16,1536
Ta 212,16,12288
Ta 214,16,13824
Ta 216,16,8
Ta 218,16,1544
Ta 220,16,12296
Ta 222,16,13832
Ta 224,17,0
Ta 226,17,1536
Ta 228,17,12288
Ta 230,17,13824
WL 8
MvaaZ 64,208,0
s_add_u32 m0,s42,0
Ta 232,17,8
s_add_u32 s43,s14,0
Mvaa 64,212,16
Ta 234,17,1544
MvaaZ 72,208,4
buffer_load_dwordx4 v25,s[20:23],s43 offen offset:0 lds
Mvaa 72,212,20
Ta 236,17,12296
MvaaZ 80,208,8
Ta 238,17,13832
Mvaa 80,212,24
s_waitcnt vmcnt(13)
Ra 32,20,32768
K1_p2:
s_cbranch_vccnz K1_p66
MvaaZ 88,208,12
buffer_load_dwordx4 v26,s[20:23],s43 offen offset:1024 lds
Mvaa 88,212,28
WL 9
Ra 48,21,32768
s_add_u32 m0,s42,0
MvaaZ 68,216,0
s_add_u32 s43,s14,0
Ta 208,16,128
Mvaa 68,220,16
Ta 210,16,1664
MvaaZ 76,216,4
buffer_load_dwordx4 v27,s[20:23],s43 offen offset:2048 lds
Mvaa 76,220,20
Ta 212,16,12416
MvaaZ 84,216,8
Ta 214,16,13952
Mvaa 84,220,24
buffer_load_dwordx4 v28,s[20:23],s43 offen offset:3072 lds
MvaaZ 92,216,12
s_add_u32 m0,s42,4096
s_add_u32 s43,s14,40960
Mvaa 92,220,28
s_waitcnt vmcnt(14) lgkmcnt(4)
Ta 216,16,136
MvaaZ 96,224,0
Ta 218,16,1672
Mvaa 96,228,16
Ta 220,16,12424
MvaaZ 104,224,4
buffer_load_dwordx4 v25,s[20:23],s43 offen offset:0 lds
Mvaa 104,228,20
s_add_u32 s10,s14,128
Ta 222,16,13960
K1_p3:
s_cbranch_vccnz K1_p67
s_sub_u32 s11,s10,1280
MvaaZ 112,224,8
Ra 36,20,34816
Mvaa 112,228,24
Ra 52,21,34816
MvaaZ 120,224,12
buffer_load_dwordx4 v26,s[20:23],s43 offen offset:1024 lds
Mvaa 120,228,28
WL 12
Ta 224,17,128
s_add_u32 m0,s42,4096
MvaaZ 100,232,0
s_add_u32 s43,s14,40960
Ta 226,17,1664
s_min_u32 s14,s10,s11
Mvaa 100,236,16
Ta 228,17,12416
MvaaZ 108,232,4
buffer_load_dwordx4 v27,s[20:23],s43 offen offset:2048 lds
Mvaa 108,236,20
Ta 230,17,13952
MvaaZ 116,232,8
Mvaa 116,236,24
buffer_load_dwordx4 v28,s[20:23],s43 offen offset:3072 lds
MvaaZ 124,232,12
s_add_u32 m0,s41,49152
s_add_u32 s43,s13,0
Mvaa 124,236,28
s_waitcnt vmcnt(16) lgkmcnt(4)
Ta 232,17,136
MvaaZ 128,208,0
Ta 234,17,1672
Mvaa 128,212,16
K1_p4:
s_cbranch_vccnz K1_p68
Ta 236,17,12424
MvaaZ 136,208,4
buffer_load_dwordx4 v22,s[24:27],s43 offen offset:0 lds
Mvaa 136,212,20
Ta 238,17,13960
MvaaZ 144,208,8
Ra 40,20,36864
Mvaa 144,212,24
Ra 56,21,36864
MvaaZ 152,208,12
buffer_load_dwordx4 v23,s[24:27],s43 offen offset:1024 lds
Mvaa 152,212,28
WL 12
Ta 208,16,256
s_add_u32 s10,s13,786432
MvaaZ 132,216,0
s_sub_u32 s11,s10,7864320
Ta 210,16,1792
Mvaa 132,220,16
Ta 212,16,12544
MvaaZ 140,216,4
buffer_load_dwordx4 v24,s[24:27],s43 offen offset:2048 lds
Mvaa 140,220,20
s_add_u32 m0,s41,52224
Ta 214,16,14080
s_add_u32 s43,s13,98304
MvaaZ 148,216,8
s_min_u32 s13,s10,s11
Mvaa 148,220,24
buffer_load_dwordx4 v22,s[24:27],s43 offen offset:0 lds
MvaaZ 156,216,12
Mvaa 156,220,28
s_waitcnt vmcnt(18) lgkmcnt(4)
K1_p5:
s_cbranch_vccnz K1_p69
Ta 216,16,264
MvaaZ 160,224,0
Ta 218,16,1800
Mvaa 160,228,16
Ta 220,16,12552
MvaaZ 168,224,4
buffer_load_dwordx4 v23,s[24:27],s43 offen offset:1024 lds
Mvaa 168,228,20
Ta 222,16,14088
MvaaZ 176,224,8
Ra 44,20,38912
Mvaa 176,228,24
Ra 60,21,38912
MvaaZ 184,224,12
buffer_load_dwordx4 v24,s[24:27],s43 offen offset:2048 lds
Mvaa 184,228,28
WL 12
Ta 224,17,256
s_add_u32 m0,s42,32768
MvaaZ 164,232,0
s_add_u32 s43,s14,0
Ta 226,17,1792
Mvaa 164,236,16
Ta 228,17,12544
MvaaZ 172,232,4
buffer_load_dwordx4 v25,s[20:23],s43 offen offset:0 lds
Mvaa 172,236,20
Ta 230,17,14080
MvaaZ 180,232,8
buffer_load_dwordx4 v26,s[20:23],s43 offen offset:1024 lds
Mvaa 180,236,24
s_add_u32 m0,s42,32768
s_add_u32 s43,s14,0
K1_p6:
s_cbranch_vccnz K1_p70
MvaaZ 188,232,12
buffer_load_dwordx4 v27,s[20:23],s43 offen offset:2048 lds
Mvaa 188,236,28
WL 4
Ta 232,17,264
s_add_u32 s10,s14,128
MvaaZ 192,208,0
s_sub_u32 s11,s10,1280
buffer_load_dwordx4 v28,s[20:23],s43 offen offset:3072 lds
Mvaa 192,212,16
s_add_u32 m0,s42,36864
Ta 234,17,1800
s_add_u32 s43,s14,40960
MvaaZ 200,208,4
buffer_load_dwordx4 v25,s[20:23],s43 offen offset:0 lds
Mvaa 200,212,20
Ta 236,17,12552
MvaaZ 208,208,8
buffer_load_dwordx4 v26,s[20:23],s43 offen offset:1024 lds
Mvaa 208,212,24
s_add_u32 m0,s42,36864
Ta 238,17,14088
s_add_u32 s43,s14,40960
MvaaZ 216,208,12
s_min_u32 s14,s10,s11
buffer_load_dwordx4 v27,s[20:23],s43 offen offset:2048 lds
Mvaa 216,212,28
s_waitcnt vmcnt(21) lgkmcnt(10)
s_barrier
Ta 208,16,24576
MvaaZ 196,216,0
buffer_load_dwordx4 v28,s[20:23],s43 offen offset:3072 lds
Mvaa 196,220,16
s_add_u32 m0,s12,24576
K1_p7:
s_cbranch_vccnz K1_p71
Ta 210,16,26112
s_add_u32 s43,s13,0
MvaaZ 204,216,4
Ta 212,16,36864
Mvaa 204,220,20
Ta 214,16,38400
MvaaZ 212,216,8
buffer_load_dwordx4 v22,s[24:27],s43 offen offset:0 lds
Mvaa 212,220,24
MvaaZ 220,216,12
Mvaa 220,220,28
WL 8
Ta 216,16,24584
MvaaZ 224,224,0
Ta 218,16,26120
Mvaa 224,228,16
Ta 220,16,36872
MvaaZ 232,224,4
Ta 222,16,38408
Mvaa 232,228,20
buffer_load_dwordx4 v23,s[24:27],s43 offen offset:1024 lds
MvaaZ 240,224,8
Mvaa 240,228,24
MvaaZ 248,224,12
Mvaa 248,228,28
WL 8
Ta 224,17,24576
MvaaZ 228,232,0
Ta 226,17,26112
Mvaa 228,236,16
Ta 228,17,36864
MvaaZ 236,232,4
s_add_u32 s10,s13,786432
K1_p8:
s_cbranch_vccnz K1_p72
buffer_load_dwordx4 v24,s[24:27],s43 offen offset:2048 lds
Mvaa 236,236,20
s_add_u32 m0,s12,27648
Ta 230,17,38400
s_add_u32 s43,s13,98304
MvaaZ 244,232,8
s_sub_u32 s11,s10,7864320
s_min_u32 s13,s10,s11
s_sub_u32 s12,s15,s12
Mvaa 244,236,24
MvaaZ 252,232,12
Mvaa 252,236,28
s_waitcnt vmcnt(23) lgkmcnt(8)
Ta 232,17,24584
s_mov_b32 s3,0
K1q4_L0:
Mvaa 64,208,32
Ta 234,17,26120
Mvaa 64,212,48
buffer_load_dwordx4 v22,s[24:27],s43 offen offset:0 lds
Mvaa 72,208,36
Ta 236,17,36872
Mvaa 72,212,52
Ta 238,17,38408
Mvaa 80,208,40
Ra 0,20,0
Mvaa 80,212,56
Ra 16,21,0
Mvaa 88,208,44
buffer_load_dwordx4 v23,s[24:27],s43 offen offset:1024 lds
Mvaa 88,212,60
WL 10
Ta 208,16,24704
Mvaa 68,216,32
Ta 210,16,26240
K1_p9:
s_cbranch_vccnz K1_p73
Mvaa 68,220,48
Ta 212,16,36992
Mvaa 76,216,36
Ta 214,16,38528
Mvaa 76,220,52
Mvaa 84,216,40
Mvaa 84,220,56
buffer_load_dwordx4 v24,s[24:27],s43 offen offset:2048 lds
Mvaa 92,216,44
s_add_u32 m0,s42,0
s_add_u32 s43,s14,0
Mvaa 92,220,60
s_waitcnt vmcnt(24) lgkmcnt(4)
Ta 216,16,24712
Mvaa 96,224,32
Ta 218,16,26248
Mvaa 96,228,48
Ta 220,16,37000
Mvaa 104,224,36
Ta 222,16,38536
Mvaa 104,228,52
Ra 4,20,2048
Mvaa 112,224,40
Ra 20,21,2048
Mvaa 112,228,56
buffer_load_dwordx4 v25,s[20:23],s43 offen offset:0 lds
Mvaa 120,224,44
Mvaa 120,228,60
WL 12
Ta 224,17,24704
Mvaa 100,232,32
Ta 226,17,26240
Mvaa 100,236,48
K1_p10:
s_cbranch_vccnz K1_p74
Ta 228,17,36992
Mvaa 108,232,36
Ta 230,17,38528
Mvaa 108,236,52
Mvaa 116,232,40
buffer_load_dwordx4 v26,s[20:23],s43 offen offset:1024 lds
Mvaa 116,236,56
Mvaa 124,232,44
s_add_u32 m0,s42,0
s_add_u32 s43,s14,0
Mvaa 124,236,60
s_waitcnt vmcnt(24) lgkmcnt(4)
Ta 232,17,24712
Mvaa 128,208,32
Ta 234,17,26248
Mvaa 128,212,48
Ta 236,17,37000
Mvaa 136,208,36
Ta 238,17,38536
Mvaa 136,212,52
Ra 8,20,4096
Mvaa 144,208,40
Ra 24,21,4096
Mvaa 144,212,56
buffer_load_dwordx4 v27,s[20:23],s43 offen offset:2048 lds
Mvaa 152,208,44
Mvaa 152,212,60
WL 12
Ta 208,16,24832
Mvaa 132,216,32
Ta 210,16,26368
Mvaa 132,220,48
Ta 212,16,37120
Mvaa 140,216,36
K1_p11:
s_cbranch_vccnz K1_p75
Ta 214,16,38656
Mvaa 140,220,52
Mvaa 148,216,40
buffer_load_dwordx4 v28,s[20:23],s43 offen offset:3072 lds
Mvaa 148,220,56
Mvaa 156,216,44
s_add_u32 m0,s42,4096
s_add_u32 s43,s14,40960
Mvaa 156,220,60
s_waitcnt vmcnt(24) lgkmcnt(4)
Ta 216,16,24840
Mvaa 160,224,32
Ta 218,16,26376
Mvaa 160,228,48
Ta 220,16,37128
Mvaa 168,224,36
Ta 222,16,38664
Mvaa 168,228,52
Ra 12,20,6144
v_xor_b32 v16,0xc000,v16
Mvaa 176,224,40
Ra 28,21,6144
Mvaa 176,228,56
buffer_load_dwordx4 v25,s[20:23],s43 offen offset:0 lds
Mvaa 184,224,44
Mvaa 184,228,60
WL 12
Ta 224,17,24832
Mvaa 164,232,32
Ta 226,17,26368
Mvaa 164,236,48
Ta 228,17,37120
K1_p12:
s_cbranch_vccnz K1_p76
Mvaa 172,232,36
Ta 230,17,38656
Mvaa 172,236,52
Mvaa 180,232,40
buffer_load_dwordx4 v26,s[20:23],s43 offen offset:1024 lds
Mvaa 180,236,56
Mvaa 188,232,44
s_add_u32 m0,s42,4096
s_add_u32 s43,s14,40960
s_add_u32 s10,s14,128
Mvaa 188,236,60
WL 4
Ta 232,17,24840
s_sub_u32 s11,s10,1280
Mvaa 192,208,32
s_min_u32 s14,s10,s11
Ta 234,17,26376
Mvaa 192,212,48
Ta 236,17,37128
Mvaa 200,208,36
Ta 238,17,38664
Mvaa 200,212,52
s_add_u32 s101,s101,1280
v_xor_b32 v17,0xc000,v17
Mvaa 208,208,40
buffer_load_dwordx4 v27,s[20:23],s43 offen offset:2048 lds
Mvaa 208,212,56
Mvaa 216,208,44
Mvaa 216,212,60
s_waitcnt vmcnt(21) lgkmcnt(10)
s_barrier
Ta 208,16,0
Mvaa 196,216,32
Ta 210,16,1536
K1_p13:
s_cbranch_vccnz K1_p77
Mvaa 196,220,48
buffer_load_dwordx4 v28,s[20:23],s43 offen offset:3072 lds
Mvaa 204,216,36
s_add_u32 m0,s12,0
buffer_load_dword v18,v19,s[48:51],s101 offen
Mvaa 204,220,52
s_add_u32 s43,s13,0
Ta 212,16,12288
Mvaa 212,216,40
Ta 214,16,13824
Mvaa 212,220,56
buffer_load_dwordx4 v22,s[24:27],s43 offen offset:0 lds
Mvaa 220,216,44
Mvaa 220,220,60
WL 8
Ta 216,16,8
Mvaa 224,224,32
Ta 218,16,1544
Mvaa 224,228,48
Ta 220,16,12296
Mvaa 232,224,36
Ta 222,16,13832
Mvaa 232,228,52
buffer_load_dwordx4 v23,s[24:27],s43 offen offset:1024 lds
Mvaa 240,224,40
Mvaa 240,228,56
Mvaa 248,224,44
Mvaa 248,228,60
WL 8
Ta 224,17,0
Mvaa 228,232,32
Ta 226,17,1536
Mvaa 228,236,48
K1_p14:
s_cbranch_vccnz K1_p78
Ta 228,17,12288
Mvaa 236,232,36
s_add_u32 s10,s13,786432
buffer_load_dwordx4 v24,s[24:27],s43 offen offset:2048 lds
Mvaa 236,236,52
s_add_u32 m0,s12,3072
Ta 230,17,13824
s_add_u32 s43,s13,98304
Mvaa 244,232,40
s_sub_u32 s11,s10,7864320
s_min_u32 s13,s10,s11
Mvaa 244,236,56
Mvaa 252,232,44
Mvaa 252,236,60
s_waitcnt vmcnt(24) lgkmcnt(8)
Ta 232,17,8
Mvaa 64,208,0
Ta 234,17,1544
Mvaa 64,212,16
buffer_load_dwordx4 v22,s[24:27],s43 offen offset:0 lds
Mvaa 72,208,4
Ta 236,17,12296
Mvaa 72,212,20
Ta 238,17,13832
Mvaa 80,208,8
Ra 32,20,32768
Mvaa 80,212,24
Ra 48,21,32768
Mvaa 88,208,12
buffer_load_dwordx4 v23,s[24:27],s43 offen offset:1024 lds
Mvaa 88,212,28
WL 10
Ta 208,16,128
K1_p15:
s_cbranch_vccnz K1_p79
Mvaa 68,216,0
Ta 210,16,1664
Mvaa 68,220,16
Ta 212,16,12416
Mvaa 76,216,4
Ta 214,16,13952
Mvaa 76,220,20
Mvaa 84,216,8
Mvaa 84,220,24
buffer_load_dwordx4 v24,s[24:27],s43 offen offset:2048 lds
Mvaa 92,216,12
s_add_u32 m0,s42,32768
s_add_u32 s43,s14,0
Mvaa 92,220,28
s_waitcnt vmcnt(25) lgkmcnt(4)
Ta 216,16,136
Mvaa 96,224,0
Ta 218,16,1672
Mvaa 96,228,16
Ta 220,16,12424
Mvaa 104,224,4
Ta 222,16,13960
Mvaa 104,228,20
Ra 36,20,34816
Mvaa 112,224,8
Ra 52,21,34816
Mvaa 112,228,24
buffer_load_dwordx4 v25,s[20:23],s43 offen offset:0 lds
Mvaa 120,224,12
Mvaa 120,228,28
WL 12
Ta 224,17,128
Mvaa 100,232,0
K1_p16:
s_cbranch_vccnz K1_p112
Ta 226,17,1664
Mvaa 100,236,16
Ta 228,17,12416
Mvaa 108,232,4
Ta 230,17,13952
Mvaa 108,236,20
Mvaa 116,232,8
buffer_load_dwordx4 v26,s[20:23],s43 offen offset:1024 lds
Mvaa 116,236,24
Mvaa 124,232,12
s_add_u32 m0,s42,32768
s_add_u32 s43,s14,0
Mvaa 124,236,28
s_waitcnt vmcnt(25) lgkmcnt(4)
Ta 232,17,136
Mvaa 128,208,0
Ta 234,17,1672
Mvaa 128,212,16
Ta 236,17,12424
Mvaa 136,208,4
Ta 238,17,13960
Mvaa 136,212,20
Ra 40,20,36864
Mvaa 144,208,8
Ra 56,21,36864
Mvaa 144,212,24
buffer_load_dwordx4 v27,s[20:23],s43 offen offset:2048 lds
Mvaa 152,208,12
Mvaa 152,212,28
WL 12
Ta 208,16,256
Mvaa 132,216,0
Ta 210,16,1792
K1_p17:
s_cbranch_vccnz K1_p113
Mvaa 132,220,16
Ta 212,16,12544
Mvaa 140,216,4
Ta 214,16,14080
Mvaa 140,220,20
Mvaa 148,216,8
buffer_load_dwordx4 v28,s[20:23],s43 offen offset:3072 lds
Mvaa 148,220,24
Mvaa 156,216,12
s_add_u32 m0,s42,36864
s_add_u32 s43,s14,40960
Mvaa 156,220,28
s_waitcnt vmcnt(25) lgkmcnt(4)
Ta 216,16,264
Mvaa 160,224,0
Ta 218,16,1800
Mvaa 160,228,16
Ta 220,16,12552
Mvaa 168,224,4
Ta 222,16,14088
Mvaa 168,228,20
Ra 44,20,38912
Mvaa 176,224,8
Ra 60,21,38912
Mvaa 176,228,24
buffer_load_dwordx4 v25,s[20:23],s43 offen offset:0 lds
Mvaa 184,224,12
Mvaa 184,228,28
WL 12
Ta 224,17,256
Mvaa 164,232,0
Ta 226,17,1792
Mvaa 164,236,16
K1_p18:
s_cbranch_vccnz K1_p82
Ta 228,17,12544
Mvaa 172,232,4
Ta 230,17,14080
Mvaa 172,236,20
Mvaa 180,232,8
buffer_load_dwordx4 v26,s[20:23],s43 offen offset:1024 lds
Mvaa 180,236,24
Mvaa 188,232,12
s_add_u32 m0,s42,36864
s_add_u32 s43,s14,40960
s_add_u32 s10,s14,128
Mvaa 188,236,28
WL 4
Ta 232,17,264
s_sub_u32 s11,s10,1280
Mvaa 192,208,0
s_min_u32 s14,s10,s11
Ta 234,17,1800
Mvaa 192,212,16
Ta 236,17,12552
Mvaa 200,208,4
Ta 238,17,14088
Mvaa 200,212,20
s_add_u32 s101,s101,1280
Mvaa 208,208,8
buffer_load_dwordx4 v27,s[20:23],s43 offen offset:2048 lds
Mvaa 208,212,24
Mvaa 216,208,12
Mvaa 216,212,28
s_waitcnt vmcnt(22) lgkmcnt(10)
s_barrier
Ta 208,16,24576
Mvaa 196,216,0
K1_p19:
s_cbranch_vccnz K1_p83
Ta 210,16,26112
Mvaa 196,220,16
buffer_load_dwordx4 v28,s[20:23],s43 offen offset:3072 lds
Mvaa 204,216,4
s_add_u32 m0,s12,24576
buffer_load_dword v18,v19,s[48:51],s101 offen
Mvaa 204,220,20
s_add_u32 s43,s13,0
Ta 212,16,36864
Mvaa 212,216,8
Ta 214,16,38400
Mvaa 212,220,24
buffer_load_dwordx4 v22,s[24:27],s43 offen offset:0 lds
Mvaa 220,216,12
Mvaa 220,220,28
WL 8
Ta 216,16,24584
Mvaa 224,224,0
Ta 218,16,26120
Mvaa 224,228,16
Ta 220,16,36872
Mvaa 232,224,4
Ta 222,16,38408
Mvaa 232,228,20
buffer_load_dwordx4 v23,s[24:27],s43 offen offset:1024 lds
Mvaa 240,224,8
Mvaa 240,228,24
Mvaa 248,224,12
Mvaa 248,228,28
WL 8
Ta 224,17,24576
Mvaa 228,232,0
Ta 226,17,26112
K1_p20:
s_cbranch_vccnz K1_p84
Mvaa 228,236,16
Ta 228,17,36864
Mvaa 236,232,4
s_add_u32 s10,s13,786432
buffer_load_dwordx4 v24,s[24:27],s43 offen offset:2048 lds
Mvaa 236,236,20
s_add_u32 m0,s12,27648
Ta 230,17,38400
s_add_u32 s43,s13,98304
Mvaa 244,232,8
s_sub_u32 s11,s10,7864320
s_min_u32 s13,s10,s11
s_sub_u32 s12,s15,s12
Mvaa 244,236,24
Mvaa 252,232,12
Mvaa 252,236,28
s_waitcnt vmcnt(25) lgkmcnt(8)
Ta 232,17,24584
s_add_u32 s3,s3,1
s_cmp_lg_u32 s3,3
s_cbranch_scc1 K1q4_L0
Mvaa 64,208,32
s_barrier
Ta 234,17,26120
Mvaa 64,212,48
buffer_load_dwordx4 v22,s[24:27],s43 offen offset:0 lds
Mvaa 72,208,36
Ta 236,17,36872
Mvaa 72,212,52
Ta 238,17,38408
Mvaa 80,208,40
Ra 0,20,0
Mvaa 80,212,56
Ra 16,21,0
Mvaa 88,208,44
K1_p21:
s_cbranch_vccnz K1_p85
buffer_load_dwordx4 v23,s[24:27],s43 offen offset:1024 lds
Mvaa 88,212,60
WL 10
Ta 208,16,24704
Mvaa 68,216,32
Ta 210,16,26240
Mvaa 68,220,48
Ta 212,16,36992
Mvaa 76,216,36
Ta 214,16,38528
Mvaa 76,220,52
Mvaa 84,216,40
Mvaa 84,220,56
buffer_load_dwordx4 v24,s[24:27],s43 offen offset:2048 lds
Mvaa 92,216,44
s_add_u32 m0,s41,49152
s_mov_b32 s43,0
Mvaa 92,220,60
s_waitcnt vmcnt(26) lgkmcnt(4)
buffer_load_dwordx4 v7,s[28:31],s43 offen offset:0 nt lds
Mvaa 96,224,32
Ta 216,16,24712
Mvaa 96,228,48
Ta 218,16,26248
Mvaa 104,224,36
Ta 220,16,37000
Mvaa 104,228,52
Ta 222,16,38536
Mvaa 112,224,40
buffer_load_dwordx4 v8,s[28:31],s43 offen offset:1024 nt lds
Mvaa 112,228,56
Ra 4,20,2048
Mvaa 120,224,44
K1_p22:
s_cbranch_vccnz K1_p86
Ra 20,21,2048
Mvaa 120,228,60
WL 12
Ta 224,17,24704
Mvaa 100,232,32
Ta 226,17,26240
Mvaa 100,236,48
Ta 228,17,36992
Mvaa 108,232,36
Ta 230,17,38528
Mvaa 108,236,52
Mvaa 116,232,40
Mvaa 116,236,56
Mvaa 124,232,44
Mvaa 124,236,60
s_waitcnt vmcnt(26) lgkmcnt(4)
Ta 232,17,24712
Mvaa 128,208,32
Ta 234,17,26248
Mvaa 128,212,48
Ta 236,17,37000
Mvaa 136,208,36
Ta 238,17,38536
Mvaa 136,212,52
buffer_load_dwordx4 v9,s[28:31],s43 offen offset:2048 nt lds
Mvaa 144,208,40
Ra 8,20,4096
Mvaa 144,212,56
Ra 24,21,4096
Mvaa 152,208,44
Mvaa 152,212,60
WL 12
Ta 208,16,24832
K1_p23:
s_cbranch_vccnz K1_p87
Mvaa 132,216,32
Ta 210,16,26368
Mvaa 132,220,48
Ta 212,16,37120
Mvaa 140,216,36
Ta 214,16,38656
Mvaa 140,220,52
Mvaa 148,216,40
s_add_u32 m0,s41,52224
s_mov_b32 s43,3072
Mvaa 148,220,56
Mvaa 156,216,44
Mvaa 156,220,60
s_waitcnt vmcnt(25) lgkmcnt(4)
Ta 216,16,24840
Mvaa 160,224,32
Ta 218,16,26376
Mvaa 160,228,48
Ta 220,16,37128
Mvaa 168,224,36
Ta 222,16,38664
Mvaa 168,228,52
buffer_load_dwordx4 v7,s[28:31],s43 offen offset:0 nt lds
Mvaa 176,224,40
Ra 12,20,6144
v_xor_b32 v16,0xc000,v16
Mvaa 176,228,56
Ra 28,21,6144
Mvaa 184,224,44
Mvaa 184,228,60
WL 12
Ta 224,17,24832
Mvaa 164,232,32
K1_p24:
s_cbranch_vccnz K1_p88
Ta 226,17,26368
Mvaa 164,236,48
Ta 228,17,37120
Mvaa 172,232,36
Ta 230,17,38656
Mvaa 172,236,52
Mvaa 180,232,40
Mvaa 180,236,56
Mvaa 188,232,44
Mvaa 188,236,60
WL 4
Ta 232,17,24840
Mvaa 192,208,32
Ta 234,17,26376
Mvaa 192,212,48
Ta 236,17,37128
Mvaa 200,208,36
buffer_load_dwordx4 v8,s[28:31],s43 offen offset:1024 nt lds
Mvaa 200,212,52
Ta 238,17,38664
Mvaa 208,208,40
v_xor_b32 v17,0xc000,v17
Mvaa 208,212,56
Mvaa 216,208,44
Mvaa 216,212,60
s_waitcnt vmcnt(20) lgkmcnt(10)
s_barrier
Ta 208,16,0
Mvaa 196,216,32
Ta 210,16,1536
Mvaa 196,220,48
Ta 212,16,12288
Mvaa 204,216,36
K1_p25:
s_cbranch_vccnz K1_p89
Ta 214,16,13824
Mvaa 204,220,52
Mvaa 212,216,40
Mvaa 212,220,56
Mvaa 220,216,44
Mvaa 220,220,60
WL 8
Ta 216,16,8
Mvaa 224,224,32
Ta 218,16,1544
Mvaa 224,228,48
buffer_load_dwordx4 v9,s[28:31],s43 offen offset:2048 nt lds
Mvaa 232,224,36
Ta 220,16,12296
Mvaa 232,228,52
Ta 222,16,13832
Mvaa 240,224,40
Mvaa 240,228,56
Mvaa 248,224,44
Mvaa 248,228,60
WL 8
Ta 224,17,0
Mvaa 228,232,32
Ta 226,17,1536
Mvaa 228,236,48
Ta 228,17,12288
Mvaa 236,232,36
s_add_u32 m0,s41,98304
Ta 230,17,13824
s_mov_b32 s43,0
Mvaa 236,236,52
Mvaa 244,232,40
Mvaa 244,236,56
K1_p26:
s_cbranch_vccnz K1_p90
Mvaa 252,232,44
Mvaa 252,236,60
s_waitcnt vmcnt(19) lgkmcnt(8)
Ta 232,17,8
Mvaa 64,208,0
Ta 234,17,1544
Mvaa 64,212,16
buffer_load_dwordx4 v7,s[32:35],s43 offen offset:0 nt lds
Mvaa 72,208,4
Ta 236,17,12296
Mvaa 72,212,20
Ta 238,17,13832
Mvaa 80,208,8
Ra 32,20,32768
Mvaa 80,212,24
Ra 48,21,32768
Mvaa 88,208,12
Mvaa 88,212,28
WL 10
Ta 208,16,128
Mvaa 68,216,0
Ta 210,16,1664
Mvaa 68,220,16
Ta 212,16,12416
Mvaa 76,216,4
Ta 214,16,13952
Mvaa 76,220,20
Mvaa 84,216,8
Mvaa 84,220,24
Mvaa 92,216,12
Mvaa 92,220,28
s_waitcnt vmcnt(18) lgkmcnt(4)
Ta 216,16,136
K1_p27:
s_cbranch_vccnz K1_p91
Mvaa 96,224,0
buffer_load_dwordx4 v8,s[32:35],s43 offen offset:1024 nt lds
Mvaa 96,228,16
Ta 218,16,1672
Mvaa 104,224,4
Ta 220,16,12424
Mvaa 104,228,20
Ta 222,16,13960
Mvaa 112,224,8
Ra 36,20,34816
Mvaa 112,228,24
Ra 52,21,34816
Mvaa 120,224,12
Mvaa 120,228,28
WL 12
Ta 224,17,128
Mvaa 100,232,0
Ta 226,17,1664
Mvaa 100,236,16
Ta 228,17,12416
Mvaa 108,232,4
Ta 230,17,13952
Mvaa 108,236,20
Mvaa 116,232,8
Mvaa 116,236,24
Mvaa 124,232,12
buffer_load_dwordx4 v9,s[32:35],s43 offen offset:2048 nt lds
Mvaa 124,236,28
s_waitcnt vmcnt(18) lgkmcnt(4)
Ta 232,17,136
Mvaa 128,208,0
Ta 234,17,1672
K1_p28:
s_cbranch_vccnz K1_p92
Mvaa 128,212,16
Ta 236,17,12424
Mvaa 136,208,4
Ta 238,17,13960
Mvaa 136,212,20
Ra 40,20,36864
Mvaa 144,208,8
Ra 56,21,36864
Mvaa 144,212,24
Mvaa 152,208,12
Mvaa 152,212,28
WL 12
Ta 208,16,256
Mvaa 132,216,0
s_add_u32 m0,s41,101376
Ta 210,16,1792
s_mov_b32 s43,3072
Mvaa 132,220,16
Ta 212,16,12544
Mvaa 140,216,4
Ta 214,16,14080
Mvaa 140,220,20
Mvaa 148,216,8
Mvaa 148,220,24
Mvaa 156,216,12
buffer_load_dwordx4 v7,s[32:35],s43 offen offset:0 nt lds
Mvaa 156,220,28
s_waitcnt vmcnt(17) lgkmcnt(4)
Ta 216,16,264
Mvaa 160,224,0
Ta 218,16,1800
Mvaa 160,228,16
Ta 220,16,12552
K1_p29:
s_cbranch_vccnz K1_p93
Mvaa 168,224,4
Ta 222,16,14088
Mvaa 168,228,20
Ra 44,20,38912
Mvaa 176,224,8
Ra 60,21,38912
Mvaa 176,228,24
Mvaa 184,224,12
Mvaa 184,228,28
WL 12
Ta 224,17,256
Mvaa 164,232,0
Ta 226,17,1792
Mvaa 164,236,16
Ta 228,17,12544
Mvaa 172,232,4
Ta 230,17,14080
Mvaa 172,236,20
Mvaa 180,232,8
Mvaa 180,236,24
buffer_load_dwordx4 v8,s[32:35],s43 offen offset:1024 nt lds
Mvaa 188,232,12
Mvaa 188,236,28
WL 4
Ta 232,17,264
Mvaa 192,208,0
Ta 234,17,1800
Mvaa 192,212,16
Ta 236,17,12552
Mvaa 200,208,4
Ta 238,17,14088
Mvaa 200,212,20
K1_p30:
s_cbranch_vccnz K1_p94
Mvaa 208,208,8
Mvaa 208,212,24
Mvaa 216,208,12
Mvaa 216,212,28
s_waitcnt vmcnt(11) lgkmcnt(10)
s_barrier
Ta 208,16,24576
Mvaa 196,216,0
Ta 210,16,26112
Mvaa 196,220,16
Ta 212,16,36864
Mvaa 204,216,4
Ta 214,16,38400
Mvaa 204,220,20
Mvaa 212,216,8
buffer_load_dwordx4 v9,s[32:35],s43 offen offset:2048 nt lds
Mvaa 212,220,24
Mvaa 220,216,12
Mvaa 220,220,28
WL 8
Ta 216,16,24584
Mvaa 224,224,0
Ta 218,16,26120
Mvaa 224,228,16
Ta 220,16,36872
Mvaa 232,224,4
Ta 222,16,38408
Mvaa 232,228,20
Mvaa 240,224,8
Mvaa 240,228,24
Mvaa 248,224,12
s_add_u32 m0,s41,73728
s_mov_b32 s43,24576
K1_p31:
s_cbranch_vccnz K1_p95
Mvaa 248,228,28
WL 8
Ta 224,17,24576
Mvaa 228,232,0
Ta 226,17,26112
Mvaa 228,236,16
Ta 228,17,36864
Mvaa 236,232,4
Ta 230,17,38400
Mvaa 236,236,20
Mvaa 244,232,8
buffer_load_dwordx4 v7,s[28:31],s43 offen offset:0 nt lds
Mvaa 244,236,24
Mvaa 252,232,12
Mvaa 252,236,28
WL 8
Ta 232,17,24584
Mvaa 64,208,32
Ta 234,17,26120
Mvaa 64,212,48
Ta 236,17,36872
Mvaa 72,208,36
Ta 238,17,38408
Mvaa 72,212,52
Mvaa 80,208,40
Mvaa 80,212,56
Mvaa 88,208,44
s_nop 0
v_mul_f32 v64,s44,v64
v_mul_f32 v65,s44,v65
Mvaa 88,212,60
WL 8
Ta 208,16,24704
v_mul_f32 v66,s44,v66
Mvaa 68,216,32
K1_p32:
s_cbranch_vccnz K1_p224
Ta 210,16,26240
v_mul_f32 v67,s44,v67
Mvaa 68,220,48
Ta 212,16,36992
CV 64,64,65
Mvaa 76,216,36
Ta 214,16,38528
CV 65,66,67
Mvaa 76,220,52
buffer_load_dwordx4 v8,s[28:31],s43 offen offset:1024 nt lds
Mvaa 84,216,40
v_mul_f32 v72,s44,v72
v_mul_f32 v73,s44,v73
Mvaa 84,220,56
v_mul_f32 v74,s44,v74
v_mul_f32 v75,s44,v75
Mvaa 92,216,44
v_mul_f32 v68,s44,v68
v_mul_f32 v69,s44,v69
Mvaa 92,220,60
WL 8
Ta 216,16,24712
v_mul_f32 v70,s44,v70
Mvaa 96,224,32
Ta 218,16,26248
v_mul_f32 v71,s44,v71
Mvaa 96,228,48
Ta 220,16,37000
CV 66,68,69
Mvaa 104,224,36
Ta 222,16,38536
CV 67,70,71
Mvaa 104,228,52
CV 72,72,73
CV 73,74,75
Mvaa 112,224,40
v_mul_f32 v76,s44,v76
K1_p33:
s_cbranch_vccnz K1_p225
v_mul_f32 v77,s44,v77
Mvaa 112,228,56
v_mul_f32 v78,s44,v78
v_mul_f32 v79,s44,v79
Mvaa 120,224,44
v_mul_f32 v96,s44,v96
v_mul_f32 v97,s44,v97
Mvaa 120,228,60
WL 8
Ta 224,17,24704
v_mul_f32 v98,s44,v98
Mvaa 100,232,32
Ta 226,17,26240
v_mul_f32 v99,s44,v99
Mvaa 100,236,48
Ta 228,17,36992
CV 96,96,97
Mvaa 108,232,36
Ta 230,17,38528
CV 97,98,99
Mvaa 108,236,52
buffer_load_dwordx4 v9,s[28:31],s43 offen offset:2048 nt lds
Mvaa 116,232,40
CV 74,76,77
CV 75,78,79
Mvaa 116,236,56
v_mul_f32 v104,s44,v104
v_mul_f32 v105,s44,v105
Mvaa 124,232,44
v_mul_f32 v100,s44,v100
v_mul_f32 v101,s44,v101
Mvaa 124,236,60
WL 8
Ta 232,17,24712
v_mul_f32 v102,s44,v102
Mvaa 128,208,32
Ta 234,17,26248
v_mul_f32 v103,s44,v103
Mvaa 128,212,48
K1_p34:
s_cbranch_vccnz K1_p226
Ta 236,17,37000
CV 98,100,101
Mvaa 136,208,36
Ta 238,17,38536
CV 99,102,103
Mvaa 136,212,52
v_mul_f32 v106,s44,v106
v_mul_f32 v107,s44,v107
Mvaa 144,208,40
s_add_u32 m0,s41,76800
CV 104,104,105
CV 105,106,107
Mvaa 144,212,56
s_mov_b32 s43,27648
v_mul_f32 v108,s44,v108
v_mul_f32 v109,s44,v109
Mvaa 152,208,44
v_mul_f32 v110,s44,v110
v_mul_f32 v111,s44,v111
Mvaa 152,212,60
WL 8
Ta 208,16,24832
CV 106,108,109
Mvaa 132,216,32
Ta 210,16,26368
CV 107,110,111
Mvaa 132,220,48
Ta 212,16,37120
v_mul_f32 v80,s44,v80
Mvaa 140,216,36
Ta 214,16,38656
v_mul_f32 v81,s44,v81
Mvaa 140,220,52
buffer_load_dwordx4 v7,s[28:31],s43 offen offset:0 nt lds
Mvaa 148,216,40
v_mul_f32 v82,s44,v82
v_mul_f32 v83,s44,v83
K1_p35:
s_cbranch_vccnz K1_p227
Mvaa 148,220,56
CV 80,80,81
CV 81,82,83
Mvaa 156,216,44
v_mul_f32 v84,s44,v84
v_mul_f32 v85,s44,v85
Mvaa 156,220,60
WL 8
Ta 216,16,24840
v_mul_f32 v86,s44,v86
Mvaa 160,224,32
Ta 218,16,26376
v_mul_f32 v87,s44,v87
Mvaa 160,228,48
Ta 220,16,37128
CV 82,84,85
Mvaa 168,224,36
Ta 222,16,38664
CV 83,86,87
Mvaa 168,228,52
v_mul_f32 v112,s44,v112
v_mul_f32 v113,s44,v113
Mvaa 176,224,40
v_mul_f32 v114,s44,v114
v_mul_f32 v115,s44,v115
Mvaa 176,228,56
CV 112,112,113
CV 113,114,115
Mvaa 184,224,44
v_mul_f32 v116,s44,v116
v_mul_f32 v117,s44,v117
Mvaa 184,228,60
WL 8
Ta 224,17,24832
v_mul_f32 v118,s44,v118
Mvaa 164,232,32
Ta 226,17,26368
v_mul_f32 v119,s44,v119
Mvaa 164,236,48
K1_p36:
s_cbranch_vccnz K1_p228
Ta 228,17,37120
CV 114,116,117
Mvaa 172,232,36
buffer_load_dwordx4 v8,s[28:31],s43 offen offset:1024 nt lds
Mvaa 172,236,52
Ta 230,17,38656
CV 115,118,119
Mvaa 180,232,40
v_mul_f32 v88,s44,v88
v_mul_f32 v89,s44,v89
Mvaa 180,236,56
v_mul_f32 v90,s44,v90
v_mul_f32 v91,s44,v91
Mvaa 188,232,44
CV 88,88,89
CV 89,90,91
Mvaa 188,236,60
WL 8
Ta 232,17,24840
v_mul_f32 v92,s44,v92
Mvaa 192,208,32
Ta 234,17,26376
v_mul_f32 v93,s44,v93
Mvaa 192,212,48
Ta 236,17,37128
v_mul_f32 v94,s44,v94
Mvaa 200,208,36
Ta 238,17,38664
v_mul_f32 v95,s44,v95
Mvaa 200,212,52
CV 90,92,93
CV 91,94,95
Mvaa 208,208,40
v_mul_f32 v120,s44,v120
v_mul_f32 v121,s44,v121
Mvaa 208,212,56
v_mul_f32 v122,s44,v122
K1_p37:
s_cbranch_vccnz K1_p229
v_mul_f32 v123,s44,v123
Mvaa 216,208,44
CV 120,120,121
CV 121,122,123
Mvaa 216,212,60
s_waitcnt vmcnt(11) lgkmcnt(8)
s_barrier
Ra 208,1,0
Mvaa 196,216,32
Ra 212,2,0
v_mul_f32 v124,s44,v124
Mvaa 196,220,48
buffer_load_dwordx4 v9,s[28:31],s43 offen offset:2048 nt lds
Mvaa 204,216,36
v_mul_f32 v125,s44,v125
v_mul_f32 v126,s44,v126
Mvaa 204,220,52
v_mul_f32 v127,s44,v127
CV 122,124,125
Mvaa 212,216,40
CV 123,126,127
v_mul_f32 v128,s44,v128
Mvaa 212,220,56
v_mul_f32 v129,s44,v129
v_mul_f32 v130,s44,v130
Mvaa 220,216,44
v_mul_f32 v131,s44,v131
CV 128,128,129
Mvaa 220,220,60
WL 6
Ra 216,1,128
CV 129,130,131
Mvaa 224,224,32
Ra 220,2,128
v_mul_f32 v132,s44,v132
Mvaa 224,228,48
v_mul_f32 v133,s44,v133
v_mul_f32 v134,s44,v134
Mvaa 232,224,36
K1_p38:
s_cbranch_vccnz K1_p230
s_add_u32 m0,s41,122880
v_mul_f32 v135,s44,v135
CV 130,132,133
Mvaa 232,228,52
s_mov_b32 s43,49152
CV 131,134,135
v_mul_f32 v160,s44,v160
Mvaa 240,224,40
v_mul_f32 v161,s44,v161
v_mul_f32 v162,s44,v162
Mvaa 240,228,56
v_mul_f32 v163,s44,v163
CV 160,160,161
Mvaa 248,224,44
CV 161,162,163
v_mul_f32 v164,s44,v164
Mvaa 248,228,60
WL 4
Ra 224,1,256
v_mul_f32 v165,s44,v165
Mvaa 228,232,32
Ra 228,2,256
v_mul_f32 v166,s44,v166
Mvaa 228,236,48
buffer_load_dwordx4 v7,s[28:31],s43 offen offset:0 nt lds
Mvaa 236,232,36
v_mul_f32 v167,s44,v167
CV 162,164,165
Mvaa 236,236,52
CV 163,166,167
v_mul_f32 v136,s44,v136
Mvaa 244,232,40
v_mul_f32 v137,s44,v137
v_mul_f32 v138,s44,v138
Mvaa 244,236,56
v_mul_f32 v139,s44,v139
CV 136,136,137
Mvaa 252,232,44
CV 137,138,139
K1_p39:
s_cbranch_vccnz K1_p231
v_mul_f32 v140,s44,v140
Mvaa 252,236,60
WL 4
Ra 232,1,6144
v_mul_f32 v141,s44,v141
MvavZ 32,208,64
s_lshr_b32 s12,s2,3
Ra 236,2,6144
v_mul_f32 v142,s44,v142
Mvav 32,212,96
s_mul_i32 s15,s12,52
v_mul_f32 v143,s44,v143
CV 138,140,141
MvavZ 36,208,72
s_lshr_b32 s15,s15,8
CV 139,142,143
v_mul_f32 v168,s44,v168
Mvav 36,212,104
s_mul_i32 s13,s15,5
v_mul_f32 v169,s44,v169
v_mul_f32 v170,s44,v170
MvavZ 40,208,80
s_sub_u32 s12,s12,s13
v_mul_f32 v171,s44,v171
CV 168,168,169
Mvav 40,212,112
s_mul_i32 s15,s15,3
CV 169,170,171
v_mul_f32 v172,s44,v172
MvavZ 44,208,88
s_mul_i32 s12,s12,3
v_mul_f32 v173,s44,v173
v_mul_f32 v174,s44,v174
Mvav 44,212,120
WL 4
Ra 208,1,6272
v_mul_f32 v175,s44,v175
Mvav 32,216,128
s_add_u32 s15,s15,s12
buffer_load_dwordx4 v8,s[28:31],s43 offen offset:1024 nt lds
CV 170,172,173
CV 171,174,175
K1_p40:
s_cbranch_vccnz K1_p232
Mvav 32,220,160
s_and_b32 s15,s15,15
Ra 212,2,6272
v_mul_f32 v144,s44,v144
v_mul_f32 v145,s44,v145
v_mul_f32 v146,s44,v146
v_mul_f32 v147,s44,v147
CV 144,144,145
CV 145,146,147
v_mul_f32 v148,s44,v148
v_mul_f32 v149,s44,v149
v_mul_f32 v150,s44,v150
v_mul_f32 v151,s44,v151
CV 146,148,149
CV 147,150,151
Mvav 36,216,136
s_mul_i32 s12,s15,3
v_mul_f32 v176,s44,v176
v_mul_f32 v177,s44,v177
v_mul_f32 v178,s44,v178
v_mul_f32 v179,s44,v179
CV 176,176,177
CV 177,178,179
v_mul_f32 v180,s44,v180
v_mul_f32 v181,s44,v181
v_mul_f32 v182,s44,v182
v_mul_f32 v183,s44,v183
CV 178,180,181
CV 179,182,183
Mvav 36,220,168
s_add_u32 s12,s12,12
v_mul_f32 v152,s44,v152
v_mul_f32 v153,s44,v153
v_mul_f32 v154,s44,v154
v_mul_f32 v155,s44,v155
CV 152,152,153
CV 153,154,155
v_mul_f32 v156,s44,v156
v_mul_f32 v157,s44,v157
v_mul_f32 v158,s44,v158
v_mul_f32 v159,s44,v159
CV 154,156,157
CV 155,158,159
Mvav 40,216,144
s_sub_u32 s13,s12,48
v_mul_f32 v184,s44,v184
K1_p41:
s_cbranch_vccnz K1_p233
v_mul_f32 v185,s44,v185
v_mul_f32 v186,s44,v186
v_mul_f32 v187,s44,v187
CV 184,184,185
CV 185,186,187
v_mul_f32 v188,s44,v188
v_mul_f32 v189,s44,v189
v_mul_f32 v190,s44,v190
v_mul_f32 v191,s44,v191
CV 186,188,189
CV 187,190,191
Mvav 40,220,176
s_min_u32 s12,s12,s13
v_mul_f32 v192,s44,v192
v_mul_f32 v193,s44,v193
v_mul_f32 v194,s44,v194
v_mul_f32 v195,s44,v195
CV 192,192,193
CV 193,194,195
v_mul_f32 v196,s44,v196
v_mul_f32 v197,s44,v197
v_mul_f32 v198,s44,v198
v_mul_f32 v199,s44,v199
CV 194,196,197
CV 195,198,199
Mvav 44,216,152
s_mul_i32 s14,s12,40960
v_mul_f32 v224,s44,v224
v_mul_f32 v225,s44,v225
v_mul_f32 v226,s44,v226
v_mul_f32 v227,s44,v227
CV 224,224,225
CV 225,226,227
v_mul_f32 v228,s44,v228
v_mul_f32 v229,s44,v229
v_mul_f32 v230,s44,v230
v_mul_f32 v231,s44,v231
CV 226,228,229
CV 227,230,231
Mvav 44,220,184
WL 4
Ra 216,1,6400
v_mul_f32 v200,s44,v200
v_mul_f32 v201,s44,v201
v_mul_f32 v202,s44,v202
v_mul_f32 v203,s44,v203
K1_p42:
s_cbranch_vccnz K1_p234
CV 200,200,201
CV 201,202,203
v_mul_f32 v204,s44,v204
v_mul_f32 v205,s44,v205
v_mul_f32 v206,s44,v206
v_mul_f32 v207,s44,v207
CV 202,204,205
CV 203,206,207
Mvav 32,224,192
Ra 220,2,6400
v_mul_f32 v232,s44,v232
v_mul_f32 v233,s44,v233
v_mul_f32 v234,s44,v234
v_mul_f32 v235,s44,v235
CV 232,232,233
CV 233,234,235
v_mul_f32 v236,s44,v236
v_mul_f32 v237,s44,v237
v_mul_f32 v238,s44,v238
v_mul_f32 v239,s44,v239
CV 234,236,237
CV 235,238,239
Mvav 32,228,224
v_mul_f32 v208,s44,v208
v_mul_f32 v209,s44,v209
v_mul_f32 v210,s44,v210
v_mul_f32 v211,s44,v211
CV 208,208,209
CV 209,210,211
v_mul_f32 v212,s44,v212
v_mul_f32 v213,s44,v213
v_mul_f32 v214,s44,v214
v_mul_f32 v215,s44,v215
CV 210,212,213
CV 211,214,215
Mvav 36,224,200
v_mul_f32 v240,s44,v240
v_mul_f32 v241,s44,v241
v_mul_f32 v242,s44,v242
v_mul_f32 v243,s44,v243
CV 240,240,241
CV 241,242,243
v_mul_f32 v244,s44,v244
v_mul_f32 v245,s44,v245
v_mul_f32 v246,s44,v246
K1_p43:
s_cbranch_vccnz K1_p235
v_mul_f32 v247,s44,v247
CV 242,244,245
CV 243,246,247
Mvav 36,228,232
v_mul_f32 v216,s44,v216
v_mul_f32 v217,s44,v217
v_mul_f32 v218,s44,v218
v_mul_f32 v219,s44,v219
CV 216,216,217
CV 217,218,219
v_mul_f32 v220,s44,v220
v_mul_f32 v221,s44,v221
v_mul_f32 v222,s44,v222
v_mul_f32 v223,s44,v223
CV 218,220,221
CV 219,222,223
Mvav 40,224,208
v_mul_f32 v248,s44,v248
v_mul_f32 v249,s44,v249
v_mul_f32 v250,s44,v250
v_mul_f32 v251,s44,v251
CV 248,248,249
CV 249,250,251
v_mul_f32 v252,s44,v252
v_mul_f32 v253,s44,v253
v_mul_f32 v254,s44,v254
v_mul_f32 v255,s44,v255
CV 250,252,253
CV 251,254,255
Mvav 40,228,240
Mvav 44,224,216
buffer_load_dwordx4 v9,s[28:31],s43 offen offset:2048 nt lds
Mvav 44,228,248
WL 4
Ra 224,1,12288
v_max3_f32 v228,v32,v33,v34
MvavZ 48,232,64
Ra 228,2,12288
v_max_f32 v228,v228,v35
Mvav 48,236,96
v_mov_b32 v229,v228
v_max3_f32 v236,v36,v37,v38
K1_p44:
s_cbranch_vccnz K1_p236
MvavZ 52,232,72
v_max_f32 v236,v236,v39
v_mov_b32 v237,v236
Mvav 52,236,104
v_permlane32_swap_b32 v228,v229
v_max_f32 v228,v228,v229
MvavZ 56,232,80
v_mov_b32 v229,v228
v_permlane32_swap_b32 v236,v237
Mvav 56,236,112
v_max_f32 v236,v236,v237
v_mov_b32 v237,v236
MvavZ 60,232,88
v_permlane16_swap_b32 v228,v229
v_max_f32 v228,v228,v229
Mvav 60,236,120
WL 4
Ra 232,1,12416
v_sub_f32 v68,0,v228
Mvav 48,208,128
s_add_u32 m0,s41,125952
Ra 236,2,12416
v_sub_f32 v69,0,v228
Mvav 48,212,160
s_mov_b32 s43,52224
v_sub_f32 v70,0,v228
v_sub_f32 v71,0,v228
Mvav 52,208,136
v_max3_f32 v244,v40,v41,v42
v_max_f32 v244,v244,v43
Mvav 52,212,168
v_mov_b32 v245,v244
v_permlane16_swap_b32 v236,v237
Mvav 56,208,144
v_max_f32 v236,v236,v237
v_sub_f32 v76,0,v236
Mvav 56,212,176
v_sub_f32 v77,0,v236
v_sub_f32 v78,0,v236
Mvav 60,208,152
buffer_load_dwordx4 v7,s[28:31],s43 offen offset:0 nt lds
Mvav 60,212,184
K1_p45:
s_cbranch_vccnz K1_p237
WL 4
Ra 208,1,12544
v_sub_f32 v79,0,v236
Mvav 48,216,192
Ra 212,2,12544
v_permlane32_swap_b32 v244,v245
Mvav 48,220,224
v_max_f32 v244,v244,v245
v_mov_b32 v245,v244
Mvav 52,216,200
v_max3_f32 v252,v44,v45,v46
v_max_f32 v252,v252,v47
Mvav 52,220,232
v_mov_b32 v253,v252
v_permlane16_swap_b32 v244,v245
Mvav 56,216,208
v_max_f32 v244,v244,v245
v_sub_f32 v84,0,v244
Mvav 56,220,240
v_sub_f32 v85,0,v244
v_sub_f32 v86,0,v244
Mvav 60,216,216
v_sub_f32 v87,0,v244
v_permlane32_swap_b32 v252,v253
Mvav 60,220,248
WL 4
Ra 216,1,18432
v_max_f32 v252,v252,v253
MvavZ 100,224,64
Ra 220,2,18432
v_mov_b32 v253,v252
Mvav 100,228,96
v_add_f32 v32,v32,v68
v_add_f32 v33,v33,v68
MvavZ 108,224,72
EX 32
Mvav 108,228,104
EX 33
MvavZ 116,224,80
v_permlane16_swap_b32 v252,v253
v_max_f32 v252,v252,v253
Mvav 116,228,112
buffer_load_dwordx4 v8,s[28:31],s43 offen offset:1024 nt lds
K1_p46:
s_cbranch_vccnz K1_p238
MvavZ 124,224,88
v_sub_f32 v92,0,v252
v_sub_f32 v93,0,v252
Mvav 124,228,120
WL 4
Ra 224,1,18560
v_sub_f32 v94,0,v252
Mvav 100,232,128
Ra 228,2,18560
v_sub_f32 v95,0,v252
Mvav 100,236,160
v_add_f32 v34,v34,v68
v_add_f32 v35,v35,v68
Mvav 108,232,136
EX 34
Mvav 108,236,168
EX 35
Mvav 116,232,144
CV 164,32,33
CV 165,34,35
Mvav 116,236,176
v_add_f32 v36,v36,v76
v_add_f32 v37,v37,v76
Mvav 124,232,152
EX 36
Mvav 124,236,184
WL 4
Ra 232,1,18688
v_add_f32 v38,v38,v76
Mvav 100,208,192
Ra 236,2,18688
v_add_u32 v1,24576,v1
Mvav 100,212,224
EX 37
Mvav 108,208,200
EX 38
Mvav 108,212,232
v_add_u32 v2,24576,v2
v_add_f32 v39,v39,v76
Mvav 116,208,208
K1_p47:
s_cbranch_vccnz K1_p239
buffer_load_dwordx4 v9,s[28:31],s43 offen offset:2048 nt lds
Mvav 116,212,240
EX 39
Mvav 124,208,216
CV 172,36,37
CV 173,38,39
Mvav 124,212,248
s_waitcnt vmcnt(6) lgkmcnt(4)
s_barrier
Ra 208,1,0
MvavC 132,216,64,68
Ra 212,2,0
v_add_f32 v40,v40,v84
Mvav 132,220,96
EX 40
MvavC 140,216,72,76
v_add_f32 v41,v41,v84
v_add_f32 v42,v42,v84
Mvav 140,220,104
EX 41
MvavC 148,216,80,84
EX 42
Mvav 148,220,112
v_add_f32 v43,v43,v84
CV 180,40,41
MvavC 156,216,88,92
s_add_u32 m0,s41,0
EX 43
Mvav 156,220,120
WL 4
Ra 216,1,128
CV 181,42,43
Mvav 132,224,128
s_mov_b32 s43,24576
Ra 220,2,128
v_add_f32 v44,v44,v92
Mvav 132,228,160
EX 44
Mvav 140,224,136
K1_p48:
s_cbranch_vccnz K1_p240
v_add_f32 v45,v45,v92
v_add_f32 v46,v46,v92
Mvav 140,228,168
EX 45
Mvav 148,224,144
buffer_load_dwordx4 v7,s[32:35],s43 offen offset:0 nt lds
Mvav 148,228,176
EX 46
Mvav 156,224,152
v_add_f32 v47,v47,v92
CV 188,44,45
Mvav 156,228,184
WL 4
Ra 224,1,256
v_add_f32 v48,v48,v68
Mvav 132,232,192
Ra 228,2,256
v_add_f32 v49,v49,v68
Mvav 132,236,224
EX 47
Mvav 140,232,200
EX 48
Mvav 140,236,232
EX 49
Mvav 148,232,208
CV 189,46,47
v_add_f32 v50,v50,v68
Mvav 148,236,240
EX 50
Mvav 156,232,216
v_add_f32 v51,v51,v68
CV 166,48,49
Mvav 156,236,248
WL 4
Ra 232,1,6144
v_add_f32 v52,v52,v76
MvavC 32,208,64,68
Ra 236,2,6144
v_add_f32 v53,v53,v76
Mvav 32,212,96
K1_p49:
s_cbranch_vccnz K1_p241
EX 51
MvavC 36,208,72,76
EX 52
Mvav 36,212,104
buffer_load_dwordx4 v8,s[32:35],s43 offen offset:1024 nt lds
MvavC 40,208,80,84
EX 53
Mvav 40,212,112
EX 132
MvavC 44,208,88,92
EX 133
Mvav 44,212,120
WL 4
Ra 208,1,6272
CV 167,50,51
Mvav 32,216,128
s_add_u32 s10,s7,49152
Ra 212,2,6272
v_add_f32 v54,v54,v76
Mvav 32,220,160
s_sub_u32 s11,s10,147456
EX 54
Mvav 36,216,136
s_min_u32 s10,s10,s11
EX 134
Mvav 36,220,168
s_sub_u32 s9,s10,s7
EX 135
Mvav 40,216,144
s_add_u32 s17,s41,s7
EX 140
Mvav 40,220,176
s_mov_b32 s7,s10
EX 141
Mvav 44,216,152
EX 142
Mvav 44,220,184
WL 4
Ra 216,1,6400
v_add_f32 v55,v55,v76
Mvav 32,224,192
K1_p50:
s_cbranch_vccnz K1_p242
Ra 220,2,6400
CV 174,52,53
Mvav 32,228,224
EX 55
Mvav 36,224,200
buffer_load_dwordx4 v9,s[32:35],s43 offen offset:2048 nt lds
Mvav 36,228,232
CV 175,54,55
v_add_f32 v56,v56,v84
Mvav 40,224,208
v_add_f32 v57,v57,v84
v_add_f32 v58,v58,v84
Mvav 40,228,240
v_add_f32 v59,v59,v84
v_add_f32 v60,v60,v92
Mvav 44,224,216
EX 56
Mvav 44,228,248
WL 4
Ra 224,1,12288
v_add_f32 v61,v61,v92
MvavC 48,232,64,68
Ra 228,2,12288
v_add_f32 v62,v62,v92
Mvav 48,236,96
EX 57
MvavC 52,232,72,76
EX 58
EX 59
Mvav 52,236,104
EX 60
CV 182,56,57
CV 183,58,59
v_add_f32 v63,v63,v92
MvavC 56,232,80,84
s_add_u32 m0,s41,3072
EX 61
EX 62
EX 63
Mvav 56,236,112
s_mov_b32 s43,27648
K1_p51:
s_cbranch_vccnz K1_p243
CV 190,60,61
CV 191,62,63
MvavC 60,232,88,92
EX 143
Mvav 60,236,120
WL 4
Ra 232,1,12416
v_add_f32 v100,v100,v68
Mvav 48,208,128
Ra 236,2,12416
v_add_f32 v101,v101,v68
Mvav 48,212,160
EX 100
Mvav 52,208,136
buffer_load_dwordx4 v7,s[32:35],s43 offen offset:0 nt lds
Mvav 52,212,168
EX 101
Mvav 56,208,144
EX 148
Mvav 56,212,176
EX 149
Mvav 60,208,152
EX 150
Mvav 60,212,184
WL 4
Ra 208,1,12544
v_add_f32 v102,v102,v68
Mvav 48,216,192
Ra 212,2,12544
v_add_f32 v103,v103,v68
Mvav 48,220,224
EX 102
Mvav 52,216,200
EX 103
Mvav 52,220,232
CV 196,100,101
CV 197,102,103
Mvav 56,216,208
K1_p52:
s_cbranch_vccnz K1_p244
v_add_f32 v108,v108,v76
v_add_f32 v109,v109,v76
Mvav 56,220,240
v_add_f32 v110,v110,v76
v_add_f32 v111,v111,v76
Mvav 60,216,216
EX 108
Mvav 60,220,248
WL 4
EX 109
MvavC 100,224,64,68
EX 110
EX 111
Mvav 100,228,96
Ra 216,1,18432
CV 204,108,109
CV 205,110,111
v_add_f32 v116,v116,v84
v_add_f32 v117,v117,v84
v_add_f32 v118,v118,v84
v_add_f32 v119,v119,v84
MvavC 108,224,72,76
EX 116
EX 117
EX 118
EX 119
Mvav 108,228,104
buffer_load_dwordx4 v8,s[32:35],s43 offen offset:1024 nt lds
CV 212,116,117
CV 213,118,119
v_add_f32 v124,v124,v92
v_add_f32 v125,v125,v92
v_add_f32 v126,v126,v92
v_add_f32 v127,v127,v92
MvavC 116,224,80,84
EX 124
EX 125
EX 126
EX 127
Mvav 116,228,112
Ra 220,2,18432
CV 220,124,125
CV 221,126,127
MvavC 124,224,88,92
K1_p53:
s_cbranch_vccnz K1_p245
EX 151
Mvav 124,228,120
WL 4
Ra 224,1,18560
CV 198,132,133
Mvav 100,232,128
Ra 228,2,18560
CV 199,134,135
Mvav 100,236,160
EX 156
Mvav 108,232,136
EX 157
Mvav 108,236,168
EX 158
Mvav 116,232,144
EX 159
Mvav 116,236,176
EX 32
Mvav 124,232,152
EX 33
Mvav 124,236,184
WL 4
Ra 232,1,18688
CV 206,140,141
Mvav 100,208,192
Ra 236,2,18688
CV 207,142,143
Mvav 100,212,224
buffer_load_dwordx4 v9,s[32:35],s43 offen offset:2048 nt lds
Mvav 108,208,200
EX 34
Mvav 108,212,232
EX 35
Mvav 116,208,208
EX 36
Mvav 116,212,240
CV 214,148,149
CV 215,150,151
K1_p54:
s_cbranch_vccnz K1_p246
Mvav 124,208,216
EX 37
Mvav 124,212,248
s_waitcnt vmcnt(18) lgkmcnt(4)
s_barrier
CV 222,156,157
MvavC 132,216,64,68
CV 223,158,159
v_add_u32 v3,s9,v3
Mvav 132,220,96
Ta 208,3,0
v_add_u32 v4,s9,v4
MvavC 140,216,72,76
s_add_u32 m0,s41,24576
Ta 210,3,6144
v_add_u32 v5,s9,v5
Mvav 140,220,104
s_mov_b32 s43,73728
Ta 212,3,12288
v_add_u32 v6,s9,v6
MvavC 148,216,80,84
Ta 214,3,18432
CV 228,32,33
Mvav 148,220,112
EX 38
MvavC 156,216,88,92
EX 39
Mvav 156,220,120
WL 6
Ta 216,4,0
CV 229,34,35
Mvav 132,224,128
Ta 218,4,6144
CV 236,36,37
Mvav 132,228,160
buffer_load_dwordx4 v7,s[28:31],s43 offen offset:0 nt lds
K1_p55:
s_cbranch_vccnz K1_p247
Mvav 140,224,136
Ta 220,4,12288
CV 237,38,39
Mvav 140,228,168
Ta 222,4,18432
Mvav 148,224,144
EX 40
Mvav 148,228,176
EX 41
Mvav 156,224,152
EX 42
Mvav 156,228,184
WL 8
Ta 224,5,0
CV 244,40,41
Mvav 132,232,192
Ta 226,5,6144
Mvav 132,236,224
Ta 228,5,12288
Mvav 140,232,200
Ta 230,5,18432
Mvav 140,236,232
EX 43
Mvav 148,232,208
EX 44
Mvav 148,236,240
EX 45
Mvav 156,232,216
EX 46
Mvav 156,236,248
Ta 232,6,0
CV 245,42,43
MaavZ 192,240,164
buffer_load_dwordx4 v8,s[28:31],s43 offen offset:1024 nt lds
Maav 192,240,196
Ta 234,6,6144
K1_p56:
s_cbranch_vccnz K1_p248
CV 252,44,45
MaavZ 196,240,172
Ta 236,6,12288
Maav 196,240,204
Ta 238,6,18432
MaavZ 200,240,180
EX 47
Maav 200,240,212
EX 48
MaavZ 204,240,188
EX 49
Maav 204,240,220
WL 12
EX 50
MaavZ 0,208,164
EX 51
Maav 0,212,196
EX 52
MaavZ 4,208,172
EX 53
Maav 4,212,204
EX 54
MaavZ 8,208,180
EX 55
Maav 8,212,212
EX 56
MaavZ 12,208,188
buffer_load_dwordx4 v9,s[28:31],s43 offen offset:2048 nt lds
Maav 12,212,220
WL 8
Ta 208,3,128
CV 253,46,47
MaavZ 16,216,164
s_add_u32 s10,s6,49152
Ta 210,3,6272
CV 230,48,49
Maav 16,220,196
K1_p57:
s_cbranch_vccnz K1_p249
s_sub_u32 s11,s10,147456
Ta 212,3,12416
CV 231,50,51
MaavZ 20,216,172
s_min_u32 s10,s10,s11
Ta 214,3,18560
CV 238,52,53
Maav 20,220,204
s_sub_u32 s8,s10,s6
EX 57
MaavZ 24,216,180
s_add_u32 s16,s41,s6
EX 58
Maav 24,220,212
s_mov_b32 s6,s10
EX 59
MaavZ 28,216,188
EX 60
Maav 28,220,220
WL 8
Ta 216,4,128
v_add_u32 v1,s8,v1
MaavZ 32,224,164
s_add_u32 m0,s41,27648
Ta 218,4,6272
v_add_u32 v2,s8,v2
Maav 32,228,196
s_mov_b32 s43,76800
Ta 220,4,12416
CV 239,54,55
MaavZ 36,224,172
Ta 222,4,18560
CV 246,56,57
Maav 36,228,204
EX 61
MaavZ 40,224,180
EX 62
Maav 40,228,212
K1_p58:
s_cbranch_vccnz K1_p250
EX 63
MaavZ 44,224,188
buffer_load_dwordx4 v7,s[28:31],s43 offen offset:0 nt lds
Maav 44,228,220
WL 8
Ta 224,5,128
CV 247,58,59
MaavZ 48,232,164
Ta 226,5,6272
CV 254,60,61
Maav 48,236,196
Ta 228,5,12416
CV 255,62,63
MaavZ 52,232,172
Ta 230,5,18560
Maav 52,236,204
EX 100
MaavZ 56,232,180
EX 101
Maav 56,236,212
EX 102
MaavZ 60,232,188
EX 103
Maav 60,236,220
WL 8
Ta 232,6,128
CV 16,100,101
MaavZ 64,208,164
Ta 234,6,6272
CV 17,102,103
Maav 64,212,196
Ta 236,6,12416
MaavZ 68,208,172
Ta 238,6,18560
Maav 68,212,204
K1_p59:
s_cbranch_vccnz K1_p251
EX 108
MaavZ 72,208,180
EX 109
Maav 72,212,212
buffer_load_dwordx4 v8,s[28:31],s43 offen offset:1024 nt lds
MaavZ 76,208,188
EX 110
Maav 76,212,220
WL 8
Ta 208,3,256
CV 20,108,109
MaavZ 80,216,164
Ta 210,3,6400
Maav 80,220,196
Ta 212,3,12544
MaavZ 84,216,172
Ta 214,3,18688
Maav 84,220,204
EX 111
MaavZ 88,216,180
EX 116
Maav 88,220,212
EX 117
MaavZ 92,216,188
EX 118
Maav 92,220,220
WL 8
Ta 216,4,256
CV 21,110,111
MaavZ 96,224,164
Ta 218,4,6400
CV 24,116,117
Maav 96,228,196
Ta 220,4,12544
MaavZ 100,224,172
Ta 222,4,18688
K1_p60:
s_cbranch_vccnz K1_p252
Maav 100,228,204
EX 119
MaavZ 104,224,180
buffer_load_dwordx4 v9,s[28:31],s43 offen offset:2048 nt lds
Maav 104,228,212
EX 124
MaavZ 108,224,188
EX 125
Maav 108,228,220
WL 8
Ta 224,5,256
CV 25,118,119
MaavZ 112,232,164
Ta 226,5,6400
CV 28,124,125
Maav 112,236,196
Ta 228,5,12544
MaavZ 116,232,172
Ta 230,5,18688
Maav 116,236,204
EX 126
MaavZ 120,232,180
EX 127
Maav 120,236,212
EX 132
MaavZ 124,232,188
s_add_u32 m0,s17,0
EX 133
Maav 124,236,220
WL 8
Ta 232,6,256
CV 29,126,127
MaavZ 128,208,164
s_add_u32 s43,s5,0
Ta 234,6,6400
CV 18,132,133
Maav 128,212,196
K1_p61:
s_cbranch_vccnz K1_p253
Ta 236,6,12544
MaavZ 132,208,172
Ta 238,6,18688
Maav 132,212,204
EX 134
MaavZ 136,208,180
buffer_load_dwordx4 v7,s[32:35],s43 offen offset:0 nt lds
Maav 136,212,212
EX 135
MaavZ 140,208,188
EX 140
Maav 140,212,220
s_waitcnt vmcnt(13) lgkmcnt(8)
s_barrier
Ra 208,1,0
MaavZ 144,216,164
Ra 212,2,0
CV 19,134,135
Maav 144,220,196
EX 141
MaavZ 148,216,172
EX 142
Maav 148,220,204
EX 143
MaavZ 152,216,180
EX 148
Maav 152,220,212
EX 149
MaavZ 156,216,188
EX 150
Maav 156,220,220
WL 6
Ra 216,1,128
CV 22,140,141
MaavZ 160,224,164
Ra 220,2,128
CV 23,142,143
Maav 160,228,196
K1_p62:
s_cbranch_vccnz K1_p254
EX 151
MaavZ 164,224,172
buffer_load_dwordx4 v8,s[32:35],s43 offen offset:1024 nt lds
Maav 164,228,204
EX 156
MaavZ 168,224,180
EX 157
Maav 168,228,212
EX 158
MaavZ 172,224,188
EX 159
Maav 172,228,220
WL 4
Ra 224,1,256
CV 26,148,149
MaavZ 176,232,164
Ra 228,2,256
CV 27,150,151
Maav 176,236,196
CV 30,156,157
CV 31,158,159
MaavZ 180,232,172
Maav 180,236,204
MaavZ 184,232,180
Maav 184,236,212
MaavZ 188,232,188
Maav 188,236,220
WL 4
Ra 232,1,6144
s_mov_b32 s3,0
K1q4_L1:
MvavC 32,208,64,68
Ra 236,2,6144
Mvav 32,212,96
buffer_load_dwordx4 v9,s[32:35],s43 offen offset:2048 nt lds
MvavC 36,208,72,76
K1_p63:
s_cbranch_vccnz K1_p255
Mvav 36,212,104
MvavC 40,208,80,84
Mvav 40,212,112
MvavC 44,208,88,92
Mvav 44,212,120
WL 4
Ra 208,1,6272
Mvav 32,216,128
s_add_u32 s10,s7,49152
Ra 212,2,6272
s_sub_u32 s11,s10,147456
Mvav 32,220,160
s_min_u32 s10,s10,s11
s_sub_u32 s9,s10,s7
Mvav 36,216,136
s_add_u32 m0,s17,3072
v_add_u32 v3,s9,v3
v_add_u32 v4,s9,v4
Mvav 36,220,168
s_add_u32 s43,s5,3072
v_add_u32 v5,s9,v5
v_add_u32 v6,s9,v6
Mvav 40,216,144
s_add_u32 s5,s5,24576
s_add_u32 s17,s41,s7
s_mov_b32 s7,s10
Mvav 40,220,176
Mvav 44,216,152
Mvav 44,220,184
WL 4
Ra 216,1,6400
Mvav 32,224,192
Ra 220,2,6400
Mvav 32,228,224
buffer_load_dwordx4 v7,s[32:35],s43 offen offset:0 nt lds
Mvav 36,224,200
Mvav 36,228,232
K1_p64:
s_cbranch_vccnz K1_tr
Mvav 40,224,208
Mvav 40,228,240
Mvav 44,224,216
Mvav 44,228,248
WL 4
Ra 224,1,12288
MvavC 48,232,64,68
Ra 228,2,12288
Mvav 48,236,96
EX 32
MvavC 52,232,72,76
EX 33
Mvav 52,236,104
EX 34
MvavC 56,232,80,84
EX 35
Mvav 56,236,112
EX 36
MvavC 60,232,88,92
buffer_load_dwordx4 v8,s[32:35],s43 offen offset:1024 nt lds
Mvav 60,236,120
WL 4
Ra 232,1,12416
CV 164,32,33
Mvav 48,208,128
Ra 236,2,12416
CV 165,34,35
Mvav 48,212,160
EX 37
Mvav 52,208,136
EX 38
Mvav 52,212,168
EX 39
Mvav 56,208,144
EX 40
Mvav 56,212,176
EX 41
K1_p65:
s_cbranch_vccnz K1_tr
Mvav 60,208,152
EX 42
Mvav 60,212,184
WL 4
Ra 208,1,12544
CV 172,36,37
Mvav 48,216,192
Ra 212,2,12544
CV 173,38,39
Mvav 48,220,224
EX 43
Mvav 52,216,200
EX 44
Mvav 52,220,232
EX 45
Mvav 56,216,208
EX 46
Mvav 56,220,240
buffer_load_dwordx4 v9,s[32:35],s43 offen offset:2048 nt lds
Mvav 60,216,216
EX 47
Mvav 60,220,248
WL 4
Ra 216,1,18432
CV 180,40,41
MvavC 100,224,64,68
Ra 220,2,18432
CV 181,42,43
Mvav 100,228,96
EX 48
MvavC 108,224,72,76
EX 49
Mvav 108,228,104
EX 50
MvavC 116,224,80,84
EX 51
Mvav 116,228,112
EX 52
K1_p66:
s_cbranch_vccnz K1_tr
MvavC 124,224,88,92
EX 53
Mvav 124,228,120
WL 4
Ra 224,1,18560
CV 188,44,45
Mvav 100,232,128
Ra 228,2,18560
CV 189,46,47
Mvav 100,236,160
EX 54
Mvav 108,232,136
EX 55
Mvav 108,236,168
EX 56
Mvav 116,232,144
EX 57
Mvav 116,236,176
EX 58
Mvav 124,232,152
EX 59
Mvav 124,236,184
WL 4
Ra 232,1,18688
CV 166,48,49
Mvav 100,208,192
Ra 236,2,18688
CV 167,50,51
Mvav 100,212,224
EX 60
Mvav 108,208,200
EX 61
Mvav 108,212,232
EX 62
Mvav 116,208,208
EX 63
Mvav 116,212,240
CV 174,52,53
K1_p67:
s_cbranch_vccnz K1_tr
CV 175,54,55
Mvav 124,208,216
s_add_u32 m0,s16,0
CV 182,56,57
CV 183,58,59
Mvav 124,212,248
s_waitcnt vmcnt(12) lgkmcnt(4)
s_barrier
Ta 208,3,0
MvavC 132,216,64,68
s_add_u32 s43,s4,0
Ta 210,3,6144
CV 190,60,61
Mvav 132,220,96
Ta 212,3,12288
CV 191,62,63
MvavC 140,216,72,76
Ta 214,3,18432
Mvav 140,220,104
EX 100
MvavC 148,216,80,84
buffer_load_dwordx4 v7,s[28:31],s43 offen offset:0 nt lds
Mvav 148,220,112
EX 101
MvavC 156,216,88,92
EX 102
Mvav 156,220,120
WL 6
Ta 216,4,0
CV 196,100,101
Mvav 132,224,128
Ta 218,4,6144
Mvav 132,228,160
Ta 220,4,12288
Mvav 140,224,136
Ta 222,4,18432
K1_p68:
s_cbranch_vccnz K1_tr
Mvav 140,228,168
EX 103
Mvav 148,224,144
EX 108
Mvav 148,228,176
EX 109
Mvav 156,224,152
EX 110
Mvav 156,228,184
WL 8
Ta 224,5,0
CV 197,102,103
Mvav 132,232,192
Ta 226,5,6144
CV 204,108,109
Mvav 132,236,224
Ta 228,5,12288
Mvav 140,232,200
Ta 230,5,18432
Mvav 140,236,232
buffer_load_dwordx4 v8,s[28:31],s43 offen offset:1024 nt lds
Mvav 148,232,208
EX 111
Mvav 148,236,240
EX 116
Mvav 156,232,216
EX 117
Mvav 156,236,248
Ta 232,6,0
CV 205,110,111
Maav 192,240,228
Ta 234,6,6144
CV 212,116,117
Maav 192,240,16
Ta 236,6,12288
K1_p69:
s_cbranch_vccnz K1_tr
Maav 196,240,236
Ta 238,6,18432
Maav 196,240,20
EX 118
Maav 200,240,244
EX 119
Maav 200,240,24
EX 124
Maav 204,240,252
EX 125
Maav 204,240,28
WL 12
EX 126
Maav 0,208,228
EX 127
Maav 0,212,16
buffer_load_dwordx4 v9,s[28:31],s43 offen offset:2048 nt lds
Maav 4,208,236
EX 132
Maav 4,212,20
EX 133
Maav 8,208,244
EX 134
Maav 8,212,24
EX 135
Maav 12,208,252
EX 140
Maav 12,212,28
WL 8
Ta 208,3,128
CV 213,118,119
Maav 16,216,228
s_add_u32 s10,s6,49152
Ta 210,3,6272
CV 220,124,125
Maav 16,220,16
s_sub_u32 s11,s10,147456
Ta 212,3,12416
K1_p70:
s_cbranch_vccnz K1_tr
CV 221,126,127
Maav 20,216,236
s_add_u32 m0,s16,3072
Ta 214,3,18560
CV 198,132,133
Maav 20,220,20
s_add_u32 s43,s4,3072
EX 141
Maav 24,216,244
s_min_u32 s10,s10,s11
EX 142
Maav 24,220,24
s_sub_u32 s8,s10,s6
EX 143
Maav 28,216,252
s_add_u32 s4,s4,24576
EX 148
Maav 28,220,28
WL 8
Ta 216,4,128
v_add_u32 v1,s8,v1
Maav 32,224,228
s_add_u32 s16,s41,s6
Ta 218,4,6272
v_add_u32 v2,s8,v2
Maav 32,228,16
s_mov_b32 s6,s10
buffer_load_dwordx4 v7,s[28:31],s43 offen offset:0 nt lds
Maav 36,224,236
Ta 220,4,12416
CV 199,134,135
Maav 36,228,20
Ta 222,4,18560
CV 206,140,141
Maav 40,224,244
EX 149
Maav 40,228,24
EX 150
K1_p71:
s_cbranch_vccnz K1_tr
Maav 44,224,252
EX 151
Maav 44,228,28
WL 8
Ta 224,5,128
CV 207,142,143
Maav 48,232,228
Ta 226,5,6272
CV 214,148,149
Maav 48,236,16
Ta 228,5,12416
CV 215,150,151
Maav 52,232,236
Ta 230,5,18560
Maav 52,236,20
EX 156
Maav 56,232,244
EX 157
Maav 56,236,24
EX 158
Maav 60,232,252
buffer_load_dwordx4 v8,s[28:31],s43 offen offset:1024 nt lds
Maav 60,236,28
WL 8
Ta 232,6,128
CV 222,156,157
Maav 64,208,228
Ta 234,6,6272
Maav 64,212,16
Ta 236,6,12416
Maav 68,208,236
Ta 238,6,18560
Maav 68,212,20
EX 159
Maav 72,208,244
K1_p72:
s_cbranch_vccnz K1_tr
CV 223,158,159
Maav 72,212,24
Maav 76,208,252
Maav 76,212,28
WL 8
Ta 208,3,256
Maav 80,216,228
Ta 210,3,6400
Maav 80,220,16
Ta 212,3,12544
Maav 84,216,236
Ta 214,3,18688
Maav 84,220,20
Maav 88,216,244
Maav 88,220,24
buffer_load_dwordx4 v9,s[28:31],s43 offen offset:2048 nt lds
Maav 92,216,252
Maav 92,220,28
WL 8
Ta 216,4,256
Maav 96,224,228
Ta 218,4,6400
Maav 96,228,16
Ta 220,4,12544
Maav 100,224,236
Ta 222,4,18688
Maav 100,228,20
Maav 104,224,244
Maav 104,228,24
Maav 108,224,252
Maav 108,228,28
WL 8
Ta 224,5,256
K1_p73:
s_cbranch_vccnz K1_tr
Maav 112,232,228
Ta 226,5,6400
Maav 112,236,16
Ta 228,5,12544
Maav 116,232,236
Ta 230,5,18688
Maav 116,236,20
Maav 120,232,244
Maav 120,236,24
Maav 124,232,252
s_add_u32 m0,s17,0
s_add_u32 s43,s5,0
Maav 124,236,28
WL 8
Ta 232,6,256
Maav 128,208,228
Ta 234,6,6400
Maav 128,212,16
Ta 236,6,12544
Maav 132,208,236
Ta 238,6,18688
Maav 132,212,20
Maav 136,208,244
buffer_load_dwordx4 v7,s[32:35],s43 offen offset:0 nt lds
Maav 136,212,24
Maav 140,208,252
Maav 140,212,28
s_waitcnt vmcnt(13) lgkmcnt(8)
s_barrier
Ra 208,1,0
Maav 144,216,228
Ra 212,2,0
Maav 144,220,16
Maav 148,216,236
K1_p74:
s_cbranch_vccnz K1_tr
Maav 148,220,20
Maav 152,216,244
Maav 152,220,24
Maav 156,216,252
Maav 156,220,28
WL 6
Ra 216,1,128
Maav 160,224,228
Ra 220,2,128
Maav 160,228,16
Maav 164,224,236
buffer_load_dwordx4 v8,s[32:35],s43 offen offset:1024 nt lds
Maav 164,228,20
Maav 168,224,244
Maav 168,228,24
Maav 172,224,252
Maav 172,228,28
WL 4
Ra 224,1,256
Maav 176,232,228
Ra 228,2,256
Maav 176,236,16
Maav 180,232,236
Maav 180,236,20
Maav 184,232,244
Maav 184,236,24
Maav 188,232,252
Maav 188,236,28
WL 4
Ra 232,1,6144
MvavC 32,208,64,68
Ra 236,2,6144
Mvav 32,212,96
K1_p75:
s_cbranch_vccnz K1_tr
buffer_load_dwordx4 v9,s[32:35],s43 offen offset:2048 nt lds
MvavC 36,208,72,76
Mvav 36,212,104
MvavC 40,208,80,84
Mvav 40,212,112
MvavC 44,208,88,92
Mvav 44,212,120
WL 4
Ra 208,1,6272
Mvav 32,216,128
s_add_u32 s10,s7,49152
Ra 212,2,6272
s_sub_u32 s11,s10,147456
Mvav 32,220,160
s_min_u32 s10,s10,s11
s_sub_u32 s9,s10,s7
Mvav 36,216,136
s_add_u32 m0,s17,3072
v_add_u32 v3,s9,v3
v_add_u32 v4,s9,v4
Mvav 36,220,168
s_add_u32 s43,s5,3072
v_add_u32 v5,s9,v5
v_add_u32 v6,s9,v6
Mvav 40,216,144
s_add_u32 s5,s5,24576
s_add_u32 s17,s41,s7
s_mov_b32 s7,s10
Mvav 40,220,176
Mvav 44,216,152
Mvav 44,220,184
WL 4
Ra 216,1,6400
Mvav 32,224,192
Ra 220,2,6400
Mvav 32,228,224
buffer_load_dwordx4 v7,s[32:35],s43 offen offset:0 nt lds
K1_p76:
s_cbranch_vccnz K1_tr
Mvav 36,224,200
Mvav 36,228,232
Mvav 40,224,208
Mvav 40,228,240
Mvav 44,224,216
Mvav 44,228,248
WL 4
Ra 224,1,12288
MvavC 48,232,64,68
Ra 228,2,12288
Mvav 48,236,96
EX 32
MvavC 52,232,72,76
EX 33
Mvav 52,236,104
EX 34
MvavC 56,232,80,84
EX 35
Mvav 56,236,112
EX 36
MvavC 60,232,88,92
buffer_load_dwordx4 v8,s[32:35],s43 offen offset:1024 nt lds
Mvav 60,236,120
WL 4
Ra 232,1,12416
CV 228,32,33
Mvav 48,208,128
Ra 236,2,12416
CV 229,34,35
Mvav 48,212,160
EX 37
Mvav 52,208,136
EX 38
Mvav 52,212,168
EX 39
Mvav 56,208,144
K1_p77:
s_cbranch_vccnz K1_tr
EX 40
Mvav 56,212,176
EX 41
Mvav 60,208,152
EX 42
Mvav 60,212,184
WL 4
Ra 208,1,12544
CV 236,36,37
Mvav 48,216,192
Ra 212,2,12544
CV 237,38,39
Mvav 48,220,224
EX 43
Mvav 52,216,200
EX 44
Mvav 52,220,232
EX 45
Mvav 56,216,208
EX 46
Mvav 56,220,240
buffer_load_dwordx4 v9,s[32:35],s43 offen offset:2048 nt lds
Mvav 60,216,216
EX 47
Mvav 60,220,248
WL 4
Ra 216,1,18432
CV 244,40,41
MvavC 100,224,64,68
Ra 220,2,18432
CV 245,42,43
Mvav 100,228,96
EX 48
MvavC 108,224,72,76
EX 49
Mvav 108,228,104
EX 50
MvavC 116,224,80,84
K1_p78:
s_cbranch_vccnz K1_tr
EX 51
Mvav 116,228,112
EX 52
MvavC 124,224,88,92
EX 53
Mvav 124,228,120
WL 4
Ra 224,1,18560
CV 252,44,45
Mvav 100,232,128
Ra 228,2,18560
CV 253,46,47
Mvav 100,236,160
EX 54
Mvav 108,232,136
EX 55
Mvav 108,236,168
EX 56
Mvav 116,232,144
EX 57
Mvav 116,236,176
EX 58
Mvav 124,232,152
EX 59
Mvav 124,236,184
WL 4
Ra 232,1,18688
CV 230,48,49
Mvav 100,208,192
Ra 236,2,18688
CV 231,50,51
Mvav 100,212,224
EX 60
Mvav 108,208,200
EX 61
Mvav 108,212,232
EX 62
Mvav 116,208,208
EX 63
K1_p79:
s_cbranch_vccnz K1_tr
Mvav 116,212,240
CV 238,52,53
CV 239,54,55
Mvav 124,208,216
s_add_u32 m0,s16,0
CV 246,56,57
CV 247,58,59
Mvav 124,212,248
s_waitcnt vmcnt(12) lgkmcnt(4)
s_barrier
Ta 208,3,0
MvavC 132,216,64,68
s_add_u32 s43,s4,0
Ta 210,3,6144
CV 254,60,61
Mvav 132,220,96
Ta 212,3,12288
CV 255,62,63
MvavC 140,216,72,76
Ta 214,3,18432
Mvav 140,220,104
EX 100
MvavC 148,216,80,84
buffer_load_dwordx4 v7,s[28:31],s43 offen offset:0 nt lds
Mvav 148,220,112
EX 101
MvavC 156,216,88,92
EX 102
Mvav 156,220,120
WL 6
Ta 216,4,0
CV 16,100,101
Mvav 132,224,128
Ta 218,4,6144
Mvav 132,228,160
Ta 220,4,12288
K1_p80:
s_cbranch_vccnz K1_p272
Mvav 140,224,136
Ta 222,4,18432
Mvav 140,228,168
EX 103
Mvav 148,224,144
EX 108
Mvav 148,228,176
EX 109
Mvav 156,224,152
EX 110
Mvav 156,228,184
WL 8
Ta 224,5,0
CV 17,102,103
Mvav 132,232,192
Ta 226,5,6144
CV 20,108,109
Mvav 132,236,224
Ta 228,5,12288
Mvav 140,232,200
Ta 230,5,18432
Mvav 140,236,232
buffer_load_dwordx4 v8,s[28:31],s43 offen offset:1024 nt lds
Mvav 148,232,208
EX 111
Mvav 148,236,240
EX 116
Mvav 156,232,216
EX 117
Mvav 156,236,248
Ta 232,6,0
CV 21,110,111
s_cmp_eq_u32 s3,6
s_cbranch_scc1 K1q4_L1_x
s_add_u32 s3,s3,1
Maav 192,240,164
Ta 234,6,6144
K1_p81:
s_cbranch_vccnz K1_p273
CV 24,116,117
Maav 192,240,196
Ta 236,6,12288
Maav 196,240,172
Ta 238,6,18432
Maav 196,240,204
EX 118
Maav 200,240,180
EX 119
Maav 200,240,212
EX 124
Maav 204,240,188
EX 125
Maav 204,240,220
WL 12
EX 126
Maav 0,208,164
EX 127
Maav 0,212,196
buffer_load_dwordx4 v9,s[28:31],s43 offen offset:2048 nt lds
Maav 4,208,172
EX 132
Maav 4,212,204
EX 133
Maav 8,208,180
EX 134
Maav 8,212,212
EX 135
Maav 12,208,188
EX 140
Maav 12,212,220
WL 8
Ta 208,3,128
CV 25,118,119
Maav 16,216,164
s_add_u32 s10,s6,49152
Ta 210,3,6272
CV 28,124,125
K1_p82:
s_cbranch_vccnz K1_tr
Maav 16,220,196
s_sub_u32 s11,s10,147456
Ta 212,3,12416
CV 29,126,127
Maav 20,216,172
s_add_u32 m0,s16,3072
Ta 214,3,18560
CV 18,132,133
Maav 20,220,204
s_add_u32 s43,s4,3072
EX 141
Maav 24,216,180
s_min_u32 s10,s10,s11
EX 142
Maav 24,220,212
s_sub_u32 s8,s10,s6
EX 143
Maav 28,216,188
s_add_u32 s4,s4,24576
EX 148
Maav 28,220,220
WL 8
Ta 216,4,128
v_add_u32 v1,s8,v1
Maav 32,224,164
s_add_u32 s16,s41,s6
Ta 218,4,6272
v_add_u32 v2,s8,v2
Maav 32,228,196
s_mov_b32 s6,s10
buffer_load_dwordx4 v7,s[28:31],s43 offen offset:0 nt lds
Maav 36,224,172
Ta 220,4,12416
CV 19,134,135
Maav 36,228,204
Ta 222,4,18560
CV 22,140,141
K1_p83:
s_cbranch_vccnz K1_tr
Maav 40,224,180
EX 149
Maav 40,228,212
EX 150
Maav 44,224,188
EX 151
Maav 44,228,220
WL 8
Ta 224,5,128
CV 23,142,143
Maav 48,232,164
Ta 226,5,6272
CV 26,148,149
Maav 48,236,196
Ta 228,5,12416
CV 27,150,151
Maav 52,232,172
Ta 230,5,18560
Maav 52,236,204
EX 156
Maav 56,232,180
EX 157
Maav 56,236,212
EX 158
Maav 60,232,188
buffer_load_dwordx4 v8,s[28:31],s43 offen offset:1024 nt lds
Maav 60,236,220
WL 8
Ta 232,6,128
CV 30,156,157
Maav 64,208,164
Ta 234,6,6272
Maav 64,212,196
Ta 236,6,12416
Maav 68,208,172
K1_p84:
s_cbranch_vccnz K1_tr
Ta 238,6,18560
Maav 68,212,204
EX 159
Maav 72,208,180
CV 31,158,159
Maav 72,212,212
Maav 76,208,188
Maav 76,212,220
WL 8
Ta 208,3,256
Maav 80,216,164
Ta 210,3,6400
Maav 80,220,196
Ta 212,3,12544
Maav 84,216,172
Ta 214,3,18688
Maav 84,220,204
Maav 88,216,180
Maav 88,220,212
buffer_load_dwordx4 v9,s[28:31],s43 offen offset:2048 nt lds
Maav 92,216,188
Maav 92,220,220
WL 8
Ta 216,4,256
Maav 96,224,164
Ta 218,4,6400
Maav 96,228,196
Ta 220,4,12544
Maav 100,224,172
Ta 222,4,18688
Maav 100,228,204
Maav 104,224,180
Maav 104,228,212
K1_p85:
s_cbranch_vccnz K1_tr
Maav 108,224,188
Maav 108,228,220
WL 8
Ta 224,5,256
Maav 112,232,164
Ta 226,5,6400
Maav 112,236,196
Ta 228,5,12544
Maav 116,232,172
Ta 230,5,18688
Maav 116,236,204
Maav 120,232,180
Maav 120,236,212
Maav 124,232,188
s_add_u32 m0,s17,0
s_add_u32 s43,s5,0
Maav 124,236,220
WL 8
Ta 232,6,256
Maav 128,208,164
Ta 234,6,6400
Maav 128,212,196
Ta 236,6,12544
Maav 132,208,172
Ta 238,6,18688
Maav 132,212,204
Maav 136,208,180
buffer_load_dwordx4 v7,s[32:35],s43 offen offset:0 nt lds
Maav 136,212,212
Maav 140,208,188
Maav 140,212,220
s_waitcnt vmcnt(13) lgkmcnt(8)
s_barrier
Ra 208,1,0
Maav 144,216,164
K1_p86:
s_cbranch_vccnz K1_tr
Ra 212,2,0
Maav 144,220,196
Maav 148,216,172
Maav 148,220,204
Maav 152,216,180
Maav 152,220,212
Maav 156,216,188
Maav 156,220,220
WL 6
Ra 216,1,128
Maav 160,224,164
Ra 220,2,128
Maav 160,228,196
Maav 164,224,172
buffer_load_dwordx4 v8,s[32:35],s43 offen offset:1024 nt lds
Maav 164,228,204
Maav 168,224,180
Maav 168,228,212
Maav 172,224,188
Maav 172,228,220
WL 4
Ra 224,1,256
Maav 176,232,164
Ra 228,2,256
Maav 176,236,196
Maav 180,232,172
Maav 180,236,204
Maav 184,232,180
Maav 184,236,212
Maav 188,232,188
Maav 188,236,220
WL 4
Ra 232,1,6144
K1_p87:
s_cbranch_vccnz K1_tr
s_branch K1q4_L1
K1q4_L1_x:
Maav 192,240,164
s_add_u32 m0,s41,73728
Ta 234,6,6144
CV 24,116,117
Maav 192,240,196
s_mov_b32 s43,s14
Ta 236,6,12288
s_add_u32 s10,s14,40960
Maav 196,240,172
s_sub_u32 s11,s10,1966080
Ta 238,6,18432
s_min_u32 s14,s10,s11
Maav 196,240,204
s_mov_b32 s100,0x4e800000
buffer_load_dwordx4 v14,s[48:51],s43 offen offset:0 lds
Maav 200,240,180
s_add_u32 s10,s14,40960
EX 132
Maav 200,240,212
s_sub_u32 s11,s10,1966080
EX 133
Maav 204,240,188
s_add_u32 s17,s41,s7
buffer_load_dwordx4 v15,s[48:51],s43 offen offset:1024 lds
Maav 204,240,220
WL 12
EX 134
Maav 0,208,164
s_add_u32 m0,s41,75776
EX 135
Maav 0,212,196
s_mov_b32 s43,s14
EX 140
Maav 4,208,172
s_min_u32 s14,s10,s11
buffer_load_dwordx4 v14,s[48:51],s43 offen offset:0 lds
K1_p88:
s_cbranch_vccnz K1_tr
Maav 4,212,204
EX 141
Maav 8,208,180
s_add_u32 s10,s14,40960
EX 142
Maav 8,212,212
s_sub_u32 s11,s10,1966080
EX 143
Maav 12,208,188
buffer_load_dwordx4 v15,s[48:51],s43 offen offset:1024 lds
Maav 12,212,220
WL 8
Ta 208,3,128
CV 18,132,133
Maav 16,216,164
s_add_u32 m0,s41,77824
Ta 210,3,6272
CV 19,134,135
Maav 16,220,196
s_mov_b32 s43,s14
Ta 212,3,12416
CV 22,140,141
Maav 20,216,172
s_min_u32 s14,s10,s11
Ta 214,3,18560
CV 23,142,143
Maav 20,220,204
buffer_load_dwordx4 v14,s[48:51],s43 offen offset:0 lds
Maav 24,216,180
s_add_u32 s10,s14,40960
EX 118
Maav 24,220,212
s_sub_u32 s11,s10,1966080
EX 119
Maav 28,216,188
buffer_load_dwordx4 v15,s[48:51],s43 offen offset:1024 lds
K1_p89:
s_cbranch_vccnz K1_tr
Maav 28,220,220
WL 8
Ta 216,4,128
CV 25,118,119
Maav 32,224,164
s_add_u32 m0,s41,122880
Ta 218,4,6272
s_mov_b32 s43,s14
Maav 32,228,196
s_min_u32 s14,s10,s11
Ta 220,4,12416
Maav 36,224,172
Ta 222,4,18560
Maav 36,228,204
buffer_load_dwordx4 v14,s[48:51],s43 offen offset:0 lds
Maav 40,224,180
s_add_u32 s10,s14,40960
EX 148
Maav 40,228,212
s_sub_u32 s11,s10,1966080
EX 149
Maav 44,224,188
buffer_load_dwordx4 v15,s[48:51],s43 offen offset:1024 lds
Maav 44,228,220
WL 8
Ta 224,5,128
CV 26,148,149
Maav 48,232,164
s_add_u32 m0,s41,124928
Ta 226,5,6272
s_mov_b32 s43,s14
Maav 48,236,196
s_min_u32 s14,s10,s11
Ta 228,5,12416
Maav 52,232,172
K1_p90:
s_cbranch_vccnz K1_tr
Ta 230,5,18560
Maav 52,236,204
buffer_load_dwordx4 v14,s[48:51],s43 offen offset:0 lds
Maav 56,232,180
s_add_u32 s10,s14,40960
EX 150
Maav 56,236,212
s_sub_u32 s11,s10,1966080
EX 151
Maav 60,232,188
buffer_load_dwordx4 v15,s[48:51],s43 offen offset:1024 lds
Maav 60,236,220
WL 8
Ta 232,6,128
CV 27,150,151
Maav 64,208,164
s_add_u32 m0,s41,126976
Ta 234,6,6272
s_mov_b32 s43,s14
Maav 64,212,196
s_min_u32 s14,s10,s11
Ta 236,6,12416
Maav 68,208,172
Ta 238,6,18560
Maav 68,212,204
buffer_load_dwordx4 v14,s[48:51],s43 offen offset:0 lds
Maav 72,208,180
s_add_u32 s10,s14,40960
EX 124
Maav 72,212,212
s_sub_u32 s11,s10,1966080
EX 125
Maav 76,208,188
buffer_load_dwordx4 v15,s[48:51],s43 offen offset:1024 lds
Maav 76,212,220
K1_p91:
s_cbranch_vccnz K1_tr
WL 8
Ta 208,3,256
CV 28,124,125
Maav 80,216,164
s_add_u32 m0,s41,0
Ta 210,3,6400
s_mov_b32 s43,s14
Maav 80,220,196
s_min_u32 s14,s10,s11
Ta 212,3,12544
Maav 84,216,172
Ta 214,3,18688
Maav 84,220,204
buffer_load_dwordx4 v14,s[48:51],s43 offen offset:0 lds
Maav 88,216,180
s_add_u32 s10,s14,40960
EX 126
Maav 88,220,212
s_sub_u32 s11,s10,1966080
EX 127
Maav 92,216,188
buffer_load_dwordx4 v15,s[48:51],s43 offen offset:1024 lds
Maav 92,220,220
WL 8
Ta 216,4,256
CV 29,126,127
Maav 96,224,164
s_add_u32 m0,s41,2048
Ta 218,4,6400
s_mov_b32 s43,s14
Maav 96,228,196
s_min_u32 s14,s10,s11
Ta 220,4,12544
Maav 100,224,172
Ta 222,4,18688
Maav 100,228,204
K1_p92:
s_cbranch_vccnz K1_tr
buffer_load_dwordx4 v14,s[48:51],s43 offen offset:0 lds
Maav 104,224,180
s_add_u32 s10,s14,40960
EX 156
Maav 104,228,212
s_sub_u32 s11,s10,1966080
EX 157
Maav 108,224,188
buffer_load_dwordx4 v15,s[48:51],s43 offen offset:1024 lds
Maav 108,228,220
WL 8
Ta 224,5,256
CV 30,156,157
Maav 112,232,164
s_add_u32 m0,s41,4096
Ta 226,5,6400
s_mov_b32 s43,s14
Maav 112,236,196
s_min_u32 s14,s10,s11
Ta 228,5,12544
Maav 116,232,172
Ta 230,5,18688
Maav 116,236,204
buffer_load_dwordx4 v14,s[48:51],s43 offen offset:0 lds
Maav 120,232,180
EX 158
Maav 120,236,212
EX 159
Maav 124,232,188
buffer_load_dwordx4 v15,s[48:51],s43 offen offset:1024 lds
Maav 124,236,220
WL 8
Ta 232,6,256
CV 31,158,159
Maav 128,208,164
Ta 234,6,6400
K1_p93:
s_cbranch_vccnz K1_tr
Maav 128,212,196
Ta 236,6,12544
Maav 132,208,172
Ta 238,6,18688
Maav 132,212,204
Maav 136,208,180
s_add_u32 m0,s41,24576
s_mov_b32 s43,s14
s_add_u32 s10,s14,40960
Maav 136,212,212
s_sub_u32 s11,s10,1966080
s_min_u32 s14,s10,s11
Maav 140,208,188
Maav 140,212,220
s_waitcnt vmcnt(20) lgkmcnt(8)
s_barrier
Maav 144,216,164
Maav 144,220,196
Maav 148,216,172
buffer_load_dwordx4 v14,s[48:51],s43 offen offset:0 lds
Maav 148,220,204
Maav 152,216,180
s_add_u32 s10,s14,40960
s_sub_u32 s11,s10,1966080
Maav 152,220,212
Maav 156,216,188
buffer_load_dwordx4 v15,s[48:51],s43 offen offset:1024 lds
Maav 156,220,220
WL 4
s_add_u32 m0,s41,26624
s_mov_b32 s43,s14
s_min_u32 s14,s10,s11
Maav 160,224,164
Maav 160,228,196
Maav 164,224,172
K1_p94:
s_cbranch_vccnz K1_tr
buffer_load_dwordx4 v14,s[48:51],s43 offen offset:0 lds
Maav 164,228,204
Maav 168,224,180
s_add_u32 s10,s14,40960
s_sub_u32 s11,s10,1966080
Maav 168,228,212
Maav 172,224,188
buffer_load_dwordx4 v15,s[48:51],s43 offen offset:1024 lds
Maav 172,228,220
WL 0
s_mov_b32 s43,s14
s_min_u32 s14,s10,s11
s_add_u32 s10,s7,49152
s_sub_u32 s11,s10,147456
s_min_u32 s10,s10,s11
s_sub_u32 s9,s10,s7
Maav 176,232,164
s_add_u32 m0,s41,28672
v_add_u32 v3,s9,v3
v_add_u32 v4,s9,v4
Maav 176,236,196
s_mov_b32 s7,s10
Ta 208,3,0
v_add_u32 v5,s9,v5
Ta 210,3,6144
Ta 212,3,12288
Ta 214,3,18432
Ta 216,4,0
Ta 218,4,6144
Ta 220,4,12288
Ta 222,4,18432
Maav 180,232,172
Ta 224,5,0
v_add_u32 v6,s9,v6
Maav 180,236,204
buffer_load_dwordx4 v14,s[48:51],s43 offen offset:0 lds
K1_p95:
s_cbranch_vccnz K1_tr
Maav 184,232,180
Ta 226,5,6144
Maav 184,236,212
Ta 228,5,12288
Maav 188,232,188
Ta 230,5,18432
Maav 188,236,220
buffer_load_dwordx4 v15,s[48:51],s43 offen offset:1024 lds
Maav 192,240,228
Ta 232,6,0
Maav 192,240,16
Ta 234,6,6144
Maav 196,240,236
Ta 236,6,12288
Maav 196,240,20
Ta 238,6,18432
Maav 200,240,244
Maav 200,240,24
s_nop 0
v_accvgpr_read_b32 v68,a192
Maav 204,240,252
Maav 204,240,28
WL 12
v_accvgpr_read_b32 v69,a196
v_add_f32 v11,v68,v69
Maav 0,208,228
v_rcp_f32 v68,v68
Maav 0,212,16
v_rcp_f32 v69,v69
Maav 4,208,236
v_accvgpr_read_b32 v70,a200
v_add_f32 v11,v11,v70
Maav 4,212,20
v_rcp_f32 v70,v70
Maav 8,208,244
K1_p96:
s_cbranch_vccnz K1_tr
v_accvgpr_read_b32 v71,a204
v_add_f32 v11,v11,v71
Maav 8,212,24
v_rcp_f32 v71,v71
Maav 12,208,252
v_cmp_nge_f32 s[100:101],s100,v11
v_accvgpr_read_b32 v100,a0
Maav 12,212,28
WL 8
Ta 208,3,128
v_accvgpr_read_b32 v101,a1
Maav 16,216,228
s_or_b32 s100,s100,s101
Ta 210,3,6272
v_accvgpr_read_b32 v102,a2
v_accvgpr_read_b32 v103,a3
v_mul_f32 v100,v100,v68
v_mul_f32 v101,v101,v68
Maav 16,220,16
Ta 212,3,12416
v_mov_b32 v11,s100
v_mul_f32 v102,v102,v68
v_mul_f32 v103,v103,v68
CV 100,100,101
Maav 20,216,236
Ta 214,3,18560
CV 101,102,103
v_accvgpr_read_b32 v108,a4
v_accvgpr_read_b32 v109,a5
v_accvgpr_read_b32 v110,a6
Maav 20,220,20
ds_write_b32 v12,v11
v_accvgpr_read_b32 v111,a7
v_mul_f32 v108,v108,v69
v_mul_f32 v109,v109,v69
v_mul_f32 v110,v110,v69
Maav 24,216,244
v_mul_f32 v111,v111,v69
K1_p97:
s_cbranch_vccnz K1_tr
CV 108,108,109
CV 109,110,111
v_accvgpr_read_b32 v116,a8
v_accvgpr_read_b32 v117,a9
Maav 24,220,24
v_accvgpr_read_b32 v118,a10
v_accvgpr_read_b32 v119,a11
v_mul_f32 v116,v116,v70
v_mul_f32 v117,v117,v70
v_mul_f32 v118,v118,v70
Maav 28,216,252
v_mul_f32 v119,v119,v70
CV 116,116,117
CV 117,118,119
v_accvgpr_read_b32 v124,a12
v_accvgpr_read_b32 v125,a13
Maav 28,220,28
WL 9
Ta 216,4,128
v_accvgpr_read_b32 v126,a14
v_accvgpr_read_b32 v127,a15
v_mul_f32 v124,v124,v71
v_mul_f32 v125,v125,v71
Maav 32,224,228
Ta 218,4,6272
v_mul_f32 v126,v126,v71
v_mul_f32 v127,v127,v71
CV 124,124,125
CV 125,126,127
Maav 32,228,16
Ta 220,4,12416
v_accvgpr_read_b32 v132,a16
v_accvgpr_read_b32 v133,a17
v_accvgpr_read_b32 v134,a18
v_accvgpr_read_b32 v135,a19
Maav 36,224,236
K1_p98:
s_cbranch_vccnz K1_tr
Ta 222,4,18560
v_mul_f32 v132,v132,v68
v_mul_f32 v133,v133,v68
v_mul_f32 v134,v134,v68
v_mul_f32 v135,v135,v68
Maav 36,228,20
CV 102,132,133
CV 103,134,135
v_accvgpr_read_b32 v140,a20
v_accvgpr_read_b32 v141,a21
v_accvgpr_read_b32 v142,a22
Maav 40,224,244
buffer_store_dwordx4 v[100:103],v10,s[36:39],s56 offen offset:0 sc1
v_accvgpr_read_b32 v143,a23
v_mul_f32 v140,v140,v69
v_mul_f32 v141,v141,v69
Maav 40,228,24
v_mul_f32 v142,v142,v69
v_mul_f32 v143,v143,v69
CV 110,140,141
CV 111,142,143
v_accvgpr_read_b32 v148,a24
Maav 44,224,252
buffer_store_dwordx4 v[108:111],v10,s[36:39],s58 offen offset:0 sc1
v_accvgpr_read_b32 v149,a25
v_accvgpr_read_b32 v150,a26
v_accvgpr_read_b32 v151,a27
Maav 44,228,28
WL 9
Ta 224,5,128
v_mul_f32 v148,v148,v70
v_mul_f32 v149,v149,v70
v_mul_f32 v150,v150,v70
v_mul_f32 v151,v151,v70
Maav 48,232,228
Ta 226,5,6272
CV 118,148,149
CV 119,150,151
K1_p99:
s_cbranch_vccnz K1_tr
v_accvgpr_read_b32 v156,a28
v_accvgpr_read_b32 v157,a29
Maav 48,236,16
Ta 228,5,12416
v_accvgpr_read_b32 v158,a30
v_accvgpr_read_b32 v159,a31
v_mul_f32 v156,v156,v71
v_mul_f32 v157,v157,v71
Maav 52,232,236
Ta 230,5,18560
v_mul_f32 v158,v158,v71
v_mul_f32 v159,v159,v71
CV 126,156,157
CV 127,158,159
Maav 52,236,20
buffer_store_dwordx4 v[116:119],v10,s[36:39],s60 offen offset:0 sc1
v_accvgpr_read_b32 v164,a32
v_accvgpr_read_b32 v165,a33
v_accvgpr_read_b32 v166,a34
Maav 56,232,244
buffer_store_dwordx4 v[124:127],v10,s[36:39],s62 offen offset:0 sc1
v_accvgpr_read_b32 v167,a35
v_mul_f32 v164,v164,v68
v_mul_f32 v165,v165,v68
Maav 56,236,24
v_mul_f32 v166,v166,v68
v_mul_f32 v167,v167,v68
CV 164,164,165
CV 165,166,167
v_accvgpr_read_b32 v172,a36
Maav 60,232,252
v_accvgpr_read_b32 v173,a37
v_accvgpr_read_b32 v174,a38
v_accvgpr_read_b32 v175,a39
v_mul_f32 v172,v172,v69
v_mul_f32 v173,v173,v69
Maav 60,236,28
K1_p100:
s_cbranch_vccnz K1_tr
WL 9
Ta 232,6,128
v_mul_f32 v174,v174,v69
v_mul_f32 v175,v175,v69
CV 172,172,173
CV 173,174,175
Maav 64,208,228
Ta 234,6,6272
v_accvgpr_read_b32 v180,a40
v_accvgpr_read_b32 v181,a41
v_accvgpr_read_b32 v182,a42
v_accvgpr_read_b32 v183,a43
Maav 64,212,16
Ta 236,6,12416
v_mul_f32 v180,v180,v70
v_mul_f32 v181,v181,v70
v_mul_f32 v182,v182,v70
v_mul_f32 v183,v183,v70
Maav 68,208,236
Ta 238,6,18560
CV 180,180,181
CV 181,182,183
v_accvgpr_read_b32 v188,a44
v_accvgpr_read_b32 v189,a45
Maav 68,212,20
v_accvgpr_read_b32 v190,a46
v_accvgpr_read_b32 v191,a47
v_mul_f32 v188,v188,v71
v_mul_f32 v189,v189,v71
v_mul_f32 v190,v190,v71
Maav 72,208,244
v_mul_f32 v191,v191,v71
CV 188,188,189
CV 189,190,191
v_accvgpr_read_b32 v196,a48
v_accvgpr_read_b32 v197,a49
Maav 72,212,24
K1_p101:
s_cbranch_vccnz K1_tr
v_accvgpr_read_b32 v198,a50
v_accvgpr_read_b32 v199,a51
v_mul_f32 v196,v196,v68
v_mul_f32 v197,v197,v68
v_mul_f32 v198,v198,v68
Maav 76,208,252
v_mul_f32 v199,v199,v68
CV 166,196,197
CV 167,198,199
v_accvgpr_read_b32 v204,a52
v_accvgpr_read_b32 v205,a53
Maav 76,212,28
WL 8
Ta 208,3,256
v_accvgpr_read_b32 v206,a54
v_accvgpr_read_b32 v207,a55
v_mul_f32 v204,v204,v69
v_mul_f32 v205,v205,v69
Maav 80,216,228
Ta 210,3,6400
v_mul_f32 v206,v206,v69
v_mul_f32 v207,v207,v69
CV 174,204,205
CV 175,206,207
Maav 80,220,16
Ta 212,3,12544
v_accvgpr_read_b32 v212,a56
v_accvgpr_read_b32 v213,a57
v_accvgpr_read_b32 v214,a58
v_accvgpr_read_b32 v215,a59
Maav 84,216,236
Ta 214,3,18688
v_mul_f32 v212,v212,v70
v_mul_f32 v213,v213,v70
v_mul_f32 v214,v214,v70
v_mul_f32 v215,v215,v70
Maav 84,220,20
buffer_store_dwordx4 v[164:167],v10,s[36:39],s56 offen offset:1024 sc1
K1_p102:
s_cbranch_vccnz K1_tr
CV 182,212,213
CV 183,214,215
v_accvgpr_read_b32 v220,a60
Maav 88,216,244
s_add_u32 m0,s41,49152
buffer_store_dwordx4 v[172:175],v10,s[36:39],s58 offen offset:1024 sc1
v_accvgpr_read_b32 v221,a61
v_accvgpr_read_b32 v222,a62
v_accvgpr_read_b32 v223,a63
Maav 88,220,24
s_mov_b32 s43,s14
buffer_store_dwordx4 v[180:183],v10,s[36:39],s60 offen offset:1024 sc1
v_mul_f32 v220,v220,v71
v_mul_f32 v221,v221,v71
v_mul_f32 v222,v222,v71
Maav 92,216,252
s_add_u32 s10,s14,40960
v_mul_f32 v223,v223,v71
CV 190,220,221
CV 191,222,223
v_accvgpr_read_b32 v84,a64
v_accvgpr_read_b32 v85,a65
Maav 92,220,28
WL 8
WL 15
s_barrier
Ta 216,4,256
v_accvgpr_read_b32 v86,a66
v_accvgpr_read_b32 v87,a67
Maav 96,224,228
s_sub_u32 s11,s10,1966080
ds_read_b128 v[76:79],v13
v_mul_f32 v84,v84,v68
v_mul_f32 v85,v85,v68
v_mul_f32 v86,v86,v68
v_mul_f32 v87,v87,v68
Maav 96,228,16
K1_p103:
s_cbranch_vccnz K1_tr
s_min_u32 s14,s10,s11
Ta 218,4,6400
CV 84,84,85
CV 85,86,87
v_accvgpr_read_b32 v92,a68
v_accvgpr_read_b32 v93,a69
Maav 100,224,236
Ta 220,4,12544
v_accvgpr_read_b32 v94,a70
v_accvgpr_read_b32 v95,a71
v_mul_f32 v92,v92,v69
v_mul_f32 v93,v93,v69
Maav 100,228,20
buffer_load_dwordx4 v14,s[48:51],s43 offen offset:0 lds
v_mul_f32 v94,v94,v69
v_mul_f32 v95,v95,v69
CV 92,92,93
Maav 104,224,244
s_add_u32 s10,s14,40960
Ta 222,4,18688
CV 93,94,95
v_accvgpr_read_b32 v100,a72
v_accvgpr_read_b32 v101,a73
v_accvgpr_read_b32 v102,a74
Maav 104,228,24
s_sub_u32 s11,s10,1966080
buffer_store_dwordx4 v[188:191],v10,s[36:39],s62 offen offset:1024 sc1
v_accvgpr_read_b32 v103,a75
v_mul_f32 v100,v100,v70
v_mul_f32 v101,v101,v70
Maav 108,224,252
buffer_load_dwordx4 v15,s[48:51],s43 offen offset:1024 lds
v_mul_f32 v102,v102,v70
v_mul_f32 v103,v103,v70
CV 100,100,101
Maav 108,228,28
K1_p104:
s_cbranch_vccnz K1_tr
WL 9
Ta 224,5,256
CV 101,102,103
v_accvgpr_read_b32 v108,a76
v_accvgpr_read_b32 v109,a77
v_accvgpr_read_b32 v110,a78
Maav 112,232,228
s_add_u32 m0,s41,51200
Ta 226,5,6400
v_accvgpr_read_b32 v111,a79
v_mul_f32 v108,v108,v71
v_mul_f32 v109,v109,v71
v_mul_f32 v110,v110,v71
Maav 112,236,16
s_mov_b32 s43,s14
Ta 228,5,12544
v_mul_f32 v111,v111,v71
CV 108,108,109
CV 109,110,111
v_accvgpr_read_b32 v116,a80
Maav 116,232,236
s_min_u32 s14,s10,s11
Ta 230,5,18688
v_accvgpr_read_b32 v117,a81
v_accvgpr_read_b32 v118,a82
v_accvgpr_read_b32 v119,a83
v_mul_f32 v116,v116,v68
Maav 116,236,20
buffer_load_dwordx4 v14,s[48:51],s43 offen offset:0 lds
v_mul_f32 v117,v117,v68
v_mul_f32 v118,v118,v68
v_mul_f32 v119,v119,v68
Maav 120,232,244
s_add_u32 s10,s14,40960
CV 86,116,117
CV 87,118,119
v_accvgpr_read_b32 v124,a84
K1_p105:
s_cbranch_vccnz K1_tr
v_accvgpr_read_b32 v125,a85
v_accvgpr_read_b32 v126,a86
Maav 120,236,24
s_sub_u32 s11,s10,1966080
buffer_store_dwordx4 v[84:87],v10,s[36:39],s56 offen offset:2048 sc1
v_accvgpr_read_b32 v127,a87
v_mul_f32 v124,v124,v69
v_mul_f32 v125,v125,v69
Maav 124,232,252
buffer_load_dwordx4 v15,s[48:51],s43 offen offset:1024 lds
v_mul_f32 v126,v126,v69
v_mul_f32 v127,v127,v69
CV 94,124,125
Maav 124,236,28
WL 9
Ta 232,6,256
CV 95,126,127
v_accvgpr_read_b32 v132,a88
v_accvgpr_read_b32 v133,a89
v_accvgpr_read_b32 v134,a90
Maav 128,208,228
s_add_u32 m0,s41,53248
Ta 234,6,6400
v_accvgpr_read_b32 v135,a91
v_mul_f32 v132,v132,v70
v_mul_f32 v133,v133,v70
v_mul_f32 v134,v134,v70
Maav 128,212,16
s_mov_b32 s43,s14
Ta 236,6,12544
v_mul_f32 v135,v135,v70
CV 102,132,133
CV 103,134,135
v_accvgpr_read_b32 v140,a92
Maav 132,208,236
s_min_u32 s14,s10,s11
Ta 238,6,18688
K1_p106:
s_cbranch_vccnz K1_tr
v_accvgpr_read_b32 v141,a93
v_accvgpr_read_b32 v142,a94
v_accvgpr_read_b32 v143,a95
v_mul_f32 v140,v140,v71
Maav 132,212,20
buffer_load_dwordx4 v14,s[48:51],s43 offen offset:0 lds
v_mul_f32 v141,v141,v71
v_mul_f32 v142,v142,v71
v_mul_f32 v143,v143,v71
Maav 136,208,244
buffer_store_dwordx4 v[92:95],v10,s[36:39],s58 offen offset:2048 sc1
CV 110,140,141
CV 111,142,143
v_accvgpr_read_b32 v148,a96
Maav 136,212,24
buffer_store_dwordx4 v[100:103],v10,s[36:39],s60 offen offset:2048 sc1
v_accvgpr_read_b32 v149,a97
v_accvgpr_read_b32 v150,a98
v_accvgpr_read_b32 v151,a99
Maav 140,208,252
buffer_load_dwordx4 v15,s[48:51],s43 offen offset:1024 lds
v_mul_f32 v148,v148,v68
v_mul_f32 v149,v149,v68
v_mul_f32 v150,v150,v68
Maav 140,212,28
WL 8
buffer_store_dwordx4 v[108:111],v10,s[36:39],s62 offen offset:2048 sc1
v_mul_f32 v151,v151,v68
CV 148,148,149
CV 149,150,151
Maav 144,216,228
WL 11
v_accvgpr_read_b32 v156,a100
v_accvgpr_read_b32 v157,a101
v_accvgpr_read_b32 v158,a102
v_accvgpr_read_b32 v159,a103
v_mul_f32 v156,v156,v69
K1_p107:
s_cbranch_vccnz K1_tr
Maav 144,220,16
v_mul_f32 v157,v157,v69
v_mul_f32 v158,v158,v69
v_mul_f32 v159,v159,v69
CV 156,156,157
CV 157,158,159
Maav 148,216,236
v_accvgpr_read_b32 v164,a104
v_accvgpr_read_b32 v165,a105
v_accvgpr_read_b32 v166,a106
v_accvgpr_read_b32 v167,a107
v_mul_f32 v164,v164,v70
Maav 148,220,20
v_mul_f32 v165,v165,v70
v_mul_f32 v166,v166,v70
v_mul_f32 v167,v167,v70
CV 164,164,165
CV 165,166,167
Maav 152,216,244
v_accvgpr_read_b32 v172,a108
v_accvgpr_read_b32 v173,a109
v_accvgpr_read_b32 v174,a110
v_accvgpr_read_b32 v175,a111
v_mul_f32 v172,v172,v71
Maav 152,220,24
v_mul_f32 v173,v173,v71
v_mul_f32 v174,v174,v71
v_mul_f32 v175,v175,v71
CV 172,172,173
CV 173,174,175
Maav 156,216,252
v_accvgpr_read_b32 v180,a112
v_accvgpr_read_b32 v181,a113
v_accvgpr_read_b32 v182,a114
v_accvgpr_read_b32 v183,a115
v_mul_f32 v180,v180,v68
Maav 156,220,28
WL 4
K1_p108:
s_cbranch_vccnz K1_tr
v_mul_f32 v181,v181,v68
v_mul_f32 v182,v182,v68
v_mul_f32 v183,v183,v68
CV 150,180,181
CV 151,182,183
Maav 160,224,228
buffer_store_dwordx4 v[148:151],v10,s[36:39],s56 offen offset:3072 sc1
v_accvgpr_read_b32 v188,a116
v_accvgpr_read_b32 v189,a117
v_accvgpr_read_b32 v190,a118
Maav 160,228,16
v_accvgpr_read_b32 v191,a119
v_mul_f32 v188,v188,v69
v_mul_f32 v189,v189,v69
v_mul_f32 v190,v190,v69
v_mul_f32 v191,v191,v69
Maav 164,224,236
CV 158,188,189
CV 159,190,191
v_accvgpr_read_b32 v196,a120
v_accvgpr_read_b32 v197,a121
v_accvgpr_read_b32 v198,a122
Maav 164,228,20
buffer_store_dwordx4 v[156:159],v10,s[36:39],s58 offen offset:3072 sc1
v_accvgpr_read_b32 v199,a123
v_mul_f32 v196,v196,v70
v_mul_f32 v197,v197,v70
Maav 168,224,244
v_mul_f32 v198,v198,v70
v_mul_f32 v199,v199,v70
CV 166,196,197
CV 167,198,199
v_accvgpr_read_b32 v204,a124
Maav 168,228,24
buffer_store_dwordx4 v[164:167],v10,s[36:39],s60 offen offset:3072 sc1
v_accvgpr_read_b32 v205,a125
v_accvgpr_read_b32 v206,a126
K1_p109:
s_cbranch_vccnz K1_tr
v_accvgpr_read_b32 v207,a127
Maav 172,224,252
v_mul_f32 v204,v204,v71
v_mul_f32 v205,v205,v71
v_mul_f32 v206,v206,v71
v_mul_f32 v207,v207,v71
CV 174,204,205
Maav 172,228,28
WL 0
CV 175,206,207
v_or_b32 v76,v76,v77
v_or3_b32 v76,v76,v78,v79
s_nop 0
v_readfirstlane_b32 s100,v76
v_accvgpr_read_b32 v32,a128
Maav 176,232,228
buffer_store_dwordx4 v[172:175],v10,s[36:39],s62 offen offset:3072 sc1
v_accvgpr_read_b32 v33,a129
v_accvgpr_read_b32 v34,a130
v_accvgpr_read_b32 v35,a131
Maav 176,236,16
v_mul_f32 v32,v32,v68
v_mul_f32 v33,v33,v68
v_mul_f32 v34,v34,v68
v_mul_f32 v35,v35,v68
CV 32,32,33
Maav 180,232,236
CV 33,34,35
v_accvgpr_read_b32 v36,a132
v_accvgpr_read_b32 v37,a133
v_accvgpr_read_b32 v38,a134
v_accvgpr_read_b32 v39,a135
Maav 180,236,20
v_mul_f32 v36,v36,v69
v_mul_f32 v37,v37,v69
v_mul_f32 v38,v38,v69
v_mul_f32 v39,v39,v69
CV 36,36,37
Maav 184,232,244
CV 37,38,39
K1_p110:
s_cbranch_vccnz K1_tr
v_accvgpr_read_b32 v40,a136
v_accvgpr_read_b32 v41,a137
v_accvgpr_read_b32 v42,a138
v_accvgpr_read_b32 v43,a139
Maav 184,236,24
v_mul_f32 v40,v40,v70
v_mul_f32 v41,v41,v70
v_mul_f32 v42,v42,v70
v_mul_f32 v43,v43,v70
CV 40,40,41
Maav 188,232,252
CV 41,42,43
v_accvgpr_read_b32 v44,a140
v_accvgpr_read_b32 v45,a141
v_accvgpr_read_b32 v46,a142
v_accvgpr_read_b32 v47,a143
Maav 188,236,28
v_mul_f32 v44,v44,v71
v_mul_f32 v45,v45,v71
v_mul_f32 v46,v46,v71
v_mul_f32 v47,v47,v71
CV 44,44,45
CV 45,46,47
v_accvgpr_read_b32 v212,a144
v_accvgpr_read_b32 v213,a145
v_accvgpr_read_b32 v214,a146
v_accvgpr_read_b32 v215,a147
v_mul_f32 v212,v212,v68
v_mul_f32 v213,v213,v68
v_mul_f32 v214,v214,v68
v_mul_f32 v215,v215,v68
CV 34,212,213
CV 35,214,215
v_accvgpr_read_b32 v220,a148
v_accvgpr_read_b32 v221,a149
v_accvgpr_read_b32 v222,a150
v_accvgpr_read_b32 v223,a151
K1_p111:
s_cbranch_vccnz K1_tr
v_mul_f32 v220,v220,v69
v_mul_f32 v221,v221,v69
v_mul_f32 v222,v222,v69
v_mul_f32 v223,v223,v69
CV 38,220,221
CV 39,222,223
v_accvgpr_read_b32 v84,a152
v_accvgpr_read_b32 v85,a153
v_accvgpr_read_b32 v86,a154
v_accvgpr_read_b32 v87,a155
v_mul_f32 v84,v84,v70
v_mul_f32 v85,v85,v70
v_mul_f32 v86,v86,v70
v_mul_f32 v87,v87,v70
CV 42,84,85
CV 43,86,87
v_accvgpr_read_b32 v92,a156
v_accvgpr_read_b32 v93,a157
v_accvgpr_read_b32 v94,a158
v_accvgpr_read_b32 v95,a159
v_mul_f32 v92,v92,v71
v_mul_f32 v93,v93,v71
v_mul_f32 v94,v94,v71
v_mul_f32 v95,v95,v71
CV 46,92,93
CV 47,94,95
v_accvgpr_read_b32 v48,a160
v_accvgpr_read_b32 v49,a161
v_accvgpr_read_b32 v50,a162
v_accvgpr_read_b32 v51,a163
v_mul_f32 v48,v48,v68
v_mul_f32 v49,v49,v68
v_mul_f32 v50,v50,v68
v_mul_f32 v51,v51,v68
CV 48,48,49
CV 49,50,51
v_accvgpr_read_b32 v52,a164
v_accvgpr_read_b32 v53,a165
v_accvgpr_read_b32 v54,a166
v_accvgpr_read_b32 v55,a167
K1_p112:
s_cbranch_vccnz K1_tr
v_mul_f32 v52,v52,v69
v_mul_f32 v53,v53,v69
v_mul_f32 v54,v54,v69
v_mul_f32 v55,v55,v69
CV 52,52,53
CV 53,54,55
v_accvgpr_read_b32 v56,a168
v_accvgpr_read_b32 v57,a169
v_accvgpr_read_b32 v58,a170
v_accvgpr_read_b32 v59,a171
v_mul_f32 v56,v56,v70
v_mul_f32 v57,v57,v70
v_mul_f32 v58,v58,v70
v_mul_f32 v59,v59,v70
CV 56,56,57
CV 57,58,59
v_accvgpr_read_b32 v60,a172
v_accvgpr_read_b32 v61,a173
v_accvgpr_read_b32 v62,a174
v_accvgpr_read_b32 v63,a175
v_mul_f32 v60,v60,v71
v_mul_f32 v61,v61,v71
v_mul_f32 v62,v62,v71
v_mul_f32 v63,v63,v71
CV 60,60,61
CV 61,62,63
v_accvgpr_read_b32 v100,a176
v_accvgpr_read_b32 v101,a177
v_accvgpr_read_b32 v102,a178
v_accvgpr_read_b32 v103,a179
v_mul_f32 v100,v100,v68
v_mul_f32 v101,v101,v68
v_mul_f32 v102,v102,v68
v_mul_f32 v103,v103,v68
CV 50,100,101
CV 51,102,103
v_accvgpr_read_b32 v108,a180
v_accvgpr_read_b32 v109,a181
v_accvgpr_read_b32 v110,a182
K1_p113:
s_cbranch_vccnz K1_tr
v_accvgpr_read_b32 v111,a183
v_mul_f32 v108,v108,v69
v_mul_f32 v109,v109,v69
v_mul_f32 v110,v110,v69
v_mul_f32 v111,v111,v69
CV 54,108,109
CV 55,110,111
v_accvgpr_read_b32 v116,a184
v_accvgpr_read_b32 v117,a185
v_accvgpr_read_b32 v118,a186
v_accvgpr_read_b32 v119,a187
v_mul_f32 v116,v116,v70
v_mul_f32 v117,v117,v70
v_mul_f32 v118,v118,v70
v_mul_f32 v119,v119,v70
CV 58,116,117
CV 59,118,119
v_accvgpr_read_b32 v124,a188
v_accvgpr_read_b32 v125,a189
v_accvgpr_read_b32 v126,a190
v_accvgpr_read_b32 v127,a191
v_mul_f32 v124,v124,v71
v_mul_f32 v125,v125,v71
v_mul_f32 v126,v126,v71
v_mul_f32 v127,v127,v71
CV 62,124,125
CV 63,126,127
s_cmp_lg_u32 s100,0
s_cbranch_scc1 K1_fb
s_waitcnt vmcnt(22)
s_branch K1_done
K1_w3:
WL 0
s_mul_i32 s45,s45,0x9e3779b1
s_add_u32 s45,s45,0x7f4a7c15
s_add_u32 m0,s42,32768
s_add_u32 s43,s14,0
buffer_load_dwordx4 v25,s[20:23],s43 offen offset:0 lds
buffer_load_dwordx4 v26,s[20:23],s43 offen offset:1024 lds
s_add_u32 m0,s42,32768
s_add_u32 s43,s14,0
buffer_load_dwordx4 v27,s[20:23],s43 offen offset:2048 lds
K1_p114:
s_cbranch_vccnz K1_p178
buffer_load_dwordx4 v28,s[20:23],s43 offen offset:3072 lds
s_add_u32 m0,s42,36864
s_add_u32 s43,s14,40960
s_add_u32 s10,s14,128
s_sub_u32 s11,s10,1280
s_min_u32 s14,s10,s11
buffer_load_dwordx4 v25,s[20:23],s43 offen offset:0 lds
buffer_load_dwordx4 v26,s[20:23],s43 offen offset:1024 lds
s_add_u32 m0,s41,24576
s_add_u32 s43,s13,0
buffer_load_dwordx4 v22,s[24:27],s43 offen offset:0 lds
buffer_load_dwordx4 v23,s[24:27],s43 offen offset:1024 lds
buffer_load_dwordx4 v24,s[24:27],s43 offen offset:2048 lds
s_add_u32 m0,s41,27648
s_add_u32 s43,s13,98304
s_add_u32 s10,s13,786432
s_sub_u32 s11,s10,7864320
s_min_u32 s13,s10,s11
buffer_load_dwordx4 v22,s[24:27],s43 offen offset:0 lds
buffer_load_dwordx4 v23,s[24:27],s43 offen offset:1024 lds
buffer_load_dwordx4 v24,s[24:27],s43 offen offset:2048 lds
s_waitcnt vmcnt(20)
Ra 0,20,0
Ra 16,21,0
Ra 4,20,2048
Ra 20,21,2048
Ra 8,20,4096
Ra 24,21,4096
s_waitcnt vmcnt(12)
s_barrier
Ta 208,16,0
Ta 210,16,1536
Ta 212,16,12288
Ta 214,16,13824
Ta 216,16,8
K1_p115:
s_cbranch_vccnz K1_p179
Ta 218,16,1544
Ta 220,16,12296
Ta 222,16,13832
Ta 224,17,0
Ta 226,17,1536
Ta 228,17,12288
Ta 230,17,13824
WL 8
MvaaZ 64,208,0
s_add_u32 m0,s42,0
Ta 232,17,8
s_add_u32 s43,s14,0
Mvaa 64,212,16
Ta 234,17,1544
MvaaZ 72,208,4
buffer_load_dwordx4 v25,s[20:23],s43 offen offset:0 lds
Mvaa 72,212,20
s_waitcnt vmcnt(11)
Ra 32,20,32768
MvaaZ 80,208,8
Ra 48,21,32768
Mvaa 80,212,24
WL 8
buffer_load_dwordx4 v26,s[20:23],s43 offen offset:1024 lds
MvaaZ 68,216,0
s_add_u32 m0,s42,0
Ta 236,17,12296
s_add_u32 s43,s14,0
Mvaa 68,220,16
s_add_u32 s10,s14,128
Ta 238,17,13832
s_sub_u32 s11,s10,1280
MvaaZ 76,216,4
buffer_load_dwordx4 v27,s[20:23],s43 offen offset:2048 lds
Mvaa 76,220,20
K1_p116:
s_cbranch_vccnz K1_p180
Ta 208,16,128
MvaaZ 84,216,8
Ta 210,16,1664
Mvaa 84,220,24
s_waitcnt vmcnt(11) lgkmcnt(4)
buffer_load_dwordx4 v28,s[20:23],s43 offen offset:3072 lds
MvaaZ 96,224,0
s_add_u32 m0,s42,4096
Ta 212,16,12416
s_add_u32 s43,s14,40960
Mvaa 96,228,16
s_min_u32 s14,s10,s11
Ta 214,16,13952
MvaaZ 104,224,4
buffer_load_dwordx4 v25,s[20:23],s43 offen offset:0 lds
Mvaa 104,228,20
Ta 216,16,136
MvaaZ 112,224,8
Ta 218,16,1672
Mvaa 112,228,24
WL 6
buffer_load_dwordx4 v26,s[20:23],s43 offen offset:1024 lds
MvaaZ 100,232,0
s_add_u32 m0,s41,49152
Ta 220,16,12424
s_add_u32 s43,s13,0
Mvaa 100,236,16
Ta 222,16,13960
MvaaZ 108,232,4
Ra 36,20,34816
Ra 52,21,34816
Mvaa 108,236,20
buffer_load_dwordx4 v22,s[24:27],s43 offen offset:0 lds
K1_p117:
s_cbranch_vccnz K1_p181
MvaaZ 116,232,8
s_add_u32 s10,s13,786432
Ta 224,17,128
s_sub_u32 s11,s10,7864320
Mvaa 116,236,24
s_waitcnt vmcnt(13) lgkmcnt(1)
buffer_load_dwordx4 v23,s[24:27],s43 offen offset:1024 lds
MvaaZ 128,208,0
Ta 226,17,1664
Mvaa 128,212,16
Ta 228,17,12416
Ta 230,17,13952
MvaaZ 136,208,4
buffer_load_dwordx4 v24,s[24:27],s43 offen offset:2048 lds
Mvaa 136,212,20
s_add_u32 m0,s41,52224
Ta 232,17,136
s_add_u32 s43,s13,98304
MvaaZ 144,208,8
s_min_u32 s13,s10,s11
Ta 234,17,1672
Mvaa 144,212,24
WL 8
buffer_load_dwordx4 v22,s[24:27],s43 offen offset:0 lds
MvaaZ 132,216,0
Ta 236,17,12424
Mvaa 132,220,16
Ta 238,17,13960
MvaaZ 140,216,4
Ra 40,20,36864
Ra 56,21,36864
Mvaa 140,220,20
buffer_load_dwordx4 v23,s[24:27],s43 offen offset:1024 lds
K1_p118:
s_cbranch_vccnz K1_p182
MvaaZ 148,216,8
Ta 208,16,256
Mvaa 148,220,24
WL 1
buffer_load_dwordx4 v24,s[24:27],s43 offen offset:2048 lds
MvaaZ 160,224,0
s_add_u32 m0,s42,32768
Ta 210,16,1792
s_add_u32 s43,s14,0
Mvaa 160,228,16
Ta 212,16,12544
Ta 214,16,14080
MvaaZ 168,224,4
buffer_load_dwordx4 v25,s[20:23],s43 offen offset:0 lds
Mvaa 168,228,20
s_add_u32 s10,s14,128
Ta 216,16,264
s_sub_u32 s11,s10,1280
MvaaZ 176,224,8
buffer_load_dwordx4 v26,s[20:23],s43 offen offset:1024 lds
Mvaa 176,228,24
WL 7
Ta 218,16,1800
s_add_u32 m0,s42,32768
MvaaZ 164,232,0
s_add_u32 s43,s14,0
Ta 220,16,12552
Mvaa 164,236,16
Ta 222,16,14088
buffer_load_dwordx4 v27,s[20:23],s43 offen offset:2048 lds
MvaaZ 172,232,4
buffer_load_dwordx4 v28,s[20:23],s43 offen offset:3072 lds
Mvaa 172,236,20
s_add_u32 m0,s42,36864
K1_p119:
s_cbranch_vccnz K1_p183
Ta 224,17,256
s_add_u32 s43,s14,40960
MvaaZ 180,232,8
s_min_u32 s14,s10,s11
buffer_load_dwordx4 v25,s[20:23],s43 offen offset:0 lds
Mvaa 180,236,24
WL 5
Ta 226,17,1792
MvaaZ 192,208,0
Ta 228,17,12544
Mvaa 192,212,16
Ta 230,17,14080
buffer_load_dwordx4 v26,s[20:23],s43 offen offset:1024 lds
MvaaZ 200,208,4
Ta 232,17,264
Mvaa 200,212,20
Ta 234,17,1800
MvaaZ 208,208,8
s_add_u32 m0,s12,24576
Ta 236,17,12552
s_add_u32 s43,s13,0
Mvaa 208,212,24
s_waitcnt vmcnt(18) lgkmcnt(7)
s_barrier
Ta 238,17,14088
MvaaZ 196,216,0
Ta 208,16,24576
Mvaa 196,220,16
Ta 210,16,26112
MvaaZ 204,216,4
Ta 212,16,36864
Mvaa 204,220,20
Ta 214,16,38400
MvaaZ 212,216,8
K1_p120:
s_cbranch_vccnz K1_p184
buffer_load_dwordx4 v22,s[24:27],s43 offen offset:0 lds
Mvaa 212,220,24
WL 8
Ta 216,16,24584
MvaaZ 224,224,0
Ta 218,16,26120
Mvaa 224,228,16
Ta 220,16,36872
MvaaZ 232,224,4
Ta 222,16,38408
Mvaa 232,228,20
buffer_load_dwordx4 v23,s[24:27],s43 offen offset:1024 lds
MvaaZ 240,224,8
Mvaa 240,228,24
WL 8
Ta 224,17,24576
MvaaZ 228,232,0
Ta 226,17,26112
Mvaa 228,236,16
s_add_u32 s10,s13,786432
Ta 228,17,36864
s_sub_u32 s11,s10,7864320
MvaaZ 236,232,4
Ta 230,17,38400
Mvaa 236,236,20
buffer_load_dwordx4 v24,s[24:27],s43 offen offset:2048 lds
MvaaZ 244,232,8
s_add_u32 m0,s12,27648
s_add_u32 s43,s13,98304
s_min_u32 s13,s10,s11
Mvaa 244,236,24
s_waitcnt vmcnt(19) lgkmcnt(8)
s_sub_u32 s12,s15,s12
Ta 232,17,24584
K1_p121:
s_cbranch_vccnz K1_p185
s_mov_b32 s3,0
K1q3_L0:
Mvaa 64,208,32
Ta 234,17,26120
Mvaa 64,212,48
Ta 236,17,36872
Mvaa 72,208,36
buffer_load_dwordx4 v22,s[24:27],s43 offen offset:0 lds
Mvaa 72,212,52
Ta 238,17,38408
Mvaa 80,208,40
Ra 0,20,0
Mvaa 80,212,56
WL 9
Ra 16,21,0
Mvaa 68,216,32
Ta 208,16,24704
Mvaa 68,220,48
buffer_load_dwordx4 v23,s[24:27],s43 offen offset:1024 lds
Mvaa 76,216,36
Ta 210,16,26240
Mvaa 76,220,52
Ta 212,16,36992
Mvaa 84,216,40
Ta 214,16,38528
Mvaa 84,220,56
s_waitcnt vmcnt(19) lgkmcnt(4)
Ta 216,16,24712
Mvaa 96,224,32
buffer_load_dwordx4 v24,s[24:27],s43 offen offset:2048 lds
Mvaa 96,228,48
s_add_u32 m0,s42,0
Ta 218,16,26248
s_add_u32 s43,s14,0
Mvaa 104,224,36
K1_p122:
s_cbranch_vccnz K1_p186
Ta 220,16,37000
Mvaa 104,228,52
Ta 222,16,38536
Mvaa 112,224,40
Ra 4,20,2048
Mvaa 112,228,56
WL 11
buffer_load_dwordx4 v25,s[20:23],s43 offen offset:0 lds
Mvaa 100,232,32
Ra 20,21,2048
Mvaa 100,236,48
Ta 224,17,24704
Mvaa 108,232,36
Ta 226,17,26240
Mvaa 108,236,52
Ta 228,17,36992
Mvaa 116,232,40
Ta 230,17,38528
Mvaa 116,236,56
s_waitcnt vmcnt(19) lgkmcnt(4)
buffer_load_dwordx4 v26,s[20:23],s43 offen offset:1024 lds
Mvaa 128,208,32
s_add_u32 m0,s42,0
Ta 232,17,24712
s_add_u32 s43,s14,0
Mvaa 128,212,48
Ta 234,17,26248
Mvaa 136,208,36
Ta 236,17,37000
Mvaa 136,212,52
Ta 238,17,38536
Mvaa 144,208,40
Ra 8,20,4096
K1_p123:
s_cbranch_vccnz K1_p187
Mvaa 144,212,56
WL 11
buffer_load_dwordx4 v27,s[20:23],s43 offen offset:2048 lds
Mvaa 132,216,32
Ra 24,21,4096
Mvaa 132,220,48
Ta 208,16,24832
Mvaa 140,216,36
Ta 210,16,26368
Mvaa 140,220,52
Ta 212,16,37120
Mvaa 148,216,40
s_add_u32 s10,s14,128
Ta 214,16,38656
s_sub_u32 s11,s10,1280
Mvaa 148,220,56
WL 4
buffer_load_dwordx4 v28,s[20:23],s43 offen offset:3072 lds
Mvaa 160,224,32
s_add_u32 m0,s42,4096
Ta 216,16,24840
s_add_u32 s43,s14,40960
Mvaa 160,228,48
s_min_u32 s14,s10,s11
Ta 218,16,26376
Mvaa 168,224,36
Ta 220,16,37128
Mvaa 168,228,52
Ta 222,16,38664
Mvaa 176,224,40
buffer_load_dwordx4 v25,s[20:23],s43 offen offset:0 lds
Mvaa 176,228,56
WL 10
Ta 224,17,24832
K1_p124:
s_cbranch_vccnz K1_p188
v_xor_b32 v16,0xc000,v16
Mvaa 164,232,32
Ta 226,17,26368
Mvaa 164,236,48
Ta 228,17,37120
Mvaa 172,232,36
Ta 230,17,38656
Mvaa 172,236,52
Mvaa 180,232,40
buffer_load_dwordx4 v26,s[20:23],s43 offen offset:1024 lds
Mvaa 180,236,56
WL 8
Ta 232,17,24840
Mvaa 192,208,32
Ta 234,17,26376
Mvaa 192,212,48
s_add_u32 s101,s101,1280
Ta 236,17,37128
Mvaa 200,208,36
Ta 238,17,38664
Mvaa 200,212,52
v_xor_b32 v17,0xc000,v17
Mvaa 208,208,40
s_add_u32 m0,s12,0
s_add_u32 s43,s13,0
Mvaa 208,212,56
s_waitcnt vmcnt(18) lgkmcnt(8)
s_barrier
Ta 208,16,0
Mvaa 196,216,32
Ta 210,16,1536
Mvaa 196,220,48
Ta 212,16,12288
Mvaa 204,216,36
K1_p125:
s_cbranch_vccnz K1_p189
buffer_load_dword v18,v19,s[48:51],s101 offen
Mvaa 204,220,52
Ta 214,16,13824
Mvaa 212,216,40
buffer_load_dwordx4 v22,s[24:27],s43 offen offset:0 lds
Mvaa 212,220,56
WL 8
Ta 216,16,8
Mvaa 224,224,32
Ta 218,16,1544
Mvaa 224,228,48
Ta 220,16,12296
Mvaa 232,224,36
Ta 222,16,13832
Mvaa 232,228,52
buffer_load_dwordx4 v23,s[24:27],s43 offen offset:1024 lds
Mvaa 240,224,40
Mvaa 240,228,56
WL 8
Ta 224,17,0
Mvaa 228,232,32
Ta 226,17,1536
Mvaa 228,236,48
s_add_u32 s10,s13,786432
Ta 228,17,12288
s_sub_u32 s11,s10,7864320
Mvaa 236,232,36
Ta 230,17,13824
Mvaa 236,236,52
buffer_load_dwordx4 v24,s[24:27],s43 offen offset:2048 lds
Mvaa 244,232,40
s_add_u32 m0,s12,3072
K1_p126:
s_cbranch_vccnz K1_p190
s_add_u32 s43,s13,98304
s_min_u32 s13,s10,s11
Mvaa 244,236,56
s_waitcnt vmcnt(20) lgkmcnt(8)
Ta 232,17,8
Mvaa 64,208,0
Ta 234,17,1544
Mvaa 64,212,16
Ta 236,17,12296
Mvaa 72,208,4
buffer_load_dwordx4 v22,s[24:27],s43 offen offset:0 lds
Mvaa 72,212,20
Ta 238,17,13832
Mvaa 80,208,8
Ra 32,20,32768
Mvaa 80,212,24
WL 9
Ra 48,21,32768
Mvaa 68,216,0
Ta 208,16,128
Mvaa 68,220,16
buffer_load_dwordx4 v23,s[24:27],s43 offen offset:1024 lds
Mvaa 76,216,4
Ta 210,16,1664
Mvaa 76,220,20
Ta 212,16,12416
Mvaa 84,216,8
Ta 214,16,13952
Mvaa 84,220,24
s_waitcnt vmcnt(20) lgkmcnt(4)
Ta 216,16,136
Mvaa 96,224,0
buffer_load_dwordx4 v24,s[24:27],s43 offen offset:2048 lds
Mvaa 96,228,16
K1_p127:
s_cbranch_vccnz K1_p191
s_add_u32 m0,s42,32768
Ta 218,16,1672
s_add_u32 s43,s14,0
Mvaa 104,224,4
Ta 220,16,12424
Mvaa 104,228,20
Ta 222,16,13960
Mvaa 112,224,8
Ra 36,20,34816
Mvaa 112,228,24
WL 11
buffer_load_dwordx4 v25,s[20:23],s43 offen offset:0 lds
Mvaa 100,232,0
Ra 52,21,34816
Mvaa 100,236,16
Ta 224,17,128
Mvaa 108,232,4
Ta 226,17,1664
Mvaa 108,236,20
Ta 228,17,12416
Mvaa 116,232,8
Ta 230,17,13952
Mvaa 116,236,24
s_waitcnt vmcnt(20) lgkmcnt(4)
buffer_load_dwordx4 v26,s[20:23],s43 offen offset:1024 lds
Mvaa 128,208,0
s_add_u32 m0,s42,32768
Ta 232,17,136
s_add_u32 s43,s14,0
Mvaa 128,212,16
Ta 234,17,1672
Mvaa 136,208,4
Ta 236,17,12424
K1_p128:
s_cbranch_vccnz K1_p192
Mvaa 136,212,20
Ta 238,17,13960
Mvaa 144,208,8
Ra 40,20,36864
Mvaa 144,212,24
WL 11
buffer_load_dwordx4 v27,s[20:23],s43 offen offset:2048 lds
Mvaa 132,216,0
Ra 56,21,36864
Mvaa 132,220,16
Ta 208,16,256
Mvaa 140,216,4
Ta 210,16,1792
Mvaa 140,220,20
Ta 212,16,12544
Mvaa 148,216,8
s_add_u32 s10,s14,128
Ta 214,16,14080
s_sub_u32 s11,s10,1280
Mvaa 148,220,24
WL 4
buffer_load_dwordx4 v28,s[20:23],s43 offen offset:3072 lds
Mvaa 160,224,0
s_add_u32 m0,s42,36864
Ta 216,16,264
s_add_u32 s43,s14,40960
Mvaa 160,228,16
s_min_u32 s14,s10,s11
Ta 218,16,1800
Mvaa 168,224,4
Ta 220,16,12552
Mvaa 168,228,20
Ta 222,16,14088
K1_p129:
s_cbranch_vccnz K1_p193
Mvaa 176,224,8
buffer_load_dwordx4 v25,s[20:23],s43 offen offset:0 lds
Mvaa 176,228,24
WL 10
Ta 224,17,256
Mvaa 164,232,0
Ta 226,17,1792
Mvaa 164,236,16
Ta 228,17,12544
Mvaa 172,232,4
Ta 230,17,14080
Mvaa 172,236,20
Mvaa 180,232,8
buffer_load_dwordx4 v26,s[20:23],s43 offen offset:1024 lds
Mvaa 180,236,24
WL 8
Ta 232,17,264
Mvaa 192,208,0
Ta 234,17,1800
Mvaa 192,212,16
s_add_u32 s101,s101,1280
Ta 236,17,12552
Mvaa 200,208,4
Ta 238,17,14088
Mvaa 200,212,20
Mvaa 208,208,8
s_add_u32 m0,s12,24576
s_add_u32 s43,s13,0
Mvaa 208,212,24
s_waitcnt vmcnt(19) lgkmcnt(8)
s_barrier
Ta 208,16,24576
Mvaa 196,216,0
Ta 210,16,26112
K1_p130:
s_cbranch_vccnz K1_p194
Mvaa 196,220,16
Ta 212,16,36864
Mvaa 204,216,4
buffer_load_dword v18,v19,s[48:51],s101 offen
Mvaa 204,220,20
Ta 214,16,38400
Mvaa 212,216,8
buffer_load_dwordx4 v22,s[24:27],s43 offen offset:0 lds
Mvaa 212,220,24
WL 8
Ta 216,16,24584
Mvaa 224,224,0
Ta 218,16,26120
Mvaa 224,228,16
Ta 220,16,36872
Mvaa 232,224,4
Ta 222,16,38408
Mvaa 232,228,20
buffer_load_dwordx4 v23,s[24:27],s43 offen offset:1024 lds
Mvaa 240,224,8
Mvaa 240,228,24
WL 8
Ta 224,17,24576
Mvaa 228,232,0
Ta 226,17,26112
Mvaa 228,236,16
s_add_u32 s10,s13,786432
Ta 228,17,36864
s_sub_u32 s11,s10,7864320
Mvaa 236,232,4
Ta 230,17,38400
Mvaa 236,236,20
buffer_load_dwordx4 v24,s[24:27],s43 offen offset:2048 lds
K1_p131:
s_cbranch_vccnz K1_p195
Mvaa 244,232,8
s_add_u32 m0,s12,27648
s_add_u32 s43,s13,98304
s_min_u32 s13,s10,s11
Mvaa 244,236,24
s_waitcnt vmcnt(21) lgkmcnt(8)
Ta 232,17,24584
s_sub_u32 s12,s15,s12
s_add_u32 s3,s3,1
s_cmp_lg_u32 s3,3
s_cbranch_scc1 K1q3_L0
Mvaa 64,208,32
s_barrier
Ta 234,17,26120
Mvaa 64,212,48
Ta 236,17,36872
Mvaa 72,208,36
buffer_load_dwordx4 v22,s[24:27],s43 offen offset:0 lds
Mvaa 72,212,52
Ta 238,17,38408
Mvaa 80,208,40
Ra 0,20,0
Mvaa 80,212,56
WL 9
Ra 16,21,0
Mvaa 68,216,32
buffer_load_dwordx4 v23,s[24:27],s43 offen offset:1024 lds
Mvaa 68,220,48
Ta 208,16,24704
Mvaa 76,216,36
Ta 210,16,26240
Mvaa 76,220,52
Ta 212,16,36992
Mvaa 84,216,40
Ta 214,16,38528
K1_p132:
s_cbranch_vccnz K1_p196
Mvaa 84,220,56
s_waitcnt vmcnt(21) lgkmcnt(4)
buffer_load_dwordx4 v24,s[24:27],s43 offen offset:2048 lds
Mvaa 96,224,32
s_add_u32 m0,s41,49152
s_mov_b32 s43,0
Ta 216,16,24712
Mvaa 96,228,48
buffer_load_dwordx4 v7,s[28:31],s43 offen offset:0 nt lds
Mvaa 104,224,36
Ta 218,16,26248
Mvaa 104,228,52
Ta 220,16,37000
Mvaa 112,224,40
buffer_load_dwordx4 v8,s[28:31],s43 offen offset:1024 nt lds
Mvaa 112,228,56
WL 9
Ta 222,16,38536
Mvaa 100,232,32
Ra 4,20,2048
Mvaa 100,236,48
Ra 20,21,2048
Mvaa 108,232,36
Ta 224,17,24704
Mvaa 108,236,52
Ta 226,17,26240
Mvaa 116,232,40
Ta 228,17,36992
Mvaa 116,236,56
s_waitcnt vmcnt(22) lgkmcnt(3)
Ta 230,17,38528
Mvaa 128,208,32
Ta 232,17,24712
Mvaa 128,212,48
K1_p133:
s_cbranch_vccnz K1_p197
Ta 234,17,26248
Mvaa 136,208,36
Ta 236,17,37000
Mvaa 136,212,52
Ta 238,17,38536
Mvaa 144,208,40
buffer_load_dwordx4 v9,s[28:31],s43 offen offset:2048 nt lds
Mvaa 144,212,56
WL 10
Ra 8,20,4096
Mvaa 132,216,32
Ra 24,21,4096
Mvaa 132,220,48
Ta 208,16,24832
Mvaa 140,216,36
s_add_u32 m0,s41,52224
Ta 210,16,26368
s_mov_b32 s43,3072
Mvaa 140,220,52
Ta 212,16,37120
Mvaa 148,216,40
Ta 214,16,38656
Mvaa 148,220,56
WL 4
Ta 216,16,24840
Mvaa 160,224,32
Ta 218,16,26376
Mvaa 160,228,48
Ta 220,16,37128
Mvaa 168,224,36
Ta 222,16,38664
Mvaa 168,228,52
K1_p134:
s_cbranch_vccnz K1_p198
buffer_load_dwordx4 v7,s[28:31],s43 offen offset:0 nt lds
Mvaa 176,224,40
v_xor_b32 v16,0xc000,v16
Mvaa 176,228,56
WL 10
Ta 224,17,24832
Mvaa 164,232,32
Ta 226,17,26368
Mvaa 164,236,48
Ta 228,17,37120
Mvaa 172,232,36
Ta 230,17,38656
Mvaa 172,236,52
Mvaa 180,232,40
Mvaa 180,236,56
WL 8
Ta 232,17,24840
Mvaa 192,208,32
Ta 234,17,26376
Mvaa 192,212,48
Ta 236,17,37128
Mvaa 200,208,36
buffer_load_dwordx4 v8,s[28:31],s43 offen offset:1024 nt lds
Mvaa 200,212,52
Ta 238,17,38664
Mvaa 208,208,40
v_xor_b32 v17,0xc000,v17
Mvaa 208,212,56
s_waitcnt vmcnt(18) lgkmcnt(8)
s_barrier
Ta 208,16,0
Mvaa 196,216,32
Ta 210,16,1536
Mvaa 196,220,48
K1_p135:
s_cbranch_vccnz K1_p199
Ta 212,16,12288
Mvaa 204,216,36
Ta 214,16,13824
Mvaa 204,220,52
Mvaa 212,216,40
Mvaa 212,220,56
WL 8
Ta 216,16,8
Mvaa 224,224,32
Ta 218,16,1544
Mvaa 224,228,48
Ta 220,16,12296
Mvaa 232,224,36
buffer_load_dwordx4 v9,s[28:31],s43 offen offset:2048 nt lds
Mvaa 232,228,52
Ta 222,16,13832
Mvaa 240,224,40
Mvaa 240,228,56
WL 8
Ta 224,17,0
Mvaa 228,232,32
Ta 226,17,1536
Mvaa 228,236,48
s_add_u32 m0,s41,98304
Ta 228,17,12288
s_mov_b32 s43,0
Mvaa 236,232,36
Ta 230,17,13824
Mvaa 236,236,52
Mvaa 244,232,40
Mvaa 244,236,56
s_waitcnt vmcnt(17) lgkmcnt(8)
Ta 232,17,8
K1_p136:
s_cbranch_vccnz K1_p200
Mvaa 64,208,0
Ta 234,17,1544
Mvaa 64,212,16
Ta 236,17,12296
Mvaa 72,208,4
buffer_load_dwordx4 v7,s[32:35],s43 offen offset:0 nt lds
Mvaa 72,212,20
Ta 238,17,13832
Mvaa 80,208,8
Ra 32,20,32768
Mvaa 80,212,24
WL 9
Ra 48,21,32768
Mvaa 68,216,0
Ta 208,16,128
Mvaa 68,220,16
Ta 210,16,1664
Mvaa 76,216,4
Ta 212,16,12416
Mvaa 76,220,20
Ta 214,16,13952
Mvaa 84,216,8
Mvaa 84,220,24
s_waitcnt vmcnt(16) lgkmcnt(4)
Ta 216,16,136
Mvaa 96,224,0
Ta 218,16,1672
Mvaa 96,228,16
buffer_load_dwordx4 v8,s[32:35],s43 offen offset:1024 nt lds
Mvaa 104,224,4
Ta 220,16,12424
Mvaa 104,228,20
Ta 222,16,13960
K1_p137:
s_cbranch_vccnz K1_p201
Mvaa 112,224,8
Ra 36,20,34816
Mvaa 112,228,24
WL 11
Ra 52,21,34816
Mvaa 100,232,0
Ta 224,17,128
Mvaa 100,236,16
Ta 226,17,1664
Mvaa 108,232,4
Ta 228,17,12416
Mvaa 108,236,20
Ta 230,17,13952
Mvaa 116,232,8
Mvaa 116,236,24
s_waitcnt vmcnt(15) lgkmcnt(4)
Ta 232,17,136
Mvaa 128,208,0
Ta 234,17,1672
Mvaa 128,212,16
buffer_load_dwordx4 v9,s[32:35],s43 offen offset:2048 nt lds
Mvaa 136,208,4
Ta 236,17,12424
Mvaa 136,212,20
Ta 238,17,13960
Mvaa 144,208,8
Ra 40,20,36864
Mvaa 144,212,24
WL 11
Ra 56,21,36864
s_add_u32 m0,s41,101376
Mvaa 132,216,0
s_mov_b32 s43,3072
K1_p138:
s_cbranch_vccnz K1_p202
Ta 208,16,256
Mvaa 132,220,16
Ta 210,16,1792
Mvaa 140,216,4
Ta 212,16,12544
Mvaa 140,220,20
Ta 214,16,14080
Mvaa 148,216,8
Mvaa 148,220,24
WL 4
Ta 216,16,264
Mvaa 160,224,0
buffer_load_dwordx4 v7,s[32:35],s43 offen offset:0 nt lds
Mvaa 160,228,16
Ta 218,16,1800
Mvaa 168,224,4
Ta 220,16,12552
Mvaa 168,228,20
Ta 222,16,14088
Mvaa 176,224,8
Mvaa 176,228,24
WL 10
Ta 224,17,256
Mvaa 164,232,0
Ta 226,17,1792
Mvaa 164,236,16
Ta 228,17,12544
Mvaa 172,232,4
Ta 230,17,14080
Mvaa 172,236,20
Mvaa 180,232,8
buffer_load_dwordx4 v8,s[32:35],s43 offen offset:1024 nt lds
K1_p139:
s_cbranch_vccnz K1_p203
Mvaa 180,236,24
WL 8
Ta 232,17,264
Mvaa 192,208,0
Ta 234,17,1800
Mvaa 192,212,16
Ta 236,17,12552
Mvaa 200,208,4
Ta 238,17,14088
Mvaa 200,212,20
Mvaa 208,208,8
Mvaa 208,212,24
s_waitcnt vmcnt(11) lgkmcnt(8)
s_barrier
Ta 208,16,24576
Mvaa 196,216,0
Ta 210,16,26112
Mvaa 196,220,16
Ta 212,16,36864
Mvaa 204,216,4
Ta 214,16,38400
Mvaa 204,220,20
Mvaa 212,216,8
buffer_load_dwordx4 v9,s[32:35],s43 offen offset:2048 nt lds
Mvaa 212,220,24
WL 8
Ta 216,16,24584
Mvaa 224,224,0
Ta 218,16,26120
Mvaa 224,228,16
Ta 220,16,36872
Mvaa 232,224,4
Ta 222,16,38408
Mvaa 232,228,20
K1_p140:
s_cbranch_vccnz K1_p204
Mvaa 240,224,8
s_add_u32 m0,s41,73728
s_mov_b32 s43,24576
Mvaa 240,228,24
WL 8
Ta 224,17,24576
Mvaa 228,232,0
Ta 226,17,26112
Mvaa 228,236,16
Ta 228,17,36864
Mvaa 236,232,4
Ta 230,17,38400
Mvaa 236,236,20
Mvaa 244,232,8
buffer_load_dwordx4 v7,s[28:31],s43 offen offset:0 nt lds
Mvaa 244,236,24
WL 8
Ta 232,17,24584
Mvaa 64,208,32
Ta 234,17,26120
Mvaa 64,212,48
Ta 236,17,36872
Mvaa 72,208,36
Ta 238,17,38408
Mvaa 72,212,52
Mvaa 80,208,40
Mvaa 80,212,56
WL 8
Ta 208,16,24704
Mvaa 68,216,32
Ta 210,16,26240
v_mul_f32 v64,s44,v64
Mvaa 68,220,48
K1_p141:
s_cbranch_vccnz K1_p205
Ta 212,16,36992
v_mul_f32 v65,s44,v65
Mvaa 76,216,36
Ta 214,16,38528
v_mul_f32 v66,s44,v66
Mvaa 76,220,52
buffer_load_dwordx4 v8,s[28:31],s43 offen offset:1024 nt lds
Mvaa 84,216,40
v_mul_f32 v67,s44,v67
CV 64,64,65
Mvaa 84,220,56
WL 8
Ta 216,16,24712
CV 65,66,67
Mvaa 96,224,32
Ta 218,16,26248
v_mul_f32 v68,s44,v68
Mvaa 96,228,48
Ta 220,16,37000
v_mul_f32 v69,s44,v69
Mvaa 104,224,36
Ta 222,16,38536
v_mul_f32 v70,s44,v70
Mvaa 104,228,52
v_mul_f32 v71,s44,v71
CV 66,68,69
Mvaa 112,224,40
CV 67,70,71
v_mul_f32 v72,s44,v72
Mvaa 112,228,56
WL 8
Ta 224,17,24704
v_mul_f32 v73,s44,v73
Mvaa 100,232,32
Ta 226,17,26240
v_mul_f32 v96,s44,v96
Mvaa 100,236,48
Ta 228,17,36992
K1_p142:
s_cbranch_vccnz K1_p206
v_mul_f32 v97,s44,v97
Mvaa 108,232,36
Ta 230,17,38528
v_mul_f32 v98,s44,v98
Mvaa 108,236,52
buffer_load_dwordx4 v9,s[28:31],s43 offen offset:2048 nt lds
Mvaa 116,232,40
v_mul_f32 v99,s44,v99
CV 96,96,97
Mvaa 116,236,56
WL 8
Ta 232,17,24712
CV 97,98,99
Mvaa 128,208,32
Ta 234,17,26248
v_mul_f32 v100,s44,v100
Mvaa 128,212,48
Ta 236,17,37000
v_mul_f32 v101,s44,v101
Mvaa 136,208,36
s_add_u32 m0,s41,76800
Ta 238,17,38536
v_mul_f32 v102,s44,v102
Mvaa 136,212,52
s_mov_b32 s43,27648
v_mul_f32 v103,s44,v103
CV 98,100,101
Mvaa 144,208,40
CV 99,102,103
v_mul_f32 v74,s44,v74
Mvaa 144,212,56
WL 8
Ta 208,16,24832
v_mul_f32 v75,s44,v75
Mvaa 132,216,32
Ta 210,16,26368
CV 72,72,73
K1_p143:
s_cbranch_vccnz K1_p207
Mvaa 132,220,48
Ta 212,16,37120
CV 73,74,75
Mvaa 140,216,36
Ta 214,16,38656
v_mul_f32 v76,s44,v76
Mvaa 140,220,52
buffer_load_dwordx4 v7,s[28:31],s43 offen offset:0 nt lds
Mvaa 148,216,40
v_mul_f32 v77,s44,v77
v_mul_f32 v78,s44,v78
Mvaa 148,220,56
WL 8
Ta 216,16,24840
v_mul_f32 v79,s44,v79
Mvaa 160,224,32
Ta 218,16,26376
CV 74,76,77
Mvaa 160,228,48
Ta 220,16,37128
CV 75,78,79
Mvaa 168,224,36
Ta 222,16,38664
v_mul_f32 v104,s44,v104
Mvaa 168,228,52
v_mul_f32 v105,s44,v105
v_mul_f32 v106,s44,v106
Mvaa 176,224,40
v_mul_f32 v107,s44,v107
CV 104,104,105
Mvaa 176,228,56
WL 8
Ta 224,17,24832
CV 105,106,107
Mvaa 164,232,32
Ta 226,17,26368
K1_p144:
s_cbranch_vccnz K1_p80
v_mul_f32 v108,s44,v108
Mvaa 164,236,48
Ta 228,17,37120
v_mul_f32 v109,s44,v109
Mvaa 172,232,36
buffer_load_dwordx4 v8,s[28:31],s43 offen offset:1024 nt lds
Mvaa 172,236,52
Ta 230,17,38656
v_mul_f32 v110,s44,v110
Mvaa 180,232,40
v_mul_f32 v111,s44,v111
CV 106,108,109
Mvaa 180,236,56
WL 8
Ta 232,17,24840
CV 107,110,111
Mvaa 192,208,32
Ta 234,17,26376
v_mul_f32 v80,s44,v80
Mvaa 192,212,48
Ta 236,17,37128
v_mul_f32 v81,s44,v81
Mvaa 200,208,36
Ta 238,17,38664
v_mul_f32 v82,s44,v82
Mvaa 200,212,52
v_mul_f32 v83,s44,v83
CV 80,80,81
Mvaa 208,208,40
CV 81,82,83
v_mul_f32 v84,s44,v84
Mvaa 208,212,56
s_waitcnt vmcnt(11) lgkmcnt(8)
s_barrier
Ra 208,1,0
Mvaa 196,216,32
Ra 212,2,0
v_mul_f32 v85,s44,v85
K1_p145:
s_cbranch_vccnz K1_p81
Mvaa 196,220,48
buffer_load_dwordx4 v9,s[28:31],s43 offen offset:2048 nt lds
Mvaa 204,216,36
v_mul_f32 v86,s44,v86
v_mul_f32 v87,s44,v87
Mvaa 204,220,52
CV 82,84,85
CV 83,86,87
Mvaa 212,216,40
v_mul_f32 v112,s44,v112
v_mul_f32 v113,s44,v113
Mvaa 212,220,56
WL 6
Ra 216,1,128
v_mul_f32 v114,s44,v114
Mvaa 224,224,32
Ra 220,2,128
v_mul_f32 v115,s44,v115
Mvaa 224,228,48
s_add_u32 m0,s41,122880
CV 112,112,113
CV 113,114,115
Mvaa 232,224,36
s_mov_b32 s43,49152
v_mul_f32 v116,s44,v116
v_mul_f32 v117,s44,v117
Mvaa 232,228,52
v_mul_f32 v118,s44,v118
v_mul_f32 v119,s44,v119
Mvaa 240,224,40
CV 114,116,117
CV 115,118,119
Mvaa 240,228,56
WL 4
Ra 224,1,256
v_mul_f32 v128,s44,v128
Mvaa 228,232,32
Ra 228,2,256
K1_p146:
s_cbranch_vccnz K1_p210
v_mul_f32 v129,s44,v129
Mvaa 228,236,48
buffer_load_dwordx4 v7,s[28:31],s43 offen offset:0 nt lds
Mvaa 236,232,36
v_mul_f32 v130,s44,v130
v_mul_f32 v131,s44,v131
Mvaa 236,236,52
CV 128,128,129
CV 129,130,131
Mvaa 244,232,40
v_mul_f32 v132,s44,v132
v_mul_f32 v133,s44,v133
Mvaa 244,236,56
WL 4
Ra 232,1,6144
v_mul_f32 v134,s44,v134
MvavZ 32,208,64
s_lshr_b32 s12,s2,3
Ra 236,2,6144
v_mul_f32 v135,s44,v135
Mvav 32,212,96
s_mul_i32 s15,s12,52
CV 130,132,133
CV 131,134,135
MvavZ 36,208,72
s_lshr_b32 s15,s15,8
v_mul_f32 v160,s44,v160
v_mul_f32 v161,s44,v161
Mvav 36,212,104
s_mul_i32 s13,s15,5
v_mul_f32 v162,s44,v162
v_mul_f32 v163,s44,v163
MvavZ 40,208,80
s_sub_u32 s12,s12,s13
CV 160,160,161
CV 161,162,163
v_mul_f32 v164,s44,v164
v_mul_f32 v165,s44,v165
v_mul_f32 v166,s44,v166
v_mul_f32 v167,s44,v167
CV 162,164,165
CV 163,166,167
K1_p147:
s_cbranch_vccnz K1_p211
Mvav 40,212,112
WL 4
Ra 208,1,6272
v_mul_f32 v136,s44,v136
v_mul_f32 v137,s44,v137
v_mul_f32 v138,s44,v138
v_mul_f32 v139,s44,v139
CV 136,136,137
CV 137,138,139
v_mul_f32 v140,s44,v140
v_mul_f32 v141,s44,v141
v_mul_f32 v142,s44,v142
v_mul_f32 v143,s44,v143
CV 138,140,141
CV 139,142,143
Mvav 32,216,128
s_mul_i32 s15,s15,3
Ra 212,2,6272
v_mul_f32 v168,s44,v168
v_mul_f32 v169,s44,v169
v_mul_f32 v170,s44,v170
v_mul_f32 v171,s44,v171
CV 168,168,169
CV 169,170,171
v_mul_f32 v172,s44,v172
v_mul_f32 v173,s44,v173
v_mul_f32 v174,s44,v174
v_mul_f32 v175,s44,v175
CV 170,172,173
CV 171,174,175
Mvav 32,220,160
s_mul_i32 s12,s12,3
buffer_load_dwordx4 v8,s[28:31],s43 offen offset:1024 nt lds
v_mul_f32 v144,s44,v144
v_mul_f32 v145,s44,v145
v_mul_f32 v146,s44,v146
v_mul_f32 v147,s44,v147
CV 144,144,145
CV 145,146,147
v_mul_f32 v148,s44,v148
v_mul_f32 v149,s44,v149
v_mul_f32 v150,s44,v150
v_mul_f32 v151,s44,v151
CV 146,148,149
CV 147,150,151
K1_p148:
s_cbranch_vccnz K1_p212
Mvav 36,216,136
s_add_u32 s15,s15,s12
v_mul_f32 v176,s44,v176
v_mul_f32 v177,s44,v177
v_mul_f32 v178,s44,v178
v_mul_f32 v179,s44,v179
CV 176,176,177
CV 177,178,179
v_mul_f32 v180,s44,v180
v_mul_f32 v181,s44,v181
v_mul_f32 v182,s44,v182
v_mul_f32 v183,s44,v183
CV 178,180,181
CV 179,182,183
Mvav 36,220,168
s_and_b32 s15,s15,15
v_mul_f32 v192,s44,v192
v_mul_f32 v193,s44,v193
v_mul_f32 v194,s44,v194
v_mul_f32 v195,s44,v195
CV 192,192,193
CV 193,194,195
v_mul_f32 v196,s44,v196
v_mul_f32 v197,s44,v197
v_mul_f32 v198,s44,v198
v_mul_f32 v199,s44,v199
CV 194,196,197
CV 195,198,199
Mvav 40,216,144
s_mul_i32 s12,s15,3
v_mul_f32 v224,s44,v224
v_mul_f32 v225,s44,v225
v_mul_f32 v226,s44,v226
v_mul_f32 v227,s44,v227
CV 224,224,225
CV 225,226,227
v_mul_f32 v228,s44,v228
v_mul_f32 v229,s44,v229
v_mul_f32 v230,s44,v230
v_mul_f32 v231,s44,v231
CV 226,228,229
CV 227,230,231
Mvav 40,220,176
WL 4
Ra 216,1,6400
v_mul_f32 v200,s44,v200
K1_p149:
s_cbranch_vccnz K1_p213
v_mul_f32 v201,s44,v201
v_mul_f32 v202,s44,v202
v_mul_f32 v203,s44,v203
CV 200,200,201
CV 201,202,203
v_mul_f32 v204,s44,v204
v_mul_f32 v205,s44,v205
v_mul_f32 v206,s44,v206
v_mul_f32 v207,s44,v207
CV 202,204,205
CV 203,206,207
Mvav 32,224,192
s_add_u32 s12,s12,12
Ra 220,2,6400
v_mul_f32 v232,s44,v232
v_mul_f32 v233,s44,v233
v_mul_f32 v234,s44,v234
v_mul_f32 v235,s44,v235
CV 232,232,233
CV 233,234,235
v_mul_f32 v236,s44,v236
v_mul_f32 v237,s44,v237
v_mul_f32 v238,s44,v238
v_mul_f32 v239,s44,v239
CV 234,236,237
CV 235,238,239
Mvav 32,228,224
s_sub_u32 s13,s12,48
v_mul_f32 v208,s44,v208
v_mul_f32 v209,s44,v209
v_mul_f32 v210,s44,v210
v_mul_f32 v211,s44,v211
CV 208,208,209
CV 209,210,211
v_mul_f32 v212,s44,v212
v_mul_f32 v213,s44,v213
v_mul_f32 v214,s44,v214
v_mul_f32 v215,s44,v215
CV 210,212,213
CV 211,214,215
Mvav 36,224,200
s_min_u32 s12,s12,s13
v_mul_f32 v240,s44,v240
v_mul_f32 v241,s44,v241
v_mul_f32 v242,s44,v242
v_mul_f32 v243,s44,v243
CV 240,240,241
K1_p150:
s_cbranch_vccnz K1_p214
CV 241,242,243
v_mul_f32 v244,s44,v244
v_mul_f32 v245,s44,v245
v_mul_f32 v246,s44,v246
v_mul_f32 v247,s44,v247
CV 242,244,245
CV 243,246,247
Mvav 36,228,232
s_mul_i32 s14,s12,40960
Mvav 40,224,208
Mvav 40,228,240
WL 4
Ra 224,1,12288
MvavZ 48,232,64
Ra 228,2,12288
v_max3_f32 v228,v32,v33,v34
Mvav 48,236,96
buffer_load_dwordx4 v9,s[28:31],s43 offen offset:2048 nt lds
MvavZ 52,232,72
v_max_f32 v228,v228,v35
v_mov_b32 v229,v228
Mvav 52,236,104
v_max3_f32 v236,v36,v37,v38
v_max_f32 v236,v236,v39
MvavZ 56,232,80
v_permlane32_swap_b32 v228,v229
v_max_f32 v228,v228,v229
Mvav 56,236,112
WL 4
Ra 232,1,12416
v_mov_b32 v229,v228
Mvav 48,208,128
s_add_u32 m0,s41,125952
Ra 236,2,12416
v_mov_b32 v237,v236
Mvav 48,212,160
s_mov_b32 s43,52224
v_permlane16_swap_b32 v228,v229
K1_p151:
s_cbranch_vccnz K1_p215
v_max_f32 v228,v228,v229
Mvav 52,208,136
v_sub_f32 v68,0,v228
v_sub_f32 v69,0,v228
Mvav 52,212,168
v_sub_f32 v70,0,v228
v_sub_f32 v71,0,v228
Mvav 56,208,144
v_permlane32_swap_b32 v236,v237
v_max_f32 v236,v236,v237
Mvav 56,212,176
WL 4
Ra 208,1,12544
v_mov_b32 v237,v236
Mvav 48,216,192
buffer_load_dwordx4 v7,s[28:31],s43 offen offset:0 nt lds
Mvav 48,220,224
Ra 212,2,12544
v_max3_f32 v244,v40,v41,v42
Mvav 52,216,200
v_max_f32 v244,v244,v43
v_mov_b32 v245,v244
Mvav 52,220,232
v_permlane16_swap_b32 v236,v237
v_max_f32 v236,v236,v237
Mvav 56,216,208
v_sub_f32 v76,0,v236
v_sub_f32 v77,0,v236
Mvav 56,220,240
WL 4
Ra 216,1,18432
v_sub_f32 v78,0,v236
MvavZ 100,224,64
Ra 220,2,18432
v_sub_f32 v79,0,v236
Mvav 100,228,96
v_permlane32_swap_b32 v244,v245
v_max_f32 v244,v244,v245
MvavZ 108,224,72
v_mov_b32 v245,v244
v_add_f32 v32,v32,v68
Mvav 108,228,104
EX 32
K1_p152:
s_cbranch_vccnz K1_p216
MvavZ 116,224,80
buffer_load_dwordx4 v8,s[28:31],s43 offen offset:1024 nt lds
Mvav 116,228,112
WL 4
Ra 224,1,18560
v_permlane16_swap_b32 v244,v245
Mvav 100,232,128
Ra 228,2,18560
v_max_f32 v244,v244,v245
Mvav 100,236,160
v_sub_f32 v84,0,v244
v_sub_f32 v85,0,v244
Mvav 108,232,136
v_sub_f32 v86,0,v244
v_sub_f32 v87,0,v244
Mvav 108,236,168
v_add_f32 v33,v33,v68
v_add_f32 v34,v34,v68
Mvav 116,232,144
EX 33
Mvav 116,236,176
WL 4
Ra 232,1,18688
v_add_f32 v35,v35,v68
Mvav 100,208,192
Ra 236,2,18688
v_add_u32 v1,24576,v1
Mvav 100,212,224
EX 34
Mvav 108,208,200
EX 35
Mvav 108,212,232
v_add_u32 v2,24576,v2
CV 164,32,33
Mvav 116,208,208
buffer_load_dwordx4 v9,s[28:31],s43 offen offset:2048 nt lds
Mvav 116,212,240
s_waitcnt vmcnt(6) lgkmcnt(4)
s_barrier
Ra 208,1,0
K1_p153:
s_cbranch_vccnz K1_p217
MvavC 132,216,64,68
Ra 212,2,0
CV 165,34,35
Mvav 132,220,96
v_add_f32 v36,v36,v76
v_add_f32 v37,v37,v76
MvavC 140,216,72,76
EX 36
Mvav 140,220,104
EX 37
MvavC 148,216,80,84
s_add_u32 m0,s41,0
v_add_f32 v38,v38,v76
v_add_f32 v39,v39,v76
Mvav 148,220,112
WL 4
Ra 216,1,128
CV 172,36,37
Mvav 132,224,128
s_mov_b32 s43,24576
Ra 220,2,128
v_add_f32 v40,v40,v84
Mvav 132,228,160
EX 38
Mvav 140,224,136
EX 39
Mvav 140,228,168
EX 40
Mvav 148,224,144
buffer_load_dwordx4 v7,s[32:35],s43 offen offset:0 nt lds
Mvav 148,228,176
WL 4
Ra 224,1,256
CV 173,38,39
Mvav 132,232,192
Ra 228,2,256
v_add_f32 v41,v41,v84
Mvav 132,236,224
K1_p154:
s_cbranch_vccnz K1_p218
v_add_f32 v42,v42,v84
v_add_f32 v43,v43,v84
Mvav 140,232,200
EX 41
Mvav 140,236,232
EX 42
Mvav 148,232,208
EX 43
Mvav 148,236,240
WL 4
Ra 232,1,6144
CV 180,40,41
MvavC 32,208,64,68
Ra 236,2,6144
CV 181,42,43
Mvav 32,212,96
v_add_f32 v48,v48,v68
v_add_f32 v49,v49,v68
MvavC 36,208,72,76
EX 48
Mvav 36,212,104
buffer_load_dwordx4 v8,s[32:35],s43 offen offset:1024 nt lds
MvavC 40,208,80,84
EX 49
Mvav 40,212,112
WL 4
Ra 208,1,6272
v_add_f32 v50,v50,v68
Mvav 32,216,128
s_add_u32 s10,s7,49152
Ra 212,2,6272
v_add_f32 v51,v51,v68
Mvav 32,220,160
s_sub_u32 s11,s10,147456
EX 50
Mvav 36,216,136
s_min_u32 s10,s10,s11
EX 51
Mvav 36,220,168
s_sub_u32 s9,s10,s7
K1_p155:
s_cbranch_vccnz K1_p219
EX 132
Mvav 40,216,144
s_add_u32 s17,s41,s7
EX 133
Mvav 40,220,176
WL 4
Ra 216,1,6400
CV 166,48,49
Mvav 32,224,192
s_mov_b32 s7,s10
Ra 220,2,6400
CV 167,50,51
Mvav 32,228,224
v_add_f32 v52,v52,v76
v_add_f32 v53,v53,v76
Mvav 36,224,200
v_add_f32 v54,v54,v76
v_add_f32 v55,v55,v76
Mvav 36,228,232
buffer_load_dwordx4 v9,s[32:35],s43 offen offset:2048 nt lds
Mvav 40,224,208
EX 52
Mvav 40,228,240
WL 4
EX 53
MvavC 48,232,64,68
EX 54
EX 55
Mvav 48,236,96
Ra 224,1,12288
CV 174,52,53
CV 175,54,55
v_add_f32 v56,v56,v84
v_add_f32 v57,v57,v84
v_add_f32 v58,v58,v84
v_add_f32 v59,v59,v84
MvavC 52,232,72,76
s_add_u32 m0,s41,3072
EX 56
EX 57
EX 58
EX 59
Mvav 52,236,104
K1_p156:
s_cbranch_vccnz K1_p220
s_mov_b32 s43,27648
Ra 228,2,12288
CV 182,56,57
CV 183,58,59
MvavC 56,232,80,84
EX 134
Mvav 56,236,112
WL 4
Ra 232,1,12416
v_add_f32 v100,v100,v68
Mvav 48,208,128
Ra 236,2,12416
v_add_f32 v101,v101,v68
Mvav 48,212,160
EX 100
Mvav 52,208,136
buffer_load_dwordx4 v7,s[32:35],s43 offen offset:0 nt lds
Mvav 52,212,168
v_add_f32 v102,v102,v68
v_add_f32 v103,v103,v68
Mvav 56,208,144
EX 101
Mvav 56,212,176
WL 4
Ra 208,1,12544
CV 196,100,101
Mvav 48,216,192
Ra 212,2,12544
v_add_f32 v108,v108,v76
Mvav 48,220,224
EX 102
Mvav 52,216,200
EX 103
Mvav 52,220,232
CV 197,102,103
v_add_f32 v109,v109,v76
Mvav 56,216,208
v_add_f32 v110,v110,v76
K1_p157:
s_cbranch_vccnz K1_p221
v_add_f32 v111,v111,v76
Mvav 56,220,240
WL 4
EX 108
MvavC 100,224,64,68
EX 109
EX 110
EX 111
Mvav 100,228,96
Ra 216,1,18432
CV 204,108,109
CV 205,110,111
v_add_f32 v116,v116,v84
v_add_f32 v117,v117,v84
v_add_f32 v118,v118,v84
v_add_f32 v119,v119,v84
MvavC 108,224,72,76
EX 116
EX 117
EX 118
EX 119
Mvav 108,228,104
buffer_load_dwordx4 v8,s[32:35],s43 offen offset:1024 nt lds
CV 212,116,117
CV 213,118,119
MvavC 116,224,80,84
Ra 220,2,18432
CV 198,132,133
Mvav 116,228,112
WL 4
Ra 224,1,18560
v_add_u32 v3,s9,v3
Mvav 100,232,128
Ra 228,2,18560
v_add_u32 v4,s9,v4
Mvav 100,236,160
EX 135
Mvav 108,232,136
EX 140
Mvav 108,236,168
EX 141
Mvav 116,232,144
K1_p158:
s_cbranch_vccnz K1_p222
EX 142
Mvav 116,236,176
WL 4
Ra 232,1,18688
CV 199,134,135
Mvav 100,208,192
Ra 236,2,18688
CV 206,140,141
Mvav 100,212,224
buffer_load_dwordx4 v9,s[32:35],s43 offen offset:2048 nt lds
Mvav 108,208,200
EX 143
Mvav 108,212,232
CV 207,142,143
v_add_u32 v5,s9,v5
Mvav 116,208,208
EX 148
Mvav 116,212,240
s_waitcnt vmcnt(18) lgkmcnt(4)
s_barrier
Ta 208,3,0
MvavC 132,216,64,68
Ta 210,3,6144
v_add_u32 v6,s9,v6
Mvav 132,220,96
s_add_u32 m0,s41,24576
EX 149
MvavC 140,216,72,76
s_mov_b32 s43,73728
EX 150
EX 151
Mvav 140,220,104
Ta 212,3,12288
CV 214,148,149
CV 215,150,151
MvavC 148,216,80,84
Ta 214,3,18432
K1_p159:
s_cbranch_vccnz K1_p223
Mvav 148,220,112
WL 6
Ta 216,4,0
Mvav 132,224,128
Ta 218,4,6144
Mvav 132,228,160
Ta 220,4,12288
Mvav 140,224,136
buffer_load_dwordx4 v7,s[28:31],s43 offen offset:0 nt lds
Mvav 140,228,168
Ta 222,4,18432
Mvav 148,224,144
EX 32
Mvav 148,228,176
WL 8
Ta 224,5,0
Mvav 132,232,192
Ta 226,5,6144
Mvav 132,236,224
Ta 228,5,12288
Mvav 140,232,200
Ta 230,5,18432
Mvav 140,236,232
EX 33
Mvav 148,232,208
EX 34
Mvav 148,236,240
Ta 232,6,0
CV 228,32,33
MaavZ 192,240,164
Ta 234,6,6144
Maav 192,240,196
buffer_load_dwordx4 v8,s[28:31],s43 offen offset:1024 nt lds
MaavZ 196,240,172
K1_p160:
s_cbranch_vccnz K1_p96
Ta 236,6,12288
Maav 196,240,204
Ta 238,6,18432
MaavZ 200,240,180
EX 35
Maav 200,240,212
WL 12
EX 36
MaavZ 0,208,164
EX 37
Maav 0,212,196
EX 38
MaavZ 4,208,172
EX 39
Maav 4,212,204
EX 40
MaavZ 8,208,180
EX 41
Maav 8,212,212
WL 8
Ta 208,3,128
CV 229,34,35
MaavZ 16,216,164
s_add_u32 s10,s6,49152
Ta 210,3,6272
CV 236,36,37
Maav 16,220,196
s_sub_u32 s11,s10,147456
buffer_load_dwordx4 v9,s[28:31],s43 offen offset:2048 nt lds
MaavZ 20,216,172
s_min_u32 s10,s10,s11
Ta 212,3,12416
CV 237,38,39
Maav 20,220,204
s_sub_u32 s8,s10,s6
Ta 214,3,18560
CV 244,40,41
K1_p161:
s_cbranch_vccnz K1_p97
MaavZ 24,216,180
s_add_u32 s16,s41,s6
EX 42
Maav 24,220,212
WL 8
Ta 216,4,128
v_add_u32 v1,s8,v1
MaavZ 32,224,164
s_add_u32 m0,s41,27648
Ta 218,4,6272
v_add_u32 v2,s8,v2
Maav 32,228,196
s_mov_b32 s43,76800
Ta 220,4,12416
s_mov_b32 s6,s10
MaavZ 36,224,172
Ta 222,4,18560
Maav 36,228,204
EX 43
MaavZ 40,224,180
EX 48
Maav 40,228,212
WL 8
Ta 224,5,128
CV 245,42,43
MaavZ 48,232,164
buffer_load_dwordx4 v7,s[28:31],s43 offen offset:0 nt lds
Maav 48,236,196
Ta 226,5,6272
MaavZ 52,232,172
Ta 228,5,12416
Maav 52,236,204
Ta 230,5,18560
MaavZ 56,232,180
EX 49
Maav 56,236,212
K1_p162:
s_cbranch_vccnz K1_p98
WL 8
Ta 232,6,128
CV 230,48,49
MaavZ 64,208,164
Ta 234,6,6272
Maav 64,212,196
Ta 236,6,12416
MaavZ 68,208,172
Ta 238,6,18560
Maav 68,212,204
EX 50
MaavZ 72,208,180
buffer_load_dwordx4 v8,s[28:31],s43 offen offset:1024 nt lds
Maav 72,212,212
WL 8
Ta 208,3,256
MaavZ 80,216,164
Ta 210,3,6400
Maav 80,220,196
Ta 212,3,12544
MaavZ 84,216,172
Ta 214,3,18688
Maav 84,220,204
EX 51
MaavZ 88,216,180
EX 52
Maav 88,220,212
WL 8
Ta 216,4,256
CV 231,50,51
MaavZ 96,224,164
Ta 218,4,6400
Maav 96,228,196
Ta 220,4,12544
MaavZ 100,224,172
K1_p163:
s_cbranch_vccnz K1_p99
Ta 222,4,18688
Maav 100,228,204
EX 53
MaavZ 104,224,180
buffer_load_dwordx4 v9,s[28:31],s43 offen offset:2048 nt lds
Maav 104,228,212
WL 8
Ta 224,5,256
CV 238,52,53
MaavZ 112,232,164
Ta 226,5,6400
Maav 112,236,196
Ta 228,5,12544
MaavZ 116,232,172
Ta 230,5,18688
Maav 116,236,204
EX 54
MaavZ 120,232,180
s_add_u32 m0,s17,0
EX 55
Maav 120,236,212
WL 8
Ta 232,6,256
CV 239,54,55
MaavZ 128,208,164
s_add_u32 s43,s5,0
Ta 234,6,6400
Maav 128,212,196
Ta 236,6,12544
MaavZ 132,208,172
Ta 238,6,18688
Maav 132,212,204
EX 56
MaavZ 136,208,180
buffer_load_dwordx4 v7,s[32:35],s43 offen offset:0 nt lds
K1_p164:
s_cbranch_vccnz K1_p100
Maav 136,212,212
s_waitcnt vmcnt(13) lgkmcnt(8)
s_barrier
Ra 208,1,0
MaavZ 144,216,164
Ra 212,2,0
Maav 144,220,196
EX 57
MaavZ 148,216,172
EX 58
Maav 148,220,204
EX 59
MaavZ 152,216,180
EX 100
Maav 152,220,212
WL 6
Ra 216,1,128
CV 246,56,57
MaavZ 160,224,164
Ra 220,2,128
CV 247,58,59
Maav 160,228,196
EX 101
MaavZ 164,224,172
EX 102
Maav 164,228,204
buffer_load_dwordx4 v8,s[32:35],s43 offen offset:1024 nt lds
MaavZ 168,224,180
EX 103
Maav 168,228,212
WL 4
Ra 224,1,256
CV 16,100,101
MaavZ 176,232,164
Ra 228,2,256
CV 17,102,103
Maav 176,236,196
K1_p165:
s_cbranch_vccnz K1_p101
EX 108
MaavZ 180,232,172
EX 109
Maav 180,236,204
EX 110
MaavZ 184,232,180
EX 111
EX 116
EX 117
EX 118
EX 119
EX 132
EX 133
EX 134
EX 135
EX 140
EX 141
EX 142
EX 143
EX 148
EX 149
EX 150
EX 151
Maav 184,236,212
WL 4
Ra 232,1,6144
CV 20,108,109
CV 21,110,111
CV 24,116,117
CV 25,118,119
CV 18,132,133
CV 19,134,135
CV 22,140,141
CV 23,142,143
CV 26,148,149
CV 27,150,151
s_mov_b32 s3,0
K1q3_L1:
MvavC 32,208,64,68
Ra 236,2,6144
Mvav 32,212,96
MvavC 36,208,72,76
buffer_load_dwordx4 v9,s[32:35],s43 offen offset:2048 nt lds
Mvav 36,212,104
K1_p166:
s_cbranch_vccnz K1_p102
MvavC 40,208,80,84
Mvav 40,212,112
WL 4
Ra 208,1,6272
Mvav 32,216,128
s_add_u32 s10,s7,49152
Ra 212,2,6272
s_sub_u32 s11,s10,147456
Mvav 32,220,160
s_add_u32 m0,s17,3072
s_add_u32 s43,s5,3072
s_min_u32 s10,s10,s11
Mvav 36,216,136
s_sub_u32 s9,s10,s7
s_add_u32 s5,s5,24576
s_add_u32 s17,s41,s7
Mvav 36,220,168
s_mov_b32 s7,s10
v_add_u32 v3,s9,v3
v_add_u32 v4,s9,v4
Mvav 40,216,144
v_add_u32 v5,s9,v5
v_add_u32 v6,s9,v6
Mvav 40,220,176
WL 4
Ra 216,1,6400
Mvav 32,224,192
Ra 220,2,6400
Mvav 32,228,224
buffer_load_dwordx4 v7,s[32:35],s43 offen offset:0 nt lds
Mvav 36,224,200
Mvav 36,228,232
Mvav 40,224,208
Mvav 40,228,240
WL 4
Ra 224,1,12288
MvavC 48,232,64,68
K1_p167:
s_cbranch_vccnz K1_p103
Ra 228,2,12288
Mvav 48,236,96
MvavC 52,232,72,76
Mvav 52,236,104
EX 32
MvavC 56,232,80,84
EX 33
Mvav 56,236,112
WL 4
Ra 232,1,12416
CV 164,32,33
Mvav 48,208,128
Ra 236,2,12416
Mvav 48,212,160
buffer_load_dwordx4 v8,s[32:35],s43 offen offset:1024 nt lds
Mvav 52,208,136
EX 34
Mvav 52,212,168
EX 35
Mvav 56,208,144
EX 36
Mvav 56,212,176
WL 4
Ra 208,1,12544
CV 165,34,35
Mvav 48,216,192
Ra 212,2,12544
Mvav 48,220,224
EX 37
Mvav 52,216,200
EX 38
Mvav 52,220,232
EX 39
Mvav 56,216,208
EX 40
Mvav 56,220,240
WL 4
K1_p168:
s_cbranch_vccnz K1_p104
Ra 216,1,18432
CV 172,36,37
MvavC 100,224,64,68
buffer_load_dwordx4 v9,s[32:35],s43 offen offset:2048 nt lds
Mvav 100,228,96
Ra 220,2,18432
CV 173,38,39
MvavC 108,224,72,76
EX 41
Mvav 108,228,104
EX 42
MvavC 116,224,80,84
EX 43
Mvav 116,228,112
WL 4
Ra 224,1,18560
CV 180,40,41
Mvav 100,232,128
Ra 228,2,18560
CV 181,42,43
Mvav 100,236,160
EX 48
Mvav 108,232,136
EX 49
Mvav 108,236,168
EX 50
Mvav 116,232,144
EX 51
Mvav 116,236,176
WL 4
Ra 232,1,18688
CV 166,48,49
Mvav 100,208,192
Ra 236,2,18688
CV 167,50,51
Mvav 100,212,224
K1_p169:
s_cbranch_vccnz K1_p105
EX 52
Mvav 108,208,200
EX 53
Mvav 108,212,232
EX 54
Mvav 116,208,208
s_add_u32 m0,s16,0
EX 55
Mvav 116,212,240
s_waitcnt vmcnt(12) lgkmcnt(4)
s_barrier
Ta 208,3,0
MvavC 132,216,64,68
s_add_u32 s43,s4,0
Ta 210,3,6144
CV 174,52,53
Mvav 132,220,96
Ta 212,3,12288
CV 175,54,55
MvavC 140,216,72,76
Ta 214,3,18432
Mvav 140,220,104
EX 56
MvavC 148,216,80,84
buffer_load_dwordx4 v7,s[28:31],s43 offen offset:0 nt lds
Mvav 148,220,112
WL 6
Ta 216,4,0
Mvav 132,224,128
Ta 218,4,6144
Mvav 132,228,160
Ta 220,4,12288
Mvav 140,224,136
Ta 222,4,18432
Mvav 140,228,168
EX 57
Mvav 148,224,144
K1_p170:
s_cbranch_vccnz K1_p106
EX 58
Mvav 148,228,176
WL 8
Ta 224,5,0
CV 182,56,57
Mvav 132,232,192
Ta 226,5,6144
Mvav 132,236,224
Ta 228,5,12288
Mvav 140,232,200
Ta 230,5,18432
Mvav 140,236,232
buffer_load_dwordx4 v8,s[28:31],s43 offen offset:1024 nt lds
Mvav 148,232,208
EX 59
Mvav 148,236,240
Ta 232,6,0
CV 183,58,59
Maav 192,240,228
Ta 234,6,6144
Maav 192,240,16
Ta 236,6,12288
Maav 196,240,236
Ta 238,6,18432
Maav 196,240,20
EX 100
Maav 200,240,244
EX 101
Maav 200,240,24
WL 12
EX 102
Maav 0,208,228
EX 103
Maav 0,212,16
EX 108
Maav 4,208,236
K1_p171:
s_cbranch_vccnz K1_p107
buffer_load_dwordx4 v9,s[28:31],s43 offen offset:2048 nt lds
Maav 4,212,20
EX 109
Maav 8,208,244
EX 110
Maav 8,212,24
WL 8
Ta 208,3,128
CV 196,100,101
Maav 16,216,228
s_add_u32 s10,s6,49152
Ta 210,3,6272
CV 197,102,103
Maav 16,220,16
s_add_u32 m0,s16,3072
Ta 212,3,12416
CV 204,108,109
Maav 20,216,236
s_add_u32 s43,s4,3072
Ta 214,3,18560
s_sub_u32 s11,s10,147456
Maav 20,220,20
s_min_u32 s10,s10,s11
EX 111
Maav 24,216,244
s_sub_u32 s8,s10,s6
EX 116
Maav 24,220,24
WL 8
Ta 216,4,128
v_add_u32 v1,s8,v1
Maav 32,224,228
s_add_u32 s4,s4,24576
Ta 218,4,6272
v_add_u32 v2,s8,v2
Maav 32,228,16
s_add_u32 s16,s41,s6
K1_p172:
s_cbranch_vccnz K1_p108
Ta 220,4,12416
CV 205,110,111
Maav 36,224,236
s_mov_b32 s6,s10
buffer_load_dwordx4 v7,s[28:31],s43 offen offset:0 nt lds
Maav 36,228,20
Ta 222,4,18560
Maav 40,224,244
EX 117
Maav 40,228,24
WL 8
Ta 224,5,128
CV 212,116,117
Maav 48,232,228
Ta 226,5,6272
Maav 48,236,16
Ta 228,5,12416
Maav 52,232,236
Ta 230,5,18560
Maav 52,236,20
EX 118
Maav 56,232,244
EX 119
Maav 56,236,24
WL 8
Ta 232,6,128
CV 213,118,119
Maav 64,208,228
Ta 234,6,6272
Maav 64,212,16
buffer_load_dwordx4 v8,s[28:31],s43 offen offset:1024 nt lds
Maav 68,208,236
Ta 236,6,12416
Maav 68,212,20
Ta 238,6,18560
K1_p173:
s_cbranch_vccnz K1_p109
Maav 72,208,244
EX 132
Maav 72,212,24
WL 8
Ta 208,3,256
Maav 80,216,228
Ta 210,3,6400
Maav 80,220,16
Ta 212,3,12544
Maav 84,216,236
Ta 214,3,18688
Maav 84,220,20
EX 133
Maav 88,216,244
EX 134
Maav 88,220,24
WL 8
Ta 216,4,256
CV 198,132,133
Maav 96,224,228
buffer_load_dwordx4 v9,s[28:31],s43 offen offset:2048 nt lds
Maav 96,228,16
Ta 218,4,6400
Maav 100,224,236
Ta 220,4,12544
Maav 100,228,20
Ta 222,4,18688
Maav 104,224,244
EX 135
Maav 104,228,24
WL 8
Ta 224,5,256
CV 199,134,135
Maav 112,232,228
Ta 226,5,6400
K1_p174:
s_cbranch_vccnz K1_p110
Maav 112,236,16
Ta 228,5,12544
Maav 116,232,236
Ta 230,5,18688
Maav 116,236,20
EX 140
Maav 120,232,244
s_add_u32 m0,s17,0
EX 141
Maav 120,236,24
WL 8
Ta 232,6,256
CV 206,140,141
Maav 128,208,228
s_add_u32 s43,s5,0
Ta 234,6,6400
Maav 128,212,16
Ta 236,6,12544
Maav 132,208,236
Ta 238,6,18688
Maav 132,212,20
EX 142
Maav 136,208,244
buffer_load_dwordx4 v7,s[32:35],s43 offen offset:0 nt lds
Maav 136,212,24
s_waitcnt vmcnt(13) lgkmcnt(8)
s_barrier
Ra 208,1,0
Maav 144,216,228
Ra 212,2,0
Maav 144,220,16
EX 143
Maav 148,216,236
EX 148
Maav 148,220,20
EX 149
Maav 152,216,244
K1_p175:
s_cbranch_vccnz K1_p111
EX 150
Maav 152,220,24
WL 6
Ra 216,1,128
CV 207,142,143
Maav 160,224,228
Ra 220,2,128
CV 214,148,149
Maav 160,228,16
EX 151
Maav 164,224,236
CV 215,150,151
Maav 164,228,20
buffer_load_dwordx4 v8,s[32:35],s43 offen offset:1024 nt lds
Maav 168,224,244
Maav 168,228,24
WL 4
Ra 224,1,256
Maav 176,232,228
Ra 228,2,256
Maav 176,236,16
Maav 180,232,236
Maav 180,236,20
Maav 184,232,244
Maav 184,236,24
WL 4
Ra 232,1,6144
MvavC 32,208,64,68
Ra 236,2,6144
Mvav 32,212,96
MvavC 36,208,72,76
buffer_load_dwordx4 v9,s[32:35],s43 offen offset:2048 nt lds
Mvav 36,212,104
MvavC 40,208,80,84
K1_p176:
s_cbranch_vccnz K1_p208
Mvav 40,212,112
WL 4
Ra 208,1,6272
Mvav 32,216,128
s_add_u32 s10,s7,49152
Ra 212,2,6272
s_sub_u32 s11,s10,147456
Mvav 32,220,160
s_add_u32 m0,s17,3072
s_add_u32 s43,s5,3072
s_min_u32 s10,s10,s11
Mvav 36,216,136
s_sub_u32 s9,s10,s7
s_add_u32 s5,s5,24576
s_add_u32 s17,s41,s7
Mvav 36,220,168
s_mov_b32 s7,s10
v_add_u32 v3,s9,v3
v_add_u32 v4,s9,v4
Mvav 40,216,144
v_add_u32 v5,s9,v5
v_add_u32 v6,s9,v6
Mvav 40,220,176
WL 4
Ra 216,1,6400
Mvav 32,224,192
Ra 220,2,6400
Mvav 32,228,224
buffer_load_dwordx4 v7,s[32:35],s43 offen offset:0 nt lds
Mvav 36,224,200
Mvav 36,228,232
Mvav 40,224,208
Mvav 40,228,240
WL 4
Ra 224,1,12288
MvavC 48,232,64,68
Ra 228,2,12288
K1_p177:
s_cbranch_vccnz K1_p209
Mvav 48,236,96
MvavC 52,232,72,76
Mvav 52,236,104
EX 32
MvavC 56,232,80,84
EX 33
Mvav 56,236,112
WL 4
Ra 232,1,12416
CV 228,32,33
Mvav 48,208,128
Ra 236,2,12416
Mvav 48,212,160
buffer_load_dwordx4 v8,s[32:35],s43 offen offset:1024 nt lds
Mvav 52,208,136
EX 34
Mvav 52,212,168
EX 35
Mvav 56,208,144
EX 36
Mvav 56,212,176
WL 4
Ra 208,1,12544
CV 229,34,35
Mvav 48,216,192
Ra 212,2,12544
Mvav 48,220,224
EX 37
Mvav 52,216,200
EX 38
Mvav 52,220,232
EX 39
Mvav 56,216,208
EX 40
Mvav 56,220,240
WL 4
Ra 216,1,18432
K1_p178:
s_cbranch_vccnz K1_p274
CV 236,36,37
MvavC 100,224,64,68
buffer_load_dwordx4 v9,s[32:35],s43 offen offset:2048 nt lds
Mvav 100,228,96
Ra 220,2,18432
CV 237,38,39
MvavC 108,224,72,76
EX 41
Mvav 108,228,104
EX 42
MvavC 116,224,80,84
EX 43
Mvav 116,228,112
WL 4
Ra 224,1,18560
CV 244,40,41
Mvav 100,232,128
Ra 228,2,18560
CV 245,42,43
Mvav 100,236,160
EX 48
Mvav 108,232,136
EX 49
Mvav 108,236,168
EX 50
Mvav 116,232,144
EX 51
Mvav 116,236,176
WL 4
Ra 232,1,18688
CV 230,48,49
Mvav 100,208,192
Ra 236,2,18688
CV 231,50,51
Mvav 100,212,224
EX 52
Mvav 108,208,200
K1_p179:
s_cbranch_vccnz K1_p275
EX 53
Mvav 108,212,232
EX 54
Mvav 116,208,208
s_add_u32 m0,s16,0
EX 55
Mvav 116,212,240
s_waitcnt vmcnt(12) lgkmcnt(4)
s_barrier
Ta 208,3,0
MvavC 132,216,64,68
s_add_u32 s43,s4,0
Ta 210,3,6144
CV 238,52,53
Mvav 132,220,96
Ta 212,3,12288
CV 239,54,55
MvavC 140,216,72,76
Ta 214,3,18432
Mvav 140,220,104
EX 56
MvavC 148,216,80,84
buffer_load_dwordx4 v7,s[28:31],s43 offen offset:0 nt lds
Mvav 148,220,112
WL 6
Ta 216,4,0
Mvav 132,224,128
Ta 218,4,6144
Mvav 132,228,160
Ta 220,4,12288
Mvav 140,224,136
Ta 222,4,18432
Mvav 140,228,168
EX 57
Mvav 148,224,144
EX 58
Mvav 148,228,176
K1_p180:
s_cbranch_vccnz K1_p276
WL 8
Ta 224,5,0
CV 246,56,57
Mvav 132,232,192
Ta 226,5,6144
Mvav 132,236,224
Ta 228,5,12288
Mvav 140,232,200
Ta 230,5,18432
Mvav 140,236,232
buffer_load_dwordx4 v8,s[28:31],s43 offen offset:1024 nt lds
Mvav 148,232,208
EX 59
Mvav 148,236,240
Ta 232,6,0
CV 247,58,59
s_cmp_eq_u32 s3,6
s_cbranch_scc1 K1q3_L1_x
s_add_u32 s3,s3,1
Maav 192,240,164
Ta 234,6,6144
Maav 192,240,196
Ta 236,6,12288
Maav 196,240,172
Ta 238,6,18432
Maav 196,240,204
EX 100
Maav 200,240,180
EX 101
Maav 200,240,212
WL 12
EX 102
Maav 0,208,164
EX 103
Maav 0,212,196
EX 108
Maav 4,208,172
K1_p181:
s_cbranch_vccnz K1_p277
buffer_load_dwordx4 v9,s[28:31],s43 offen offset:2048 nt lds
Maav 4,212,204
EX 109
Maav 8,208,180
EX 110
Maav 8,212,212
WL 8
Ta 208,3,128
CV 16,100,101
Maav 16,216,164
s_add_u32 s10,s6,49152
Ta 210,3,6272
CV 17,102,103
Maav 16,220,196
s_add_u32 m0,s16,3072
Ta 212,3,12416
CV 20,108,109
Maav 20,216,172
s_add_u32 s43,s4,3072
Ta 214,3,18560
s_sub_u32 s11,s10,147456
Maav 20,220,204
s_min_u32 s10,s10,s11
EX 111
Maav 24,216,180
s_sub_u32 s8,s10,s6
EX 116
Maav 24,220,212
WL 8
Ta 216,4,128
v_add_u32 v1,s8,v1
Maav 32,224,164
s_add_u32 s4,s4,24576
Ta 218,4,6272
v_add_u32 v2,s8,v2
Maav 32,228,196
K1_p182:
s_cbranch_vccnz K1_p278
s_add_u32 s16,s41,s6
Ta 220,4,12416
CV 21,110,111
Maav 36,224,172
s_mov_b32 s6,s10
buffer_load_dwordx4 v7,s[28:31],s43 offen offset:0 nt lds
Maav 36,228,204
Ta 222,4,18560
Maav 40,224,180
EX 117
Maav 40,228,212
WL 8
Ta 224,5,128
CV 24,116,117
Maav 48,232,164
Ta 226,5,6272
Maav 48,236,196
Ta 228,5,12416
Maav 52,232,172
Ta 230,5,18560
Maav 52,236,204
EX 118
Maav 56,232,180
EX 119
Maav 56,236,212
WL 8
Ta 232,6,128
CV 25,118,119
Maav 64,208,164
Ta 234,6,6272
Maav 64,212,196
buffer_load_dwordx4 v8,s[28:31],s43 offen offset:1024 nt lds
Maav 68,208,172
Ta 236,6,12416
Maav 68,212,204
K1_p183:
s_cbranch_vccnz K1_p279
Ta 238,6,18560
Maav 72,208,180
EX 132
Maav 72,212,212
WL 8
Ta 208,3,256
Maav 80,216,164
Ta 210,3,6400
Maav 80,220,196
Ta 212,3,12544
Maav 84,216,172
Ta 214,3,18688
Maav 84,220,204
EX 133
Maav 88,216,180
EX 134
Maav 88,220,212
WL 8
Ta 216,4,256
CV 18,132,133
Maav 96,224,164
buffer_load_dwordx4 v9,s[28:31],s43 offen offset:2048 nt lds
Maav 96,228,196
Ta 218,4,6400
Maav 100,224,172
Ta 220,4,12544
Maav 100,228,204
Ta 222,4,18688
Maav 104,224,180
EX 135
Maav 104,228,212
WL 8
Ta 224,5,256
CV 19,134,135
Maav 112,232,164
K1_p184:
s_cbranch_vccnz K1_p280
Ta 226,5,6400
Maav 112,236,196
Ta 228,5,12544
Maav 116,232,172
Ta 230,5,18688
Maav 116,236,204
EX 140
Maav 120,232,180
s_add_u32 m0,s17,0
EX 141
Maav 120,236,212
WL 8
Ta 232,6,256
CV 22,140,141
Maav 128,208,164
s_add_u32 s43,s5,0
Ta 234,6,6400
Maav 128,212,196
Ta 236,6,12544
Maav 132,208,172
Ta 238,6,18688
Maav 132,212,204
EX 142
Maav 136,208,180
buffer_load_dwordx4 v7,s[32:35],s43 offen offset:0 nt lds
Maav 136,212,212
s_waitcnt vmcnt(13) lgkmcnt(8)
s_barrier
Ra 208,1,0
Maav 144,216,164
Ra 212,2,0
Maav 144,220,196
EX 143
Maav 148,216,172
EX 148
Maav 148,220,204
EX 149
K1_p185:
s_cbranch_vccnz K1_p281
Maav 152,216,180
EX 150
Maav 152,220,212
WL 6
Ra 216,1,128
CV 23,142,143
Maav 160,224,164
Ra 220,2,128
CV 26,148,149
Maav 160,228,196
EX 151
Maav 164,224,172
CV 27,150,151
Maav 164,228,204
buffer_load_dwordx4 v8,s[32:35],s43 offen offset:1024 nt lds
Maav 168,224,180
Maav 168,228,212
WL 4
Ra 224,1,256
Maav 176,232,164
Ra 228,2,256
Maav 176,236,196
Maav 180,232,172
Maav 180,236,204
Maav 184,232,180
Maav 184,236,212
WL 4
Ra 232,1,6144
s_branch K1q3_L1
K1q3_L1_x:
Maav 192,240,164
s_add_u32 m0,s41,73728
Ta 234,6,6144
s_mov_b32 s43,s14
Maav 192,240,196
s_add_u32 s10,s14,40960
K1_p186:
s_cbranch_vccnz K1_tr
Ta 236,6,12288
s_sub_u32 s11,s10,1966080
Maav 196,240,172
s_min_u32 s14,s10,s11
Ta 238,6,18432
s_add_u32 s10,s14,40960
Maav 196,240,204
s_sub_u32 s11,s10,1966080
buffer_load_dwordx4 v14,s[48:51],s43 offen offset:0 lds
Maav 200,240,180
s_mov_b32 s100,0x4e800000
EX 100
Maav 200,240,212
WL 12
buffer_load_dwordx4 v15,s[48:51],s43 offen offset:1024 lds
Maav 0,208,164
s_add_u32 m0,s41,75776
EX 101
Maav 0,212,196
s_mov_b32 s43,s14
EX 102
Maav 4,208,172
s_min_u32 s14,s10,s11
buffer_load_dwordx4 v14,s[48:51],s43 offen offset:0 lds
Maav 4,212,204
s_add_u32 s10,s14,40960
EX 103
Maav 8,208,180
s_sub_u32 s11,s10,1966080
EX 132
Maav 8,212,212
WL 8
Ta 208,3,128
CV 16,100,101
Maav 16,216,164
s_add_u32 s17,s41,s7
buffer_load_dwordx4 v15,s[48:51],s43 offen offset:1024 lds
K1_p187:
s_cbranch_vccnz K1_tr
Maav 16,220,196
s_add_u32 m0,s41,77824
Ta 210,3,6272
CV 17,102,103
Maav 20,216,172
s_mov_b32 s43,s14
Ta 212,3,12416
s_min_u32 s14,s10,s11
Maav 20,220,204
s_add_u32 s10,s14,40960
buffer_load_dwordx4 v14,s[48:51],s43 offen offset:0 lds
Maav 24,216,180
s_sub_u32 s11,s10,1966080
Ta 214,3,18560
Maav 24,220,212
WL 8
Ta 216,4,128
Maav 32,224,164
buffer_load_dwordx4 v15,s[48:51],s43 offen offset:1024 lds
Maav 32,228,196
s_add_u32 m0,s41,122880
Ta 218,4,6272
s_mov_b32 s43,s14
Maav 36,224,172
s_min_u32 s14,s10,s11
Ta 220,4,12416
s_add_u32 s10,s14,40960
Maav 36,228,204
s_sub_u32 s11,s10,1966080
buffer_load_dwordx4 v14,s[48:51],s43 offen offset:0 lds
Maav 40,224,180
Ta 222,4,18560
Maav 40,228,212
WL 8
Ta 224,5,128
K1_p188:
s_cbranch_vccnz K1_tr
Maav 48,232,164
buffer_load_dwordx4 v15,s[48:51],s43 offen offset:1024 lds
Maav 48,236,196
s_add_u32 m0,s41,124928
Ta 226,5,6272
s_mov_b32 s43,s14
Maav 52,232,172
s_min_u32 s14,s10,s11
Ta 228,5,12416
s_add_u32 s10,s14,40960
Maav 52,236,204
s_sub_u32 s11,s10,1966080
buffer_load_dwordx4 v14,s[48:51],s43 offen offset:0 lds
Maav 56,232,180
Ta 230,5,18560
Maav 56,236,212
WL 8
Ta 232,6,128
Maav 64,208,164
buffer_load_dwordx4 v15,s[48:51],s43 offen offset:1024 lds
Maav 64,212,196
s_add_u32 m0,s41,126976
Ta 234,6,6272
s_mov_b32 s43,s14
Maav 68,208,172
s_min_u32 s14,s10,s11
Ta 236,6,12416
s_add_u32 s10,s14,40960
Maav 68,212,204
s_sub_u32 s11,s10,1966080
buffer_load_dwordx4 v14,s[48:51],s43 offen offset:0 lds
Maav 72,208,180
Ta 238,6,18560
Maav 72,212,212
K1_p189:
s_cbranch_vccnz K1_tr
WL 8
Ta 208,3,256
Maav 80,216,164
buffer_load_dwordx4 v15,s[48:51],s43 offen offset:1024 lds
Maav 80,220,196
s_add_u32 m0,s41,0
Ta 210,3,6400
s_mov_b32 s43,s14
Maav 84,216,172
s_min_u32 s14,s10,s11
Ta 212,3,12544
s_add_u32 s10,s14,40960
Maav 84,220,204
s_sub_u32 s11,s10,1966080
buffer_load_dwordx4 v14,s[48:51],s43 offen offset:0 lds
Maav 88,216,180
Ta 214,3,18688
Maav 88,220,212
WL 8
Ta 216,4,256
Maav 96,224,164
buffer_load_dwordx4 v15,s[48:51],s43 offen offset:1024 lds
Maav 96,228,196
s_add_u32 m0,s41,2048
Ta 218,4,6400
s_mov_b32 s43,s14
Maav 100,224,172
s_min_u32 s14,s10,s11
Ta 220,4,12544
s_add_u32 s10,s14,40960
Maav 100,228,204
s_sub_u32 s11,s10,1966080
buffer_load_dwordx4 v14,s[48:51],s43 offen offset:0 lds
Maav 104,224,180
Ta 222,4,18688
K1_p190:
s_cbranch_vccnz K1_tr
Maav 104,228,212
WL 8
Ta 224,5,256
Maav 112,232,164
buffer_load_dwordx4 v15,s[48:51],s43 offen offset:1024 lds
Maav 112,236,196
s_add_u32 m0,s41,4096
Ta 226,5,6400
s_mov_b32 s43,s14
Maav 116,232,172
s_min_u32 s14,s10,s11
Ta 228,5,12544
Maav 116,236,204
buffer_load_dwordx4 v14,s[48:51],s43 offen offset:0 lds
Maav 120,232,180
Ta 230,5,18688
Maav 120,236,212
WL 8
Ta 232,6,256
Maav 128,208,164
buffer_load_dwordx4 v15,s[48:51],s43 offen offset:1024 lds
Maav 128,212,196
Ta 234,6,6400
Maav 132,208,172
s_add_u32 m0,s41,24576
Ta 236,6,12544
s_mov_b32 s43,s14
Maav 132,212,204
s_add_u32 s10,s14,40960
Ta 238,6,18688
s_sub_u32 s11,s10,1966080
Maav 136,208,180
s_min_u32 s14,s10,s11
EX 133
Maav 136,212,212
K1_p191:
s_cbranch_vccnz K1_tr
s_waitcnt vmcnt(20) lgkmcnt(8)
s_barrier
CV 18,132,133
Maav 144,216,164
EX 134
Maav 144,220,196
EX 135
Maav 148,216,172
s_add_u32 s10,s14,40960
buffer_load_dwordx4 v14,s[48:51],s43 offen offset:0 lds
Maav 148,220,204
s_sub_u32 s11,s10,1966080
EX 108
Maav 152,216,180
EX 109
Maav 152,220,212
WL 4
buffer_load_dwordx4 v15,s[48:51],s43 offen offset:1024 lds
Maav 160,224,164
s_add_u32 m0,s41,26624
s_mov_b32 s43,s14
s_min_u32 s14,s10,s11
Maav 160,228,196
EX 110
Maav 164,224,172
s_add_u32 s10,s14,40960
s_sub_u32 s11,s10,1966080
buffer_load_dwordx4 v14,s[48:51],s43 offen offset:0 lds
Maav 164,228,204
EX 111
Maav 168,224,180
CV 19,134,135
CV 20,108,109
Maav 168,228,212
WL 0
buffer_load_dwordx4 v15,s[48:51],s43 offen offset:1024 lds
Maav 176,232,164
K1_p192:
s_cbranch_vccnz K1_p256
s_mov_b32 s43,s14
s_min_u32 s14,s10,s11
s_add_u32 s10,s7,49152
s_sub_u32 s11,s10,147456
s_min_u32 s10,s10,s11
s_sub_u32 s9,s10,s7
Maav 176,236,196
s_add_u32 m0,s41,28672
v_add_u32 v3,s9,v3
v_add_u32 v4,s9,v4
Maav 180,232,172
s_mov_b32 s7,s10
Ta 208,3,0
CV 21,110,111
Ta 210,3,6144
Ta 212,3,12288
Ta 214,3,18432
Ta 216,4,0
Ta 218,4,6144
Ta 220,4,12288
Ta 222,4,18432
Maav 180,236,204
buffer_load_dwordx4 v14,s[48:51],s43 offen offset:0 lds
Maav 184,232,180
EX 140
Maav 184,236,212
EX 141
EX 142
EX 143
Maav 192,240,228
buffer_load_dwordx4 v15,s[48:51],s43 offen offset:1024 lds
CV 22,140,141
CV 23,142,143
v_add_u32 v5,s9,v5
Maav 192,240,16
Ta 224,5,0
v_add_u32 v6,s9,v6
EX 116
EX 117
K1_p193:
s_cbranch_vccnz K1_p257
EX 118
EX 119
EX 148
EX 149
EX 150
EX 151
Ta 226,5,6144
Ta 228,5,12288
Ta 230,5,18432
Maav 196,240,236
Ta 232,6,0
CV 24,116,117
CV 25,118,119
CV 26,148,149
CV 27,150,151
Maav 196,240,20
Ta 234,6,6144
Maav 200,240,244
Ta 236,6,12288
Maav 200,240,24
WL 11
Ta 238,6,18432
v_accvgpr_read_b32 v68,a192
Maav 0,208,228
Maav 0,212,16
v_accvgpr_read_b32 v69,a196
v_add_f32 v11,v68,v69
Maav 4,208,236
v_rcp_f32 v68,v68
Maav 4,212,20
v_rcp_f32 v69,v69
Maav 8,208,244
v_accvgpr_read_b32 v70,a200
v_add_f32 v11,v11,v70
Maav 8,212,24
WL 8
Ta 208,3,128
v_cmp_nge_f32 s[100:101],s100,v11
K1_p194:
s_cbranch_vccnz K1_p258
Maav 16,216,228
s_or_b32 s100,s100,s101
Ta 210,3,6272
v_accvgpr_read_b32 v100,a0
v_accvgpr_read_b32 v101,a1
v_accvgpr_read_b32 v102,a2
v_accvgpr_read_b32 v103,a3
Maav 16,220,16
Ta 212,3,12416
v_mov_b32 v11,s100
v_mul_f32 v100,v100,v68
v_mul_f32 v101,v101,v68
v_mul_f32 v102,v102,v68
Maav 20,216,236
Ta 214,3,18560
v_mul_f32 v103,v103,v68
CV 100,100,101
CV 101,102,103
v_accvgpr_read_b32 v108,a4
Maav 20,220,20
ds_write_b32 v12,v11
v_accvgpr_read_b32 v109,a5
v_accvgpr_read_b32 v110,a6
v_accvgpr_read_b32 v111,a7
v_mul_f32 v108,v108,v69
Maav 24,216,244
v_rcp_f32 v70,v70
v_mul_f32 v109,v109,v69
v_mul_f32 v110,v110,v69
v_mul_f32 v111,v111,v69
Maav 24,220,24
WL 9
Ta 216,4,128
CV 108,108,109
CV 109,110,111
v_accvgpr_read_b32 v116,a8
v_accvgpr_read_b32 v117,a9
K1_p195:
s_cbranch_vccnz K1_p259
Maav 32,224,228
Ta 218,4,6272
v_accvgpr_read_b32 v118,a10
v_accvgpr_read_b32 v119,a11
v_mul_f32 v116,v116,v70
v_mul_f32 v117,v117,v70
Maav 32,228,16
Ta 220,4,12416
v_mul_f32 v118,v118,v70
v_mul_f32 v119,v119,v70
CV 116,116,117
CV 117,118,119
Maav 36,224,236
Ta 222,4,18560
v_accvgpr_read_b32 v124,a16
v_accvgpr_read_b32 v125,a17
v_accvgpr_read_b32 v126,a18
v_accvgpr_read_b32 v127,a19
Maav 36,228,20
v_mul_f32 v124,v124,v68
v_mul_f32 v125,v125,v68
v_mul_f32 v126,v126,v68
v_mul_f32 v127,v127,v68
CV 102,124,125
Maav 40,224,244
CV 103,126,127
v_accvgpr_read_b32 v132,a20
v_accvgpr_read_b32 v133,a21
v_accvgpr_read_b32 v134,a22
v_accvgpr_read_b32 v135,a23
Maav 40,228,24
WL 9
Ta 224,5,128
v_mul_f32 v132,v132,v69
v_mul_f32 v133,v133,v69
v_mul_f32 v134,v134,v69
v_mul_f32 v135,v135,v69
Maav 48,232,228
K1_p196:
s_cbranch_vccnz K1_p260
Ta 226,5,6272
CV 110,132,133
CV 111,134,135
v_accvgpr_read_b32 v140,a24
v_accvgpr_read_b32 v141,a25
Maav 48,236,16
Ta 228,5,12416
v_accvgpr_read_b32 v142,a26
v_accvgpr_read_b32 v143,a27
v_mul_f32 v140,v140,v70
v_mul_f32 v141,v141,v70
Maav 52,232,236
Ta 230,5,18560
v_mul_f32 v142,v142,v70
v_mul_f32 v143,v143,v70
CV 118,140,141
CV 119,142,143
Maav 52,236,20
buffer_store_dwordx4 v[100:103],v10,s[36:39],s56 offen offset:0 sc1
v_accvgpr_read_b32 v148,a32
v_accvgpr_read_b32 v149,a33
v_accvgpr_read_b32 v150,a34
Maav 56,232,244
buffer_store_dwordx4 v[108:111],v10,s[36:39],s58 offen offset:0 sc1
v_accvgpr_read_b32 v151,a35
v_mul_f32 v148,v148,v68
v_mul_f32 v149,v149,v68
Maav 56,236,24
WL 9
Ta 232,6,128
v_mul_f32 v150,v150,v68
v_mul_f32 v151,v151,v68
CV 148,148,149
CV 149,150,151
Maav 64,208,228
Ta 234,6,6272
K1_p197:
s_cbranch_vccnz K1_p261
v_accvgpr_read_b32 v156,a36
v_accvgpr_read_b32 v157,a37
v_accvgpr_read_b32 v158,a38
v_accvgpr_read_b32 v159,a39
Maav 64,212,16
Ta 236,6,12416
v_mul_f32 v156,v156,v69
v_mul_f32 v157,v157,v69
v_mul_f32 v158,v158,v69
v_mul_f32 v159,v159,v69
Maav 68,208,236
Ta 238,6,18560
CV 156,156,157
CV 157,158,159
v_accvgpr_read_b32 v164,a40
v_accvgpr_read_b32 v165,a41
Maav 68,212,20
buffer_store_dwordx4 v[116:119],v10,s[36:39],s60 offen offset:0 sc1
v_accvgpr_read_b32 v166,a42
v_accvgpr_read_b32 v167,a43
v_mul_f32 v164,v164,v70
Maav 72,208,244
v_mul_f32 v165,v165,v70
v_mul_f32 v166,v166,v70
v_mul_f32 v167,v167,v70
CV 164,164,165
CV 165,166,167
Maav 72,212,24
WL 8
Ta 208,3,256
v_accvgpr_read_b32 v172,a48
v_accvgpr_read_b32 v173,a49
v_accvgpr_read_b32 v174,a50
v_accvgpr_read_b32 v175,a51
Maav 80,216,228
Ta 210,3,6400
K1_p198:
s_cbranch_vccnz K1_p262
v_mul_f32 v172,v172,v68
v_mul_f32 v173,v173,v68
v_mul_f32 v174,v174,v68
v_mul_f32 v175,v175,v68
Maav 80,220,16
Ta 212,3,12544
CV 150,172,173
CV 151,174,175
v_accvgpr_read_b32 v180,a52
v_accvgpr_read_b32 v181,a53
Maav 84,216,236
s_add_u32 m0,s41,49152
Ta 214,3,18688
v_accvgpr_read_b32 v182,a54
v_accvgpr_read_b32 v183,a55
v_mul_f32 v180,v180,v69
v_mul_f32 v181,v181,v69
Maav 84,220,20
s_mov_b32 s43,s14
buffer_store_dwordx4 v[148:151],v10,s[36:39],s56 offen offset:1024 sc1
v_mul_f32 v182,v182,v69
v_mul_f32 v183,v183,v69
CV 158,180,181
Maav 88,216,244
s_add_u32 s10,s14,40960
CV 159,182,183
v_accvgpr_read_b32 v188,a56
v_accvgpr_read_b32 v189,a57
v_accvgpr_read_b32 v190,a58
v_accvgpr_read_b32 v191,a59
Maav 88,220,24
WL 8
WL 15
s_barrier
Ta 216,4,256
v_mul_f32 v188,v188,v70
v_mul_f32 v189,v189,v70
Maav 96,224,228
s_sub_u32 s11,s10,1966080
K1_p199:
s_cbranch_vccnz K1_p263
ds_read_b128 v[76:79],v13
v_mul_f32 v190,v190,v70
v_mul_f32 v191,v191,v70
CV 166,188,189
CV 167,190,191
Maav 96,228,16
s_min_u32 s14,s10,s11
Ta 218,4,6400
v_accvgpr_read_b32 v196,a64
v_accvgpr_read_b32 v197,a65
v_accvgpr_read_b32 v198,a66
v_accvgpr_read_b32 v199,a67
Maav 100,224,236
s_add_u32 s10,s14,40960
Ta 220,4,12544
v_mul_f32 v196,v196,v68
v_mul_f32 v197,v197,v68
v_mul_f32 v198,v198,v68
v_mul_f32 v199,v199,v68
Maav 100,228,20
s_sub_u32 s11,s10,1966080
buffer_load_dwordx4 v14,s[48:51],s43 offen offset:0 lds
CV 196,196,197
CV 197,198,199
v_accvgpr_read_b32 v204,a68
Maav 104,224,244
Ta 222,4,18688
v_accvgpr_read_b32 v205,a69
v_accvgpr_read_b32 v206,a70
v_accvgpr_read_b32 v207,a71
v_mul_f32 v204,v204,v69
Maav 104,228,24
WL 9
Ta 224,5,256
v_mul_f32 v205,v205,v69
v_mul_f32 v206,v206,v69
v_mul_f32 v207,v207,v69
K1_p200:
s_cbranch_vccnz K1_p264
CV 204,204,205
Maav 112,232,228
buffer_load_dwordx4 v15,s[48:51],s43 offen offset:1024 lds
CV 205,206,207
v_accvgpr_read_b32 v212,a72
v_accvgpr_read_b32 v213,a73
Maav 112,236,16
s_add_u32 m0,s41,51200
Ta 226,5,6400
v_accvgpr_read_b32 v214,a74
v_accvgpr_read_b32 v215,a75
v_mul_f32 v212,v212,v70
v_mul_f32 v213,v213,v70
Maav 116,232,236
s_mov_b32 s43,s14
Ta 228,5,12544
v_mul_f32 v214,v214,v70
v_mul_f32 v215,v215,v70
CV 212,212,213
CV 213,214,215
Maav 116,236,20
s_min_u32 s14,s10,s11
buffer_load_dwordx4 v14,s[48:51],s43 offen offset:0 lds
v_accvgpr_read_b32 v220,a80
v_accvgpr_read_b32 v221,a81
v_accvgpr_read_b32 v222,a82
Maav 120,232,244
s_add_u32 s10,s14,40960
Ta 230,5,18688
v_accvgpr_read_b32 v223,a83
v_mul_f32 v220,v220,v68
v_mul_f32 v221,v221,v68
v_mul_f32 v222,v222,v68
Maav 120,236,24
WL 9
Ta 232,6,256
v_mul_f32 v223,v223,v68
K1_p201:
s_cbranch_vccnz K1_p265
CV 198,220,221
CV 199,222,223
v_accvgpr_read_b32 v84,a84
Maav 128,208,228
s_sub_u32 s11,s10,1966080
buffer_load_dwordx4 v15,s[48:51],s43 offen offset:1024 lds
v_accvgpr_read_b32 v85,a85
v_accvgpr_read_b32 v86,a86
v_accvgpr_read_b32 v87,a87
Maav 128,212,16
s_add_u32 m0,s41,53248
Ta 234,6,6400
v_mul_f32 v84,v84,v69
v_mul_f32 v85,v85,v69
v_mul_f32 v86,v86,v69
v_mul_f32 v87,v87,v69
Maav 132,208,236
s_mov_b32 s43,s14
Ta 236,6,12544
CV 206,84,85
CV 207,86,87
v_accvgpr_read_b32 v92,a88
v_accvgpr_read_b32 v93,a89
Maav 132,212,20
s_min_u32 s14,s10,s11
buffer_load_dwordx4 v14,s[48:51],s43 offen offset:0 lds
v_accvgpr_read_b32 v94,a90
v_accvgpr_read_b32 v95,a91
v_mul_f32 v92,v92,v70
Maav 136,208,244
Ta 238,6,18688
v_mul_f32 v93,v93,v70
v_mul_f32 v94,v94,v70
v_mul_f32 v95,v95,v70
CV 214,92,93
Maav 136,212,24
WL 8
K1_p202:
s_cbranch_vccnz K1_p266
buffer_load_dwordx4 v15,s[48:51],s43 offen offset:1024 lds
CV 215,94,95
v_accvgpr_read_b32 v100,a96
v_accvgpr_read_b32 v101,a97
Maav 144,216,228
WL 11
buffer_store_dwordx4 v[156:159],v10,s[36:39],s58 offen offset:1024 sc1
v_accvgpr_read_b32 v102,a98
v_accvgpr_read_b32 v103,a99
v_mul_f32 v100,v100,v68
Maav 144,220,16
buffer_store_dwordx4 v[164:167],v10,s[36:39],s60 offen offset:1024 sc1
v_mul_f32 v101,v101,v68
v_mul_f32 v102,v102,v68
v_mul_f32 v103,v103,v68
Maav 148,216,236
buffer_store_dwordx4 v[196:199],v10,s[36:39],s56 offen offset:2048 sc1
CV 100,100,101
CV 101,102,103
v_accvgpr_read_b32 v108,a100
Maav 148,220,20
buffer_store_dwordx4 v[204:207],v10,s[36:39],s58 offen offset:2048 sc1
v_accvgpr_read_b32 v109,a101
v_accvgpr_read_b32 v110,a102
v_accvgpr_read_b32 v111,a103
Maav 152,216,244
buffer_store_dwordx4 v[212:215],v10,s[36:39],s60 offen offset:2048 sc1
v_mul_f32 v108,v108,v69
v_mul_f32 v109,v109,v69
v_mul_f32 v110,v110,v69
Maav 152,220,24
WL 4
v_mul_f32 v111,v111,v69
CV 108,108,109
CV 109,110,111
v_accvgpr_read_b32 v116,a104
v_accvgpr_read_b32 v117,a105
K1_p203:
s_cbranch_vccnz K1_p267
Maav 160,224,228
v_accvgpr_read_b32 v118,a106
v_accvgpr_read_b32 v119,a107
v_mul_f32 v116,v116,v70
v_mul_f32 v117,v117,v70
v_mul_f32 v118,v118,v70
Maav 160,228,16
v_mul_f32 v119,v119,v70
CV 116,116,117
CV 117,118,119
v_accvgpr_read_b32 v124,a112
v_accvgpr_read_b32 v125,a113
Maav 164,224,236
v_accvgpr_read_b32 v126,a114
v_accvgpr_read_b32 v127,a115
v_mul_f32 v124,v124,v68
v_mul_f32 v125,v125,v68
v_mul_f32 v126,v126,v68
Maav 164,228,20
v_mul_f32 v127,v127,v68
CV 102,124,125
CV 103,126,127
v_accvgpr_read_b32 v132,a116
v_accvgpr_read_b32 v133,a117
Maav 168,224,244
buffer_store_dwordx4 v[100:103],v10,s[36:39],s56 offen offset:3072 sc1
v_accvgpr_read_b32 v134,a118
v_accvgpr_read_b32 v135,a119
v_mul_f32 v132,v132,v69
Maav 168,228,24
WL 0
v_mul_f32 v133,v133,v69
v_mul_f32 v134,v134,v69
v_mul_f32 v135,v135,v69
CV 110,132,133
CV 111,134,135
Maav 176,232,228
buffer_store_dwordx4 v[108:111],v10,s[36:39],s58 offen offset:3072 sc1
K1_p204:
s_cbranch_vccnz K1_p268
v_accvgpr_read_b32 v140,a120
v_accvgpr_read_b32 v141,a121
v_accvgpr_read_b32 v142,a122
Maav 176,236,16
v_accvgpr_read_b32 v143,a123
v_mul_f32 v140,v140,v70
v_mul_f32 v141,v141,v70
v_mul_f32 v142,v142,v70
v_mul_f32 v143,v143,v70
Maav 180,232,236
CV 118,140,141
CV 119,142,143
v_or_b32 v76,v76,v77
v_or3_b32 v76,v76,v78,v79
s_nop 0
v_readfirstlane_b32 s100,v76
Maav 180,236,20
buffer_store_dwordx4 v[116:119],v10,s[36:39],s60 offen offset:3072 sc1
v_accvgpr_read_b32 v32,a128
v_accvgpr_read_b32 v33,a129
v_accvgpr_read_b32 v34,a130
Maav 184,232,244
v_accvgpr_read_b32 v35,a131
v_mul_f32 v32,v32,v68
v_mul_f32 v33,v33,v68
v_mul_f32 v34,v34,v68
v_mul_f32 v35,v35,v68
Maav 184,236,24
CV 32,32,33
CV 33,34,35
v_accvgpr_read_b32 v36,a132
v_accvgpr_read_b32 v37,a133
v_accvgpr_read_b32 v38,a134
v_accvgpr_read_b32 v39,a135
v_mul_f32 v36,v36,v69
v_mul_f32 v37,v37,v69
v_mul_f32 v38,v38,v69
v_mul_f32 v39,v39,v69
CV 36,36,37
K1_p205:
s_cbranch_vccnz K1_p269
CV 37,38,39
v_accvgpr_read_b32 v40,a136
v_accvgpr_read_b32 v41,a137
v_accvgpr_read_b32 v42,a138
v_accvgpr_read_b32 v43,a139
v_mul_f32 v40,v40,v70
v_mul_f32 v41,v41,v70
v_mul_f32 v42,v42,v70
v_mul_f32 v43,v43,v70
CV 40,40,41
CV 41,42,43
v_accvgpr_read_b32 v148,a144
v_accvgpr_read_b32 v149,a145
v_accvgpr_read_b32 v150,a146
v_accvgpr_read_b32 v151,a147
v_mul_f32 v148,v148,v68
v_mul_f32 v149,v149,v68
v_mul_f32 v150,v150,v68
v_mul_f32 v151,v151,v68
CV 34,148,149
CV 35,150,151
v_accvgpr_read_b32 v156,a148
v_accvgpr_read_b32 v157,a149
v_accvgpr_read_b32 v158,a150
v_accvgpr_read_b32 v159,a151
v_mul_f32 v156,v156,v69
v_mul_f32 v157,v157,v69
v_mul_f32 v158,v158,v69
v_mul_f32 v159,v159,v69
CV 38,156,157
CV 39,158,159
v_accvgpr_read_b32 v164,a152
v_accvgpr_read_b32 v165,a153
v_accvgpr_read_b32 v166,a154
v_accvgpr_read_b32 v167,a155
v_mul_f32 v164,v164,v70
v_mul_f32 v165,v165,v70
v_mul_f32 v166,v166,v70
v_mul_f32 v167,v167,v70
K1_p206:
s_cbranch_vccnz K1_p270
CV 42,164,165
CV 43,166,167
v_accvgpr_read_b32 v48,a160
v_accvgpr_read_b32 v49,a161
v_accvgpr_read_b32 v50,a162
v_accvgpr_read_b32 v51,a163
v_mul_f32 v48,v48,v68
v_mul_f32 v49,v49,v68
v_mul_f32 v50,v50,v68
v_mul_f32 v51,v51,v68
CV 48,48,49
CV 49,50,51
v_accvgpr_read_b32 v52,a164
v_accvgpr_read_b32 v53,a165
v_accvgpr_read_b32 v54,a166
v_accvgpr_read_b32 v55,a167
v_mul_f32 v52,v52,v69
v_mul_f32 v53,v53,v69
v_mul_f32 v54,v54,v69
v_mul_f32 v55,v55,v69
CV 52,52,53
CV 53,54,55
v_accvgpr_read_b32 v56,a168
v_accvgpr_read_b32 v57,a169
v_accvgpr_read_b32 v58,a170
v_accvgpr_read_b32 v59,a171
v_mul_f32 v56,v56,v70
v_mul_f32 v57,v57,v70
v_mul_f32 v58,v58,v70
v_mul_f32 v59,v59,v70
CV 56,56,57
CV 57,58,59
v_accvgpr_read_b32 v172,a176
v_accvgpr_read_b32 v173,a177
v_accvgpr_read_b32 v174,a178
v_accvgpr_read_b32 v175,a179
v_mul_f32 v172,v172,v68
v_mul_f32 v173,v173,v68
v_mul_f32 v174,v174,v68
K1_p207:
s_cbranch_vccnz K1_p271
v_mul_f32 v175,v175,v68
CV 50,172,173
CV 51,174,175
v_accvgpr_read_b32 v180,a180
v_accvgpr_read_b32 v181,a181
v_accvgpr_read_b32 v182,a182
v_accvgpr_read_b32 v183,a183
v_mul_f32 v180,v180,v69
v_mul_f32 v181,v181,v69
v_mul_f32 v182,v182,v69
v_mul_f32 v183,v183,v69
CV 54,180,181
CV 55,182,183
v_accvgpr_read_b32 v188,a184
v_accvgpr_read_b32 v189,a185
v_accvgpr_read_b32 v190,a186
v_accvgpr_read_b32 v191,a187
v_mul_f32 v188,v188,v70
v_mul_f32 v189,v189,v70
v_mul_f32 v190,v190,v70
v_mul_f32 v191,v191,v70
CV 58,188,189
CV 59,190,191
s_cmp_lg_u32 s100,0
s_cbranch_scc1 K1_fb
s_waitcnt vmcnt(18)
K1_done:
buffer_store_dwordx4 v[32:35],v10,s[36:39],s57 offen offset:0 sc1
buffer_store_dwordx4 v[36:39],v10,s[36:39],s59 offen offset:0 sc1
buffer_store_dwordx4 v[40:43],v10,s[36:39],s61 offen offset:0 sc1
buffer_store_dwordx4 v[44:47],v10,s[36:39],s63 offen offset:0 sc1
buffer_store_dwordx4 v[48:51],v10,s[36:39],s57 offen offset:1024 sc1
buffer_store_dwordx4 v[52:55],v10,s[36:39],s59 offen offset:1024 sc1
buffer_store_dwordx4 v[56:59],v10,s[36:39],s61 offen offset:1024 sc1
buffer_store_dwordx4 v[60:63],v10,s[36:39],s63 offen offset:1024 sc1
s_load_dwordx2 s[28:29],s[0:1],40
s_bfe_u32 s44,s2,0x20001
s_lshr_b32 s4,s40,1
s_mul_i32 s4,s4,12288
K1_p208:
s_cbranch_vccnz K1_tr
s_lshl_b32 s5,s40,1
s_xor_b32 s5,s5,s44
s_and_b32 s6,s44,2
s_xor_b32 s5,s5,s6
s_and_b32 s5,s5,3
s_lshl_b32 s5,s5,5
v_and_b32 v24,63,v0
v_lshrrev_b32 v25,2,v24
v_and_b32 v26,6,v25
v_bfe_u32 v27,v24,1,1
v_xor_b32 v26,v26,v27
v_lshlrev_b32 v26,4,v26
v_lshl_add_u32 v26,v25,7,v26
v_and_b32 v27,1,v24
v_lshl_add_u32 v26,v27,3,v26
v_xor_b32 v26,s5,v26
v_add_u32 v12,s4,v26
v_xor_b32 v13,32,v12
v_add_u32 v14,73728,v12
v_add_u32 v15,73728,v13
v_lshrrev_b32 v28,6,v0
s_bfe_u32 s4,s2,0x20001
s_mul_i32 s4,s4,1536
v_lshrrev_b32 v25,3,v24
v_and_b32 v26,6,v25
v_and_b32 v27,7,v24
v_xor_b32 v26,v26,v27
v_and_b32 v27,1,v28
v_lshl_add_u32 v25,v27,4,v25
v_add_u32 v25,s4,v25
v_mul_u32_u24 v25,1280,v25
v_lshl_add_u32 v25,v26,4,v25
v_lshrrev_b32 v27,1,v28
v_lshl_add_u32 v6,v27,7,v25
v_add_u32 v7,9216,v6
WL 0
s_barrier
s_add_u32 m0,s41,98304
s_nop 0
buffer_load_dwordx4 v6,s[48:51],s14 offen offset:0 lds
buffer_load_dwordx4 v7,s[48:51],s14 offen offset:1024 lds
s_add_u32 s10,s14,40960
s_sub_u32 s11,s10,1966080
s_min_u32 s14,s10,s11
Ta 0,14,0
K1_p209:
s_cbranch_vccnz K1_tr
Ta 2,14,6144
Ta 4,15,0
Ta 6,15,6144
Ta 8,14,2048
Ta 10,14,8192
Ta 12,15,2048
Ta 14,15,8192
Ta 16,14,4096
Ta 18,14,10240
Ta 20,15,4096
Ta 22,15,10240
s_add_u32 m0,s41,100352
s_nop 0
buffer_load_dwordx4 v6,s[48:51],s14 offen offset:0 lds
buffer_load_dwordx4 v7,s[48:51],s14 offen offset:1024 lds
s_add_u32 s10,s14,40960
s_sub_u32 s11,s10,1966080
s_min_u32 s14,s10,s11
s_add_u32 m0,s41,102400
s_nop 0
buffer_load_dwordx4 v6,s[48:51],s14 offen offset:0 lds
buffer_load_dwordx4 v7,s[48:51],s14 offen offset:1024 lds
s_add_u32 s10,s14,40960
s_sub_u32 s11,s10,1966080
s_min_u32 s14,s10,s11
s_lshl_b32 s4,s46,12
s_and_b32 s5,s47,24
s_lshl_b32 s5,s5,7
s_add_u32 s4,s4,s5
s_and_b32 s5,s47,7
s_lshl_b32 s5,s5,2
s_add_u32 s4,s4,s5
v_mov_b32 v20,s4
v_mov_b32 v21,s45
s_lshr_b32 s47,s2,3
s_mul_i32 s46,s47,52
s_lshr_b32 s46,s46,8
s_mul_i32 s4,s46,5
s_sub_u32 s47,s47,s4
s_and_b32 s4,s2,1
s_mul_i32 s4,s4,6
s_add_u32 s46,s46,s4
K1_p210:
s_cbranch_vccnz K1_tr
s_mul_i32 s4,s46,1966080
s_mul_i32 s5,s44,49152
s_add_u32 s4,s4,s5
s_sub_u32 s22,23592960,s4
s_add_u32 s20,s18,s4
s_addc_u32 s21,s19,0
s_lshl_b32 s5,s47,8
s_mul_i32 s6,s46,204800
s_add_u32 s6,s6,s5
s_sub_u32 s30,2457600,s6
s_add_u32 s28,s28,s6
s_addc_u32 s29,s29,0
s_add_u32 s24,s18,23658496
s_addc_u32 s25,s19,0
s_mov_b32 s26,16777216
s_lshr_b32 s4,s44,1
s_mul_i32 s4,s4,196608
s_sub_u32 s5,196608,s4
v_lshlrev_b32 v3,4,v24
v_add_u32 v1,s4,v3
v_add_u32 v2,s5,v3
v_add_u32 v4,49152,v3
v_add_u32 v5,98304,v3
s_lshl_b32 s4,s46,1
v_bfe_u32 v22,v24,3,1
v_add_u32 v22,s4,v22
v_mul_u32_u24 v22,43,v22
v_and_b32 v22,0x380,v22
v_and_b32 v25,7,v24
s_lshl_b32 s4,s44,5
v_add_lshl_u32 v22,s4,v22,5
v_lshl_add_u32 v22,v25,2,v22
s_min_u32 s4,s40,1
s_lshl_b32 s4,s4,30
v_add_u32 v22,s4,v22
s_mov_b32 s7,40000
WL 0
s_barrier
Ta 24,14,49152
Ta 26,14,55296
Ta 28,15,49152
Ta 30,15,55296
Ta 32,14,51200
K1_p211:
s_cbranch_vccnz K1_tr
Ta 34,14,57344
Ta 36,15,51200
Ta 38,15,57344
Ta 40,14,53248
Ta 42,14,59392
Ta 44,15,53248
Ta 46,15,59392
s_add_u32 m0,s41,73728
s_nop 0
buffer_load_dwordx4 v6,s[48:51],s14 offen offset:0 lds
buffer_load_dwordx4 v7,s[48:51],s14 offen offset:1024 lds
s_add_u32 s10,s14,40960
s_sub_u32 s11,s10,1966080
s_min_u32 s14,s10,s11
s_add_u32 m0,s41,75776
s_nop 0
buffer_load_dwordx4 v6,s[48:51],s14 offen offset:0 lds
buffer_load_dwordx4 v7,s[48:51],s14 offen offset:1024 lds
s_add_u32 s10,s14,40960
s_sub_u32 s11,s10,1966080
s_min_u32 s14,s10,s11
s_add_u32 m0,s41,77824
s_nop 0
buffer_load_dwordx4 v6,s[48:51],s14 offen offset:0 lds
buffer_load_dwordx4 v7,s[48:51],s14 offen offset:1024 lds
s_add_u32 s10,s14,40960
s_sub_u32 s11,s10,1966080
s_min_u32 s14,s10,s11
WL 0
s_waitcnt vmcnt(12)
s_barrier
s_cmp_lg_u32 s40,0
s_cbranch_scc1 K2_pub
s_mov_b64 exec,1
buffer_store_dword v21,v20,s[52:55],0 offen sc1
s_mov_b64 exec,-1
K2_pub:
s_cmp_ge_u32 s2,240
s_cbranch_scc1 K2_rest
K1_p212:
s_cbranch_vccnz K1_tr
Ta 48,12,0
Ta 50,12,6144
Ta 52,13,0
Ta 54,13,6144
Ta 56,12,2048
Ta 58,12,8192
Ta 60,13,2048
Ta 62,13,8192
Ta 64,12,4096
Ta 66,12,10240
Ta 68,13,4096
Ta 70,13,10240
s_add_u32 m0,s41,122880
s_nop 0
buffer_load_dwordx4 v6,s[48:51],s14 offen offset:0 lds
buffer_load_dwordx4 v7,s[48:51],s14 offen offset:1024 lds
s_add_u32 s10,s14,40960
s_sub_u32 s11,s10,1966080
s_min_u32 s14,s10,s11
s_add_u32 m0,s41,124928
s_nop 0
buffer_load_dwordx4 v6,s[48:51],s14 offen offset:0 lds
buffer_load_dwordx4 v7,s[48:51],s14 offen offset:1024 lds
s_add_u32 s10,s14,40960
s_sub_u32 s11,s10,1966080
s_min_u32 s14,s10,s11
s_add_u32 m0,s41,126976
s_nop 0
buffer_load_dwordx4 v6,s[48:51],s14 offen offset:0 lds
buffer_load_dwordx4 v7,s[48:51],s14 offen offset:1024 lds
s_add_u32 s10,s14,40960
s_sub_u32 s11,s10,1966080
s_min_u32 s14,s10,s11
s_add_u32 s4,s15,s40
s_add_u32 s5,s4,0
s_and_b32 s5,s5,15
K1_p213:
s_cbranch_vccnz K1_tr
s_mul_i32 s8,s5,3072
s_add_u32 s5,s4,4
s_and_b32 s5,s5,15
s_mul_i32 s9,s5,3072
s_add_u32 s5,s4,8
s_and_b32 s5,s5,15
s_mul_i32 s12,s5,3072
s_add_u32 s5,s4,12
s_and_b32 s5,s5,15
s_mul_i32 s13,s5,3072
s_lshl_b32 s4,s40,14
s_lshl_b32 s42,s2,16
v_add_u32 v8,s4,v3
s_add_u32 s4,s4,15360
v_mov_b32 v19,s4
v_and_b32 v25,1,v24
v_lshl_add_u32 v9,v25,7,v19
v_min_u32 v25,1,v24
v_lshl_add_u32 v17,v25,30,v19
WL 0
s_barrier
Ta 72,12,24576
Ta 74,12,30720
Ta 76,13,24576
Ta 78,13,30720
Ta 80,12,26624
Ta 82,12,32768
Ta 84,13,26624
Ta 86,13,32768
Ta 88,12,28672
Ta 90,12,34816
Ta 92,13,28672
Ta 94,13,34816
s_add_u32 m0,s41,0
s_nop 0
buffer_load_dwordx4 v6,s[48:51],s14 offen offset:0 lds
buffer_load_dwordx4 v7,s[48:51],s14 offen offset:1024 lds
s_add_u32 s10,s14,40960
s_sub_u32 s11,s10,1966080
s_min_u32 s14,s10,s11
K1_p214:
s_cbranch_vccnz K1_tr
s_add_u32 m0,s41,2048
s_nop 0
buffer_load_dwordx4 v6,s[48:51],s14 offen offset:0 lds
buffer_load_dwordx4 v7,s[48:51],s14 offen offset:1024 lds
s_add_u32 s10,s14,40960
s_sub_u32 s11,s10,1966080
s_min_u32 s14,s10,s11
s_add_u32 m0,s41,4096
s_nop 0
buffer_load_dwordx4 v6,s[48:51],s14 offen offset:0 lds
buffer_load_dwordx4 v7,s[48:51],s14 offen offset:1024 lds
s_add_u32 s10,s14,40960
s_sub_u32 s11,s10,1966080
s_min_u32 s14,s10,s11
WL 0
s_waitcnt vmcnt(37)
s_barrier
Ta 96,12,49152
Ta 98,12,55296
Ta 100,13,49152
Ta 102,13,55296
Ta 104,12,51200
Ta 106,12,57344
Ta 108,13,51200
Ta 110,13,57344
Ta 112,12,53248
Ta 114,12,59392
Ta 116,13,53248
Ta 118,13,59392
s_add_u32 m0,s41,24576
s_nop 0
buffer_load_dwordx4 v6,s[48:51],s14 offen offset:0 lds
buffer_load_dwordx4 v7,s[48:51],s14 offen offset:1024 lds
s_add_u32 s10,s14,40960
s_sub_u32 s11,s10,1966080
s_min_u32 s14,s10,s11
K1_p215:
s_cbranch_vccnz K1_tr
s_add_u32 m0,s41,26624
s_nop 0
buffer_load_dwordx4 v6,s[48:51],s14 offen offset:0 lds
buffer_load_dwordx4 v7,s[48:51],s14 offen offset:1024 lds
s_add_u32 s10,s14,40960
s_sub_u32 s11,s10,1966080
s_min_u32 s14,s10,s11
s_add_u32 m0,s41,28672
s_nop 0
buffer_load_dwordx4 v6,s[48:51],s14 offen offset:0 lds
buffer_load_dwordx4 v7,s[48:51],s14 offen offset:1024 lds
s_add_u32 s10,s14,40960
s_sub_u32 s11,s10,1966080
s_min_u32 s14,s10,s11
WL 0
s_waitcnt vmcnt(24)
s_barrier
Ta 120,14,24576
Ta 122,14,30720
Ta 124,15,24576
Ta 126,15,30720
Ta 128,14,26624
Ta 130,14,32768
Ta 132,15,26624
Ta 134,15,32768
Ta 136,14,28672
Ta 138,14,34816
Ta 140,15,28672
Ta 142,15,34816
s_add_u32 m0,s41,49152
s_nop 0
buffer_load_dwordx4 v6,s[48:51],s14 offen offset:0 lds
buffer_load_dwordx4 v7,s[48:51],s14 offen offset:1024 lds
s_add_u32 s10,s14,40960
s_sub_u32 s11,s10,1966080
s_min_u32 s14,s10,s11
K1_p216:
s_cbranch_vccnz K1_tr
s_add_u32 m0,s41,51200
s_nop 0
buffer_load_dwordx4 v6,s[48:51],s14 offen offset:0 lds
buffer_load_dwordx4 v7,s[48:51],s14 offen offset:1024 lds
s_add_u32 s10,s14,40960
s_sub_u32 s11,s10,1966080
s_min_u32 s14,s10,s11
s_add_u32 m0,s41,53248
s_nop 0
buffer_load_dwordx4 v6,s[48:51],s14 offen offset:0 lds
buffer_load_dwordx4 v7,s[48:51],s14 offen offset:1024 lds
s_add_u32 s10,s14,40960
s_sub_u32 s11,s10,1966080
s_min_u32 s14,s10,s11
WL 0
s_waitcnt vmcnt(24)
s_barrier
buffer_load_dword v23,v22,s[52:55],0 offen sc1
Ta 144,14,0
Ta 146,14,6144
Ta 148,15,0
Ta 150,15,6144
Ta 152,14,2048
Ta 154,14,8192
Ta 156,15,2048
Ta 158,15,8192
Ta 160,14,4096
Ta 162,14,10240
Ta 164,15,4096
Ta 166,15,10240
s_add_u32 m0,s41,98304
s_nop 0
buffer_load_dwordx4 v6,s[48:51],s14 offen offset:0 lds
buffer_load_dwordx4 v7,s[48:51],s14 offen offset:1024 lds
s_add_u32 s10,s14,40960
s_sub_u32 s11,s10,1966080
K1_p217:
s_cbranch_vccnz K1_tr
s_min_u32 s14,s10,s11
s_add_u32 m0,s41,100352
s_nop 0
buffer_load_dwordx4 v6,s[48:51],s14 offen offset:0 lds
buffer_load_dwordx4 v7,s[48:51],s14 offen offset:1024 lds
s_add_u32 s10,s14,40960
s_sub_u32 s11,s10,1966080
s_min_u32 s14,s10,s11
s_add_u32 m0,s41,102400
s_nop 0
buffer_load_dwordx4 v6,s[48:51],s14 offen offset:0 lds
buffer_load_dwordx4 v7,s[48:51],s14 offen offset:1024 lds
s_add_u32 s10,s14,40960
s_sub_u32 s11,s10,1966080
s_min_u32 s14,s10,s11
WL 0
s_waitcnt vmcnt(25)
s_barrier
Ta 168,14,49152
Ta 170,14,55296
Ta 172,15,49152
Ta 174,15,55296
Ta 176,14,51200
Ta 178,14,57344
Ta 180,15,51200
Ta 182,15,57344
Ta 184,14,53248
Ta 186,14,59392
Ta 188,15,53248
Ta 190,15,59392
WL 0
s_waitcnt vmcnt(19)
s_barrier
Ta 192,12,0
Ta 194,12,6144
Ta 196,13,0
Ta 198,13,6144
K1_p218:
s_cbranch_vccnz K1_tr
Ta 200,12,2048
Ta 202,12,8192
Ta 204,13,2048
Ta 206,13,8192
Ta 208,12,4096
Ta 210,12,10240
Ta 212,13,4096
Ta 214,13,10240
s_waitcnt vmcnt(6)
s_cmp_lg_u32 s40,0
s_cbranch_scc1 K2_go
s_mov_b32 s7,40000
K2_chk:
v_cmp_ne_u32 s[100:101],s45,v23
s_nop 0
s_cmp_eq_u64 s[100:101],0
s_cbranch_scc1 K2_go
s_sub_u32 s7,s7,1
s_cbranch_scc1 K2_go
buffer_load_dword v23,v22,s[52:55],0 offen offset:0 sc1
s_waitcnt vmcnt(0)
s_branch K2_chk
K2_go:
WL 0
s_waitcnt vmcnt(13)
s_barrier
Ta 216,12,24576
Ta 218,12,30720
Ta 220,13,24576
Ta 222,13,30720
Ta 224,12,26624
Ta 226,12,32768
Ta 228,13,26624
Ta 230,13,32768
Ta 232,12,28672
Ta 234,12,34816
Ta 236,13,28672
Ta 238,13,34816
s_mov_b32 s16,1572864
s_add_u32 s43,s16,s9
K1_p219:
s_cbranch_vccnz K1_tr
s_add_u32 m0,s41,73728
s_nop 0
buffer_load_dwordx4 v1,s[20:23],s43 offen offset:0 sc1 lds
buffer_load_dwordx4 v1,s[20:23],s43 offen offset:1024 sc1 lds
buffer_load_dwordx4 v1,s[20:23],s43 offen offset:2048 sc1 lds
s_add_u32 m0,s41,76800
s_nop 0
buffer_load_dwordx4 v2,s[20:23],s43 offen offset:0 sc1 lds
buffer_load_dwordx4 v2,s[20:23],s43 offen offset:1024 sc1 lds
buffer_load_dwordx4 v2,s[20:23],s43 offen offset:2048 sc1 lds
s_add_u32 s43,s16,s12
s_add_u32 m0,s41,122880
s_nop 0
buffer_load_dwordx4 v1,s[20:23],s43 offen offset:0 sc1 lds
buffer_load_dwordx4 v1,s[20:23],s43 offen offset:1024 sc1 lds
buffer_load_dwordx4 v1,s[20:23],s43 offen offset:2048 sc1 lds
s_add_u32 m0,s41,125952
s_nop 0
buffer_load_dwordx4 v2,s[20:23],s43 offen offset:0 sc1 lds
buffer_load_dwordx4 v2,s[20:23],s43 offen offset:1024 sc1 lds
buffer_load_dwordx4 v2,s[20:23],s43 offen offset:2048 sc1 lds
WL 0
s_waitcnt vmcnt(19)
s_barrier
Ta 240,12,49152
Ta 242,12,55296
Ta 244,13,49152
Ta 246,13,55296
Ta 248,12,51200
Ta 250,12,57344
Ta 252,13,51200
Ta 254,13,57344
Tv 220,12,53248
Tv 222,12,59392
Tv 224,13,53248
Tv 226,13,59392
K1_p220:
s_cbranch_vccnz K1_tr
WL 0
s_waitcnt vmcnt(12)
s_barrier
Tv 228,14,24576
Tv 230,14,30720
Tv 232,15,24576
Tv 234,15,30720
Tv 236,14,26624
Tv 238,14,32768
Tv 240,15,26624
Tv 242,15,32768
Tv 244,14,28672
Tv 246,14,34816
Tv 248,15,28672
Tv 250,15,34816
WL 0
s_add_u32 m0,s41,0
s_nop 0
buffer_load_dwordx4 v6,s[48:51],s14 offen offset:0 lds
buffer_load_dwordx4 v7,s[48:51],s14 offen offset:1024 lds
s_add_u32 s10,s14,40960
s_sub_u32 s11,s10,1966080
s_min_u32 s14,s10,s11
s_add_u32 m0,s41,2048
s_nop 0
buffer_load_dwordx4 v6,s[48:51],s14 offen offset:0 lds
buffer_load_dwordx4 v7,s[48:51],s14 offen offset:1024 lds
s_add_u32 s10,s14,40960
s_sub_u32 s11,s10,1966080
s_min_u32 s14,s10,s11
s_add_u32 m0,s41,4096
s_nop 0
buffer_load_dwordx4 v6,s[48:51],s14 offen offset:0 lds
buffer_load_dwordx4 v7,s[48:51],s14 offen offset:1024 lds
s_add_u32 s10,s14,40960
s_sub_u32 s11,s10,1966080
K1_p221:
s_cbranch_vccnz K1_tr
s_min_u32 s14,s10,s11
s_waitcnt vmcnt(12)
s_barrier
Rv 60,4,24576
Rv 64,4,27648
Rv 68,4,25600
Rv 72,4,28672
Rv 76,4,26624
Rv 80,4,29696
Rv 84,4,30720
Rv 88,4,33792
Rv 92,4,31744
Rv 96,4,34816
Rv 100,4,32768
Rv 104,4,35840
WL 8
MvavZ 56,0,60
Rv 108,4,36864
Mvav 56,8,68
s_add_u32 s43,s16,s13
s_add_u32 m0,s41,49152
MvavZ 28,4,60
Rv 112,4,39936
Mvav 28,12,68
buffer_load_dwordx4 v1,s[20:23],s43 offen offset:0 sc1 lds
MvavZ 32,0,64
Rv 116,4,37888
Mvav 32,8,72
buffer_load_dwordx4 v1,s[20:23],s43 offen offset:1024 sc1 lds
MvavZ 36,4,64
Rv 120,4,40960
Mvav 36,12,72
WL 8
Mvav 56,16,76
Rv 60,4,38912
K1_p222:
s_cbranch_vccnz K1_tr
Mvav 56,24,84
buffer_load_dwordx4 v1,s[20:23],s43 offen offset:2048 sc1 lds
Mvav 28,20,76
Rv 64,4,41984
Mvav 28,28,84
s_add_u32 m0,s41,52224
Mvav 32,16,80
Rv 68,4,43008
Mvav 32,24,88
buffer_load_dwordx4 v2,s[20:23],s43 offen offset:0 sc1 lds
Mvav 36,20,80
Rv 72,4,46080
Mvav 36,28,88
WL 8
Mvav 56,32,92
Rv 76,4,44032
Mvav 56,40,100
buffer_load_dwordx4 v2,s[20:23],s43 offen offset:1024 sc1 lds
Mvav 28,36,92
Rv 80,4,47104
Mvav 28,44,100
buffer_load_dwordx4 v2,s[20:23],s43 offen offset:2048 sc1 lds
Mvav 32,32,96
Rv 84,4,45056
Mvav 32,40,104
Mvav 36,36,96
Rv 88,4,48128
Mvav 36,44,104
s_waitcnt vmcnt(12) lgkmcnt(8)
s_barrier
Mvav 56,48,108
Rv 92,5,24576
Mvav 56,56,116
K1_p223:
s_cbranch_vccnz K1_tr
s_xor_b32 s16,s44,1
s_mul_i32 s16,s16,393216
s_add_u32 s43,s16,s9
s_add_u32 m0,s41,98304
Mvav 28,52,108
Rv 96,5,27648
Mvav 28,60,116
buffer_load_dwordx4 v1,s[20:23],s43 offen offset:0 sc1 lds
Mvav 32,48,112
Rv 100,5,25600
Mvav 32,56,120
buffer_load_dwordx4 v1,s[20:23],s43 offen offset:1024 sc1 lds
Mvav 36,52,112
Rv 104,5,28672
Mvav 36,60,120
WL 8
Mvav 56,64,60
Rv 108,5,26624
Mvav 56,72,68
buffer_load_dwordx4 v1,s[20:23],s43 offen offset:2048 sc1 lds
Mvav 28,68,60
Rv 112,5,29696
Mvav 28,76,68
s_add_u32 m0,s41,24576
Mvav 32,64,64
Rv 116,5,30720
Mvav 32,72,72
buffer_load_dwordx4 v6,s[48:51],s14 offen offset:0 lds
Mvav 36,68,64
Rv 120,5,33792
Mvav 36,76,72
WL 8
Mvav 56,80,76
K1_p224:
s_cbranch_vccnz K1_tr
Rv 60,5,31744
Mvav 56,88,84
buffer_load_dwordx4 v7,s[48:51],s14 offen offset:1024 lds
s_add_u32 s10,s14,40960
s_sub_u32 s11,s10,1966080
s_min_u32 s14,s10,s11
Mvav 28,84,76
Rv 64,5,34816
Mvav 28,92,84
s_add_u32 m0,s41,101376
Mvav 32,80,80
Rv 68,5,32768
Mvav 32,88,88
buffer_load_dwordx4 v2,s[20:23],s43 offen offset:0 sc1 lds
Mvav 36,84,80
Rv 72,5,35840
Mvav 36,92,88
WL 8
Mvav 56,96,92
Rv 76,5,36864
Mvav 56,104,100
buffer_load_dwordx4 v2,s[20:23],s43 offen offset:1024 sc1 lds
Mvav 28,100,92
Rv 80,5,39936
Mvav 28,108,100
buffer_load_dwordx4 v2,s[20:23],s43 offen offset:2048 sc1 lds
Mvav 32,96,96
Rv 84,5,37888
Mvav 32,104,104
Mvav 36,100,96
Rv 88,5,40960
Mvav 36,108,104
WL 8
K1_p225:
s_cbranch_vccnz K1_tr
Mvav 56,112,108
Rv 92,5,38912
Mvav 56,120,116
s_add_u32 m0,s41,26624
Mvav 28,116,108
Rv 96,5,41984
Mvav 28,124,116
buffer_load_dwordx4 v6,s[48:51],s14 offen offset:0 lds
Mvav 32,112,112
Rv 100,5,43008
Mvav 32,120,120
buffer_load_dwordx4 v7,s[48:51],s14 offen offset:1024 lds
s_add_u32 s10,s14,40960
s_sub_u32 s11,s10,1966080
s_min_u32 s14,s10,s11
Mvav 36,116,112
Rv 104,5,46080
Mvav 36,124,120
WL 8
Mvav 56,128,60
Rv 108,5,44032
Mvav 56,136,68
s_add_u32 m0,s41,28672
Mvav 28,132,60
Rv 112,5,47104
Mvav 28,140,68
buffer_load_dwordx4 v6,s[48:51],s14 offen offset:0 lds
Mvav 32,128,64
Rv 116,5,45056
Mvav 32,136,72
buffer_load_dwordx4 v7,s[48:51],s14 offen offset:1024 lds
s_add_u32 s10,s14,40960
s_sub_u32 s11,s10,1966080
K1_p226:
s_cbranch_vccnz K1_tr
s_min_u32 s14,s10,s11
Mvav 36,132,64
Rv 120,5,48128
Mvav 36,140,72
s_waitcnt vmcnt(12) lgkmcnt(8)
s_barrier
Mvav 56,144,76
Rv 60,4,0
Mvav 56,152,84
s_add_u32 s43,s16,s12
s_add_u32 m0,s41,73728
Mvav 28,148,76
Rv 64,4,3072
Tv 124,12,0
Mvav 28,156,84
buffer_load_dwordx4 v1,s[20:23],s43 offen offset:0 sc1 lds
Mvav 32,144,80
Rv 68,4,1024
Tv 126,12,6144
Mvav 32,152,88
Mvav 36,148,80
Rv 72,4,4096
Tv 128,13,0
Mvav 36,156,88
WL 11
Mvav 56,160,92
Rv 76,4,2048
Mvav 56,168,100
buffer_load_dwordx4 v1,s[20:23],s43 offen offset:1024 sc1 lds
Mvav 28,164,92
Rv 80,4,5120
Tv 130,13,6144
Mvav 28,172,100
Mvav 32,160,96
K1_p227:
s_cbranch_vccnz K1_tr
Rv 84,4,6144
Tv 132,12,2048
Mvav 32,168,104
Mvav 36,164,96
Rv 88,4,9216
Tv 134,12,8192
Mvav 36,172,104
WL 14
Mvav 56,176,108
Rv 92,4,7168
Mvav 56,184,116
buffer_load_dwordx4 v1,s[20:23],s43 offen offset:2048 sc1 lds
Mvav 28,180,108
Rv 96,4,10240
Tv 136,13,2048
Mvav 28,188,116
Mvav 32,176,112
Rv 100,4,8192
Tv 138,13,8192
Mvav 32,184,120
Mvav 36,180,112
Rv 104,4,11264
Tv 140,12,4096
Mvav 36,188,120
WL 15
Mvav 56,192,60
Rv 108,4,12288
Mvav 56,200,68
s_add_u32 m0,s41,76800
Mvav 28,196,60
Rv 112,4,15360
Tv 142,12,10240
K1_p228:
s_cbranch_vccnz K1_tr
Mvav 28,204,68
buffer_load_dwordx4 v2,s[20:23],s43 offen offset:0 sc1 lds
Mvav 32,192,64
Rv 116,4,13312
Tv 144,13,4096
Mvav 32,200,72
Mvav 36,196,64
Rv 120,4,16384
Tv 146,13,10240
Mvav 36,204,72
WL 15
Mvav 56,208,76
Rv 60,4,14336
Mvav 56,216,84
buffer_load_dwordx4 v2,s[20:23],s43 offen offset:1024 sc1 lds
Mvav 28,212,76
Rv 64,4,17408
Mvav 28,220,84
Mvav 32,208,80
Rv 68,4,18432
Mvav 32,216,88
Mvav 36,212,80
Rv 72,4,21504
Mvav 36,220,88
WL 12
Mvav 56,224,92
Rv 76,4,19456
Mvav 56,232,100
buffer_load_dwordx4 v2,s[20:23],s43 offen offset:2048 sc1 lds
Mvav 28,228,92
Rv 80,4,22528
Mvav 28,236,100
Mvav 32,224,96
K1_p229:
s_cbranch_vccnz K1_tr
Rv 84,4,20480
Mvav 32,232,104
Mvav 36,228,96
Rv 88,4,23552
Mvav 36,236,104
s_waitcnt vmcnt(6) lgkmcnt(8)
s_barrier
Mvav 56,240,108
Rv 92,5,0
Mvav 56,248,116
s_add_u32 s43,s16,s13
s_add_u32 m0,s41,122880
Mvav 28,244,108
Rv 96,5,3072
Tv 148,12,24576
Mvav 28,252,116
buffer_load_dwordx4 v1,s[20:23],s43 offen offset:0 sc1 lds
Mvav 32,240,112
Rv 100,5,1024
Tv 150,12,30720
Mvav 32,248,120
buffer_load_dwordx4 v1,s[20:23],s43 offen offset:1024 sc1 lds
Mvav 36,244,112
Rv 104,5,4096
Tv 152,13,24576
Mvav 36,252,120
WL 11
Mvvv 56,220,60
Rv 108,5,2048
Mvvv 56,228,68
buffer_load_dwordx4 v1,s[20:23],s43 offen offset:2048 sc1 lds
Mvvv 28,224,60
Rv 112,5,5120
K1_p230:
s_cbranch_vccnz K1_tr
Tv 154,13,30720
Mvvv 28,232,68
s_add_u32 m0,s41,0
Mvvv 32,220,64
Rv 116,5,6144
Tv 156,12,26624
Mvvv 32,228,72
buffer_load_dwordx4 v6,s[48:51],s14 offen offset:0 lds
Mvvv 36,224,64
Rv 120,5,9216
Tv 158,12,32768
Mvvv 36,232,72
WL 14
Mvvv 56,236,76
Rv 60,5,7168
Mvvv 56,244,84
buffer_load_dwordx4 v7,s[48:51],s14 offen offset:1024 lds
s_add_u32 s10,s14,40960
s_sub_u32 s11,s10,1966080
s_min_u32 s14,s10,s11
Mvvv 28,240,76
Rv 64,5,10240
Tv 160,13,26624
Mvvv 28,248,84
s_add_u32 m0,s41,125952
Mvvv 32,236,80
Rv 68,5,8192
Tv 162,13,32768
Mvvv 32,244,88
buffer_load_dwordx4 v2,s[20:23],s43 offen offset:0 sc1 lds
Mvvv 36,240,80
Rv 72,5,11264
Tv 164,12,28672
K1_p231:
s_cbranch_vccnz K1_tr
Mvvv 36,248,88
WL 15
MvavZ 40,0,92
Rv 76,5,12288
Mvav 40,8,100
buffer_load_dwordx4 v2,s[20:23],s43 offen offset:1024 sc1 lds
MvavZ 44,4,92
Rv 80,5,15360
Tv 166,12,34816
Mvav 44,12,100
buffer_load_dwordx4 v2,s[20:23],s43 offen offset:2048 sc1 lds
MvavZ 48,0,96
Rv 84,5,13312
Tv 168,13,28672
Mvav 48,8,104
MvavZ 52,4,96
Rv 88,5,16384
Tv 170,13,34816
Mvav 52,12,104
WL 15
Mvav 40,16,108
Rv 92,5,14336
Mvav 40,24,116
s_add_u32 m0,s41,2048
Mvav 44,20,108
Rv 96,5,17408
Mvav 44,28,116
buffer_load_dwordx4 v6,s[48:51],s14 offen offset:0 lds
Mvav 48,16,112
Rv 100,5,18432
Mvav 48,24,120
buffer_load_dwordx4 v7,s[48:51],s14 offen offset:1024 lds
s_add_u32 s10,s14,40960
K1_p232:
s_cbranch_vccnz K1_tr
s_sub_u32 s11,s10,1966080
s_min_u32 s14,s10,s11
Mvav 52,20,112
Rv 104,5,21504
Mvav 52,28,120
WL 12
Mvav 40,32,60
Rv 108,5,19456
Mvav 40,40,68
s_add_u32 m0,s41,4096
Mvav 44,36,60
Rv 112,5,22528
Mvav 44,44,68
buffer_load_dwordx4 v6,s[48:51],s14 offen offset:0 lds
Mvav 48,32,64
Rv 116,5,20480
Mvav 48,40,72
buffer_load_dwordx4 v7,s[48:51],s14 offen offset:1024 lds
s_add_u32 s10,s14,40960
s_sub_u32 s11,s10,1966080
s_min_u32 s14,s10,s11
Mvav 52,36,64
Rv 120,5,23552
Mvav 52,44,72
s_waitcnt vmcnt(12) lgkmcnt(8)
s_barrier
Mvav 40,48,76
Rv 60,4,24576
Mvav 40,56,84
s_mov_b32 s16,1572864
s_add_u32 s43,s16,s8
s_add_u32 m0,s41,49152
Mvav 44,52,76
Rv 64,4,27648
K1_p233:
s_cbranch_vccnz K1_tr
Mvav 44,60,84
buffer_load_dwordx4 v1,s[20:23],s43 offen offset:0 sc1 lds
Mvav 48,48,80
Rv 68,4,25600
Mvav 48,56,88
buffer_load_dwordx4 v1,s[20:23],s43 offen offset:1024 sc1 lds
Mvav 52,52,80
Rv 72,4,28672
Mvav 52,60,88
WL 8
Mvav 40,64,92
Rv 76,4,26624
Mvav 40,72,100
buffer_load_dwordx4 v1,s[20:23],s43 offen offset:2048 sc1 lds
Mvav 44,68,92
Rv 80,4,29696
Mvav 44,76,100
s_add_u32 m0,s41,24576
Mvav 48,64,96
Rv 84,4,30720
Mvav 48,72,104
buffer_load_dwordx4 v6,s[48:51],s14 offen offset:0 lds
Mvav 52,68,96
Rv 88,4,33792
Mvav 52,76,104
WL 8
Mvav 40,80,108
Rv 92,4,31744
Mvav 40,88,116
buffer_load_dwordx4 v7,s[48:51],s14 offen offset:1024 lds
s_add_u32 s10,s14,40960
s_sub_u32 s11,s10,1966080
s_min_u32 s14,s10,s11
K1_p234:
s_cbranch_vccnz K1_tr
Mvav 44,84,108
Rv 96,4,34816
Mvav 44,92,116
s_add_u32 m0,s41,52224
Mvav 48,80,112
Rv 100,4,32768
Mvav 48,88,120
buffer_load_dwordx4 v2,s[20:23],s43 offen offset:0 sc1 lds
Mvav 52,84,112
Rv 104,4,35840
Mvav 52,92,120
WL 8
Mvav 40,96,60
Rv 108,4,36864
Mvav 40,104,68
buffer_load_dwordx4 v2,s[20:23],s43 offen offset:1024 sc1 lds
Mvav 44,100,60
Rv 112,4,39936
Mvav 44,108,68
buffer_load_dwordx4 v2,s[20:23],s43 offen offset:2048 sc1 lds
Mvav 48,96,64
Rv 116,4,37888
Mvav 48,104,72
Mvav 52,100,64
Rv 120,4,40960
Mvav 52,108,72
WL 8
Mvav 40,112,76
Rv 60,4,38912
Mvav 40,120,84
s_add_u32 m0,s41,26624
Mvav 44,116,76
Rv 64,4,41984
K1_p235:
s_cbranch_vccnz K1_tr
Mvav 44,124,84
buffer_load_dwordx4 v6,s[48:51],s14 offen offset:0 lds
Mvav 48,112,80
Rv 68,4,43008
Mvav 48,120,88
buffer_load_dwordx4 v7,s[48:51],s14 offen offset:1024 lds
s_add_u32 s10,s14,40960
s_sub_u32 s11,s10,1966080
s_min_u32 s14,s10,s11
Mvav 52,116,80
Rv 72,4,46080
Mvav 52,124,88
WL 8
Mvav 40,128,92
Rv 76,4,44032
Mvav 40,136,100
s_add_u32 m0,s41,28672
Mvav 44,132,92
Rv 80,4,47104
Mvav 44,140,100
buffer_load_dwordx4 v6,s[48:51],s14 offen offset:0 lds
Mvav 48,128,96
Rv 84,4,45056
Mvav 48,136,104
buffer_load_dwordx4 v7,s[48:51],s14 offen offset:1024 lds
Mvav 52,132,96
Rv 88,4,48128
Mvav 52,140,104
s_waitcnt vmcnt(12) lgkmcnt(8)
s_barrier
Mvav 40,144,108
Rv 92,5,24576
Mvav 40,152,116
K1_p236:
s_cbranch_vccnz K1_tr
s_xor_b32 s16,s44,1
s_mul_i32 s16,s16,393216
s_add_u32 s43,s16,s8
s_add_u32 m0,s41,98304
Mvav 44,148,108
Rv 96,5,27648
Tv 172,12,0
Mvav 44,156,116
buffer_load_dwordx4 v1,s[20:23],s43 offen offset:0 sc1 lds
Mvav 48,144,112
Rv 100,5,25600
Tv 174,12,6144
Mvav 48,152,120
Mvav 52,148,112
Rv 104,5,28672
Tv 176,13,0
Mvav 52,156,120
WL 11
Mvav 40,160,60
Rv 108,5,26624
Mvav 40,168,68
buffer_load_dwordx4 v1,s[20:23],s43 offen offset:1024 sc1 lds
Mvav 44,164,60
Rv 112,5,29696
Tv 178,13,6144
Mvav 44,172,68
Mvav 48,160,64
Rv 116,5,30720
Tv 180,12,2048
Mvav 48,168,72
Mvav 52,164,64
Rv 120,5,33792
Tv 182,12,8192
K1_p237:
s_cbranch_vccnz K1_tr
Mvav 52,172,72
WL 14
Mvav 40,176,76
Rv 60,5,31744
Mvav 40,184,84
buffer_load_dwordx4 v1,s[20:23],s43 offen offset:2048 sc1 lds
Mvav 44,180,76
Rv 64,5,34816
Tv 184,13,2048
Mvav 44,188,84
Mvav 48,176,80
Rv 68,5,32768
Tv 186,13,8192
Mvav 48,184,88
Mvav 52,180,80
Rv 72,5,35840
Tv 188,12,4096
Mvav 52,188,88
WL 15
Mvav 40,192,92
Rv 76,5,36864
Mvav 40,200,100
s_add_u32 m0,s41,101376
Mvav 44,196,92
Rv 80,5,39936
Tv 190,12,10240
Mvav 44,204,100
buffer_load_dwordx4 v2,s[20:23],s43 offen offset:0 sc1 lds
Mvav 48,192,96
Rv 84,5,37888
Tv 192,13,4096
Mvav 48,200,104
Mvav 52,196,96
K1_p238:
s_cbranch_vccnz K1_tr
Rv 88,5,40960
Tv 194,13,10240
Mvav 52,204,104
WL 15
Mvav 40,208,108
Rv 92,5,38912
Mvav 40,216,116
buffer_load_dwordx4 v2,s[20:23],s43 offen offset:1024 sc1 lds
Mvav 44,212,108
Rv 96,5,41984
Mvav 44,220,116
Mvav 48,208,112
Rv 100,5,43008
Mvav 48,216,120
Mvav 52,212,112
Rv 104,5,46080
Mvav 52,220,120
WL 12
Mvav 40,224,60
Rv 108,5,44032
Mvav 40,232,68
buffer_load_dwordx4 v2,s[20:23],s43 offen offset:2048 sc1 lds
Mvav 44,228,60
Rv 112,5,47104
Mvav 44,236,68
Mvav 48,224,64
Rv 116,5,45056
Mvav 48,232,72
Mvav 52,228,64
Rv 120,5,48128
Mvav 52,236,72
s_waitcnt vmcnt(6) lgkmcnt(8)
s_barrier
K1_p239:
s_cbranch_vccnz K1_tr
Mvav 40,240,76
Rv 60,4,0
Mvav 40,248,84
s_xor_b32 s16,s44,2
s_mul_i32 s16,s16,393216
s_add_u32 s43,s16,s8
s_add_u32 m0,s41,73728
Mvav 44,244,76
Rv 64,4,3072
Tv 196,12,24576
Mvav 44,252,84
buffer_load_dwordx4 v1,s[20:23],s43 offen offset:0 sc1 lds
Mvav 48,240,80
Rv 68,4,1024
Tv 198,12,30720
Mvav 48,248,88
Mvav 52,244,80
Rv 72,4,4096
Tv 200,13,24576
Mvav 52,252,88
WL 11
Mvvv 40,220,92
Rv 76,4,2048
Mvvv 40,228,100
buffer_load_dwordx4 v1,s[20:23],s43 offen offset:1024 sc1 lds
Mvvv 44,224,92
Rv 80,4,5120
Tv 202,13,30720
Mvvv 44,232,100
Mvvv 48,220,96
Rv 84,4,6144
Tv 204,12,26624
Mvvv 48,228,104
K1_p240:
s_cbranch_vccnz K1_tr
Mvvv 52,224,96
Rv 88,4,9216
Tv 206,12,32768
Mvvv 52,232,104
WL 14
Mvvv 40,236,108
Rv 92,4,7168
Mvvv 40,244,116
buffer_load_dwordx4 v1,s[20:23],s43 offen offset:2048 sc1 lds
Mvvv 44,240,108
Rv 96,4,10240
Tv 208,13,26624
Mvvv 44,248,116
Mvvv 48,236,112
Rv 100,4,8192
Tv 210,13,32768
Mvvv 48,244,120
Mvvv 52,240,112
Rv 104,4,11264
Tv 212,12,28672
Mvvv 52,248,120
WL 15
Mvvv 56,124,60
Rv 108,4,12288
Mvvv 56,132,68
s_add_u32 m0,s41,76800
Mvvv 28,128,60
Rv 112,4,15360
Tv 214,12,34816
Mvvv 28,136,68
buffer_load_dwordx4 v2,s[20:23],s43 offen offset:0 sc1 lds
Mvvv 32,124,64
Rv 116,4,13312
K1_p241:
s_cbranch_vccnz K1_tr
Tv 216,13,28672
Mvvv 32,132,72
Mvvv 36,128,64
Rv 120,4,16384
Tv 218,13,34816
Mvvv 36,136,72
WL 15
Mvvv 56,140,76
Rv 60,4,14336
Mvvv 56,148,84
buffer_load_dwordx4 v2,s[20:23],s43 offen offset:1024 sc1 lds
Mvvv 28,144,76
Rv 64,4,17408
Mvvv 28,152,84
Mvvv 32,140,80
Rv 68,4,18432
Mvvv 32,148,88
Mvvv 36,144,80
Rv 72,4,21504
Mvvv 36,152,88
WL 12
Mvvv 56,156,92
Rv 76,4,19456
Mvvv 56,164,100
buffer_load_dwordx4 v2,s[20:23],s43 offen offset:2048 sc1 lds
Mvvv 28,160,92
Rv 80,4,22528
Mvvv 28,168,100
Mvvv 32,156,96
Rv 84,4,20480
Mvvv 32,164,104
Mvvv 36,160,96
K1_p242:
s_cbranch_vccnz K1_tr
Rv 88,4,23552
Mvvv 36,168,104
s_waitcnt vmcnt(6) lgkmcnt(8)
s_barrier
Mvvv 56,172,108
Rv 92,5,0
Mvvv 56,180,116
s_add_u32 s43,s16,s9
s_add_u32 m0,s41,122880
Mvvv 28,176,108
Rv 96,5,3072
Mvvv 28,184,116
buffer_load_dwordx4 v1,s[20:23],s43 offen offset:0 sc1 lds
Mvvv 32,172,112
Rv 100,5,1024
Mvvv 32,180,120
Mvvv 36,176,112
Rv 104,5,4096
Mvvv 36,184,120
WL 8
Mvvv 56,188,60
Rv 108,5,2048
Mvvv 56,196,68
buffer_load_dwordx4 v1,s[20:23],s43 offen offset:1024 sc1 lds
Mvvv 28,192,60
Rv 112,5,5120
Mvvv 28,200,68
Mvvv 32,188,64
Rv 116,5,6144
Mvvv 32,196,72
Mvvv 36,192,64
Rv 120,5,9216
Mvvv 36,200,72
WL 8
K1_p243:
s_cbranch_vccnz K1_tr
Mvvv 56,204,76
Rv 60,5,7168
Mvvv 56,212,84
buffer_load_dwordx4 v1,s[20:23],s43 offen offset:2048 sc1 lds
Mvvv 28,208,76
Rv 64,5,10240
Mvvv 28,216,84
Mvvv 32,204,80
Rv 68,5,8192
Mvvv 32,212,88
Mvvv 36,208,80
Rv 72,5,11264
Mvvv 36,216,88
WL 8
Mvvv 40,124,92
Rv 76,5,12288
Mvvv 40,132,100
s_xor_b32 s17,s42,131072
s_add_u32 s17,s17,4096
buffer_store_dwordx4 v[28:31],v8,s[24:27],s17 offen sc1
Mvvv 44,128,92
Rv 80,5,15360
Mvvv 44,136,100
s_add_u32 m0,s41,125952
Mvvv 48,124,96
Rv 84,5,13312
Mvvv 48,132,104
buffer_load_dwordx4 v2,s[20:23],s43 offen offset:0 sc1 lds
Mvvv 52,128,96
Rv 88,5,16384
Mvvv 52,136,104
WL 8
Mvvv 40,140,108
K1_p244:
s_cbranch_vccnz K1_tr
Rv 92,5,14336
Mvvv 40,148,116
s_xor_b32 s17,s42,262144
s_add_u32 s17,s17,9216
buffer_store_dwordx4 v[32:35],v8,s[24:27],s17 offen sc1
Mvvv 44,144,108
Rv 96,5,17408
Mvvv 44,152,116
buffer_load_dwordx4 v2,s[20:23],s43 offen offset:1024 sc1 lds
Mvvv 48,140,112
Rv 100,5,18432
Mvvv 48,148,120
Mvvv 52,144,112
Rv 104,5,21504
Mvvv 52,152,120
WL 8
Mvvv 40,156,60
Rv 108,5,19456
Mvvv 40,164,68
s_xor_b32 s17,s42,393216
s_add_u32 s17,s17,14336
buffer_store_dwordx4 v[36:39],v8,s[24:27],s17 offen sc1
Mvvv 44,160,60
Rv 112,5,22528
Mvvv 44,168,68
buffer_load_dwordx4 v2,s[20:23],s43 offen offset:2048 sc1 lds
Mvvv 48,156,64
Rv 116,5,20480
Mvvv 48,164,72
Mvvv 52,160,64
Rv 120,5,23552
Mvvv 52,168,72
K1_p245:
s_cbranch_vccnz K1_tr
s_waitcnt vmcnt(9) lgkmcnt(8)
s_barrier
Mvvv 40,172,76
Rv 60,4,24576
Mvvv 40,180,84
s_add_u32 s43,s16,s12
s_add_u32 m0,s41,49152
Mvvv 44,176,76
Rv 64,4,27648
Mvvv 44,184,84
buffer_load_dwordx4 v1,s[20:23],s43 offen offset:0 sc1 lds
Mvvv 48,172,80
Rv 68,4,25600
Mvvv 48,180,88
Mvvv 52,176,80
Rv 72,4,28672
Mvvv 52,184,88
WL 8
Mvvv 40,188,92
Rv 76,4,26624
Mvvv 40,196,100
buffer_load_dwordx4 v1,s[20:23],s43 offen offset:1024 sc1 lds
Mvvv 44,192,92
Rv 80,4,29696
Mvvv 44,200,100
Mvvv 48,188,96
Rv 84,4,30720
Mvvv 48,196,104
Mvvv 52,192,96
Rv 88,4,33792
Mvvv 52,200,104
WL 8
Mvvv 40,204,108
Rv 92,4,31744
K1_p246:
s_cbranch_vccnz K1_tr
Mvvv 40,212,116
buffer_load_dwordx4 v1,s[20:23],s43 offen offset:2048 sc1 lds
Mvvv 44,208,108
Rv 96,4,34816
Mvvv 44,216,116
Mvvv 48,204,112
Rv 100,4,32768
Mvvv 48,212,120
Mvvv 52,208,112
Rv 104,4,35840
Mvvv 52,216,120
WL 8
MvvvZ 24,124,60
Rv 108,4,36864
Mvvv 24,132,68
s_xor_b32 s17,s42,131072
buffer_store_dwordx4 v[40:43],v8,s[24:27],s17 offen offset:1024 sc1
MvvvZ 28,128,60
Rv 112,4,39936
Mvvv 28,136,68
s_add_u32 m0,s41,52224
MvvvZ 32,124,64
Rv 116,4,37888
Mvvv 32,132,72
buffer_load_dwordx4 v2,s[20:23],s43 offen offset:0 sc1 lds
MvvvZ 36,128,64
Rv 120,4,40960
Mvvv 36,136,72
WL 8
Mvvv 24,140,76
Rv 60,4,38912
Mvvv 24,148,84
K1_p247:
s_cbranch_vccnz K1_tr
buffer_store_dwordx4 v[44:47],v8,s[24:27],s17 offen offset:0 sc1
Mvvv 28,144,76
Rv 64,4,41984
Mvvv 28,152,84
buffer_load_dwordx4 v2,s[20:23],s43 offen offset:1024 sc1 lds
Mvvv 32,140,80
Rv 68,4,43008
Mvvv 32,148,88
Mvvv 36,144,80
Rv 72,4,46080
Mvvv 36,152,88
WL 8
Mvvv 24,156,92
Rv 76,4,44032
Mvvv 24,164,100
buffer_store_dwordx4 v[48:51],v8,s[24:27],s17 offen offset:3072 sc1
Mvvv 28,160,92
Rv 80,4,47104
Mvvv 28,168,100
buffer_load_dwordx4 v2,s[20:23],s43 offen offset:2048 sc1 lds
Mvvv 32,156,96
Rv 84,4,45056
Mvvv 32,164,104
Mvvv 36,160,96
Rv 88,4,48128
Mvvv 36,168,104
s_waitcnt vmcnt(9) lgkmcnt(8)
s_barrier
Mvvv 24,172,108
Rv 92,5,24576
Mvvv 24,180,116
buffer_store_dwordx4 v[52:55],v8,s[24:27],s17 offen offset:2048 sc1
Mvvv 28,176,108
K1_p248:
s_cbranch_vccnz K1_tr
Rv 96,5,27648
Mvvv 28,184,116
s_add_u32 s43,s16,s13
s_add_u32 m0,s41,98304
Mvvv 32,172,112
Rv 100,5,25600
Mvvv 32,180,120
buffer_load_dwordx4 v1,s[20:23],s43 offen offset:0 sc1 lds
Mvvv 36,176,112
Rv 104,5,28672
Mvvv 36,184,120
WL 8
Mvvv 24,188,60
Rv 108,5,26624
Mvvv 24,196,68
buffer_load_dwordx4 v1,s[20:23],s43 offen offset:1024 sc1 lds
Mvvv 28,192,60
Rv 112,5,29696
Mvvv 28,200,68
Mvvv 32,188,64
Rv 116,5,30720
Mvvv 32,196,72
Mvvv 36,192,64
Rv 120,5,33792
Mvvv 36,200,72
WL 8
Mvvv 24,204,76
Rv 60,5,31744
Mvvv 24,212,84
buffer_load_dwordx4 v1,s[20:23],s43 offen offset:2048 sc1 lds
Mvvv 28,208,76
Rv 64,5,34816
Mvvv 28,216,84
K1_p249:
s_cbranch_vccnz K1_tr
Mvvv 32,204,80
Rv 68,5,32768
Mvvv 32,212,88
Mvvv 36,208,80
Rv 72,5,35840
Mvvv 36,216,88
WL 8
Mvav 24,0,92
Rv 76,5,36864
Mvav 24,8,100
s_add_u32 m0,s41,101376
Mvav 28,4,92
Rv 80,5,39936
Mvav 28,12,100
buffer_load_dwordx4 v2,s[20:23],s43 offen offset:0 sc1 lds
Mvav 32,0,96
Rv 84,5,37888
Mvav 32,8,104
Mvav 36,4,96
Rv 88,5,40960
Mvav 36,12,104
WL 8
Mvav 24,16,108
Rv 92,5,38912
Mvav 24,24,116
buffer_load_dwordx4 v2,s[20:23],s43 offen offset:1024 sc1 lds
Mvav 28,20,108
Rv 96,5,41984
Mvav 28,28,116
Mvav 32,16,112
Rv 100,5,43008
Mvav 32,24,120
Mvav 36,20,112
K1_p250:
s_cbranch_vccnz K1_tr
Rv 104,5,46080
Mvav 36,28,120
WL 8
Mvav 24,32,60
Rv 108,5,44032
Mvav 24,40,68
buffer_load_dwordx4 v2,s[20:23],s43 offen offset:2048 sc1 lds
Mvav 28,36,60
Rv 112,5,47104
Mvav 28,44,68
Mvav 32,32,64
Rv 116,5,45056
Mvav 32,40,72
Mvav 36,36,64
Rv 120,5,48128
Mvav 36,44,72
s_waitcnt vmcnt(7) lgkmcnt(8)
s_barrier
Mvav 24,48,76
Rv 60,4,0
Mvav 24,56,84
s_xor_b32 s16,s44,3
s_mul_i32 s16,s16,393216
s_add_u32 s43,s16,s8
s_add_u32 m0,s41,73728
Mvav 28,52,76
Rv 64,4,3072
Mvav 28,60,84
buffer_load_dwordx4 v1,s[20:23],s43 offen offset:0 sc1 lds
Mvav 32,48,80
Rv 68,4,1024
Mvav 32,56,88
Mvav 36,52,80
Rv 72,4,4096
K1_p251:
s_cbranch_vccnz K1_tr
Mvav 36,60,88
WL 8
Mvav 24,64,92
Rv 76,4,2048
Mvav 24,72,100
buffer_load_dwordx4 v1,s[20:23],s43 offen offset:1024 sc1 lds
Mvav 28,68,92
Rv 80,4,5120
Mvav 28,76,100
Mvav 32,64,96
Rv 84,4,6144
Mvav 32,72,104
Mvav 36,68,96
Rv 88,4,9216
Mvav 36,76,104
WL 8
Mvav 24,80,108
Rv 92,4,7168
Mvav 24,88,116
buffer_load_dwordx4 v1,s[20:23],s43 offen offset:2048 sc1 lds
Mvav 28,84,108
Rv 96,4,10240
Mvav 28,92,116
Mvav 32,80,112
Rv 100,4,8192
Mvav 32,88,120
Mvav 36,84,112
Rv 104,4,11264
Mvav 36,92,120
s_waitcnt vmcnt(9) lgkmcnt(8)
Mvav 24,96,60
Rv 108,4,12288
Mvav 24,104,68
K1_p252:
s_cbranch_vccnz K1_tr
s_xor_b32 s17,s42,131072
buffer_store_dword v21,v17,s[24:27],s17 offen offset:0 sc1
Mvav 28,100,60
Rv 112,4,15360
Mvav 28,108,68
s_add_u32 m0,s41,76800
Mvav 32,96,64
Rv 116,4,13312
Mvav 32,104,72
buffer_load_dwordx4 v2,s[20:23],s43 offen offset:0 sc1 lds
Mvav 36,100,64
Rv 120,4,16384
Mvav 36,108,72
WL 8
Mvav 24,112,76
Rv 60,4,14336
Mvav 24,120,84
buffer_load_dwordx4 v2,s[20:23],s43 offen offset:1024 sc1 lds
Mvav 28,116,76
Rv 64,4,17408
Mvav 28,124,84
Mvav 32,112,80
Rv 68,4,18432
Mvav 32,120,88
Mvav 36,116,80
Rv 72,4,21504
Mvav 36,124,88
WL 8
Mvav 24,128,92
Rv 76,4,19456
Mvav 24,136,100
buffer_load_dwordx4 v2,s[20:23],s43 offen offset:2048 sc1 lds
K1_p253:
s_cbranch_vccnz K1_tr
Mvav 28,132,92
Rv 80,4,22528
Mvav 28,140,100
Mvav 32,128,96
Rv 84,4,20480
Mvav 32,136,104
Mvav 36,132,96
Rv 88,4,23552
Mvav 36,140,104
s_waitcnt vmcnt(7) lgkmcnt(8)
s_barrier
Mvav 24,144,108
Rv 92,5,0
Mvav 24,152,116
s_add_u32 s43,s16,s9
s_add_u32 m0,s41,122880
Mvav 28,148,108
Rv 96,5,3072
Mvav 28,156,116
buffer_load_dwordx4 v1,s[20:23],s43 offen offset:0 sc1 lds
Mvav 32,144,112
Rv 100,5,1024
Mvav 32,152,120
Mvav 36,148,112
Rv 104,5,4096
Mvav 36,156,120
WL 8
Mvav 24,160,60
Rv 108,5,2048
Mvav 24,168,68
buffer_load_dwordx4 v1,s[20:23],s43 offen offset:1024 sc1 lds
Mvav 28,164,60
Rv 112,5,5120
Mvav 28,172,68
K1_p254:
s_cbranch_vccnz K1_tr
Mvav 32,160,64
Rv 116,5,6144
Mvav 32,168,72
Mvav 36,164,64
Rv 120,5,9216
Mvav 36,172,72
WL 8
Mvav 24,176,76
Rv 60,5,7168
Mvav 24,184,84
buffer_load_dwordx4 v1,s[20:23],s43 offen offset:2048 sc1 lds
Mvav 28,180,76
Rv 64,5,10240
Mvav 28,188,84
Mvav 32,176,80
Rv 68,5,8192
Mvav 32,184,88
Mvav 36,180,80
Rv 72,5,11264
Mvav 36,188,88
WL 8
Mvav 24,192,92
Rv 76,5,12288
Mvav 24,200,100
s_add_u32 m0,s41,125952
Mvav 28,196,92
Rv 80,5,15360
Mvav 28,204,100
buffer_load_dwordx4 v2,s[20:23],s43 offen offset:0 sc1 lds
Mvav 32,192,96
Rv 84,5,13312
Mvav 32,200,104
K1_p255:
s_cbranch_vccnz K1_tr
Mvav 36,196,96
Rv 88,5,16384
Mvav 36,204,104
WL 8
Mvav 24,208,108
Rv 92,5,14336
Mvav 24,216,116
buffer_load_dwordx4 v2,s[20:23],s43 offen offset:1024 sc1 lds
Mvav 28,212,108
Rv 96,5,17408
Mvav 28,220,116
Mvav 32,208,112
Rv 100,5,18432
Mvav 32,216,120
Mvav 36,212,112
Rv 104,5,21504
Mvav 36,220,120
WL 8
Mvav 24,224,60
Rv 108,5,19456
Mvav 24,232,68
buffer_load_dwordx4 v2,s[20:23],s43 offen offset:2048 sc1 lds
Mvav 28,228,60
Rv 112,5,22528
Mvav 28,236,68
Mvav 32,224,64
Rv 116,5,20480
Mvav 32,232,72
Mvav 36,228,64
Rv 120,5,23552
Mvav 36,236,72
s_waitcnt vmcnt(6) lgkmcnt(8)
s_barrier
Mvav 24,240,76
K1_p256:
s_cbranch_vccnz K1_tr
Rv 60,4,24576
Mvav 24,248,84
s_add_u32 s43,s16,s12
s_add_u32 m0,s41,49152
Mvav 28,244,76
Rv 64,4,27648
Mvav 28,252,84
buffer_load_dwordx4 v1,s[20:23],s43 offen offset:0 sc1 lds
Mvav 32,240,80
Rv 68,4,25600
Mvav 32,248,88
Mvav 36,244,80
Rv 72,4,28672
Mvav 36,252,88
WL 8
Mvvv 24,220,92
Rv 76,4,26624
Mvvv 24,228,100
buffer_load_dwordx4 v1,s[20:23],s43 offen offset:1024 sc1 lds
Mvvv 28,224,92
Rv 80,4,29696
Mvvv 28,232,100
Mvvv 32,220,96
Rv 84,4,30720
Mvvv 32,228,104
Mvvv 36,224,96
Rv 88,4,33792
Mvvv 36,232,104
WL 8
Mvvv 24,236,108
Rv 92,4,31744
Mvvv 24,244,116
buffer_load_dwordx4 v1,s[20:23],s43 offen offset:2048 sc1 lds
K1_p257:
s_cbranch_vccnz K1_tr
Mvvv 28,240,108
Rv 96,4,34816
Mvvv 28,248,116
Mvvv 32,236,112
Rv 100,4,32768
Mvvv 32,244,120
Mvvv 36,240,112
Rv 104,4,35840
Mvvv 36,248,120
WL 8
MvvvZ 40,124,60
Rv 108,4,36864
Mvvv 40,132,68
s_xor_b32 s17,s42,262144
s_add_u32 s17,s17,5120
buffer_store_dwordx4 v[24:27],v8,s[24:27],s17 offen offset:2048 sc1
MvvvZ 44,128,60
Rv 112,4,39936
Mvvv 44,136,68
s_add_u32 m0,s41,52224
MvvvZ 48,124,64
Rv 116,4,37888
Mvvv 48,132,72
buffer_load_dwordx4 v2,s[20:23],s43 offen offset:0 sc1 lds
MvvvZ 52,128,64
Rv 120,4,40960
Mvvv 52,136,72
WL 8
Mvvv 40,140,76
Rv 60,4,38912
Mvvv 40,148,84
buffer_store_dwordx4 v[28:31],v8,s[24:27],s17 offen offset:3072 sc1
K1_p258:
s_cbranch_vccnz K1_tr
Mvvv 44,144,76
Rv 64,4,41984
Mvvv 44,152,84
buffer_load_dwordx4 v2,s[20:23],s43 offen offset:1024 sc1 lds
Mvvv 48,140,80
Rv 68,4,43008
Mvvv 48,148,88
Mvvv 52,144,80
Rv 72,4,46080
Mvvv 52,152,88
WL 8
Mvvv 40,156,92
Rv 76,4,44032
Mvvv 40,164,100
buffer_store_dwordx4 v[32:35],v8,s[24:27],s17 offen offset:0 sc1
Mvvv 44,160,92
Rv 80,4,47104
Mvvv 44,168,100
buffer_load_dwordx4 v2,s[20:23],s43 offen offset:2048 sc1 lds
Mvvv 48,156,96
Rv 84,4,45056
Mvvv 48,164,104
Mvvv 52,160,96
Rv 88,4,48128
Mvvv 52,168,104
s_waitcnt vmcnt(9) lgkmcnt(8)
s_barrier
Mvvv 40,172,108
Rv 92,5,24576
Mvvv 40,180,116
buffer_store_dwordx4 v[36:39],v8,s[24:27],s17 offen offset:1024 sc1
Mvvv 44,176,108
Rv 96,5,27648
K1_p259:
s_cbranch_vccnz K1_tr
Mvvv 44,184,116
s_add_u32 s43,s16,s13
s_add_u32 m0,s41,98304
Mvvv 48,172,112
Rv 100,5,25600
Mvvv 48,180,120
buffer_load_dwordx4 v1,s[20:23],s43 offen offset:0 sc1 lds
Mvvv 52,176,112
Rv 104,5,28672
Mvvv 52,184,120
WL 8
Mvvv 40,188,60
Rv 108,5,26624
Mvvv 40,196,68
buffer_load_dwordx4 v1,s[20:23],s43 offen offset:1024 sc1 lds
Mvvv 44,192,60
Rv 112,5,29696
Mvvv 44,200,68
Mvvv 48,188,64
Rv 116,5,30720
Mvvv 48,196,72
Mvvv 52,192,64
Rv 120,5,33792
Mvvv 52,200,72
WL 8
Mvvv 40,204,76
Rv 60,5,31744
Mvvv 40,212,84
buffer_load_dwordx4 v1,s[20:23],s43 offen offset:2048 sc1 lds
Mvvv 44,208,76
Rv 64,5,34816
Mvvv 44,216,84
Mvvv 48,204,80
K1_p260:
s_cbranch_vccnz K1_tr
Rv 68,5,32768
Mvvv 48,212,88
Mvvv 52,208,80
Rv 72,5,35840
Mvvv 52,216,88
WL 8
Mvav 40,0,92
Rv 76,5,36864
Mvav 40,8,100
s_add_u32 m0,s41,101376
Mvav 44,4,92
Rv 80,5,39936
Mvav 44,12,100
buffer_load_dwordx4 v2,s[20:23],s43 offen offset:0 sc1 lds
Mvav 48,0,96
Rv 84,5,37888
Mvav 48,8,104
Mvav 52,4,96
Rv 88,5,40960
Mvav 52,12,104
WL 8
Mvav 40,16,108
Rv 92,5,38912
Mvav 40,24,116
buffer_load_dwordx4 v2,s[20:23],s43 offen offset:1024 sc1 lds
Mvav 44,20,108
Rv 96,5,41984
Mvav 44,28,116
Mvav 48,16,112
Rv 100,5,43008
Mvav 48,24,120
Mvav 52,20,112
Rv 104,5,46080
K1_p261:
s_cbranch_vccnz K1_tr
Mvav 52,28,120
WL 8
Mvav 40,32,60
Rv 108,5,44032
Mvav 40,40,68
buffer_load_dwordx4 v2,s[20:23],s43 offen offset:2048 sc1 lds
Mvav 44,36,60
Rv 112,5,47104
Mvav 44,44,68
Mvav 48,32,64
Rv 116,5,45056
Mvav 48,40,72
Mvav 52,36,64
Rv 120,5,48128
Mvav 52,44,72
s_waitcnt vmcnt(7) lgkmcnt(8)
s_barrier
Mvav 40,48,76
Rv 60,4,0
Mvav 40,56,84
s_xor_b32 s16,s44,0
s_mul_i32 s16,s16,393216
s_add_u32 s43,s16,s8
s_add_u32 m0,s41,73728
Mvav 44,52,76
Rv 64,4,3072
Mvav 44,60,84
buffer_load_dwordx4 v1,s[20:23],s43 offen offset:0 sc1 lds
Mvav 48,48,80
Rv 68,4,1024
Mvav 48,56,88
Mvav 52,52,80
Rv 72,4,4096
Mvav 52,60,88
K1_p262:
s_cbranch_vccnz K1_tr
WL 8
Mvav 40,64,92
Rv 76,4,2048
Mvav 40,72,100
buffer_load_dwordx4 v1,s[20:23],s43 offen offset:1024 sc1 lds
Mvav 44,68,92
Rv 80,4,5120
Mvav 44,76,100
Mvav 48,64,96
Rv 84,4,6144
Mvav 48,72,104
Mvav 52,68,96
Rv 88,4,9216
Mvav 52,76,104
WL 8
Mvav 40,80,108
Rv 92,4,7168
Mvav 40,88,116
buffer_load_dwordx4 v1,s[20:23],s43 offen offset:2048 sc1 lds
Mvav 44,84,108
Rv 96,4,10240
Mvav 44,92,116
Mvav 48,80,112
Rv 100,4,8192
Mvav 48,88,120
Mvav 52,84,112
Rv 104,4,11264
Mvav 52,92,120
s_waitcnt vmcnt(9) lgkmcnt(8)
Mvav 40,96,60
Rv 108,4,12288
Mvav 40,104,68
s_xor_b32 s17,s42,262144
K1_p263:
s_cbranch_vccnz K1_tr
buffer_store_dword v21,v17,s[24:27],s17 offen offset:128 sc1
Mvav 44,100,60
Rv 112,4,15360
Mvav 44,108,68
s_add_u32 m0,s41,76800
Mvav 48,96,64
Rv 116,4,13312
Mvav 48,104,72
buffer_load_dwordx4 v2,s[20:23],s43 offen offset:0 sc1 lds
Mvav 52,100,64
Rv 120,4,16384
Mvav 52,108,72
WL 8
Mvav 40,112,76
Rv 60,4,14336
Mvav 40,120,84
buffer_load_dwordx4 v2,s[20:23],s43 offen offset:1024 sc1 lds
Mvav 44,116,76
Rv 64,4,17408
Mvav 44,124,84
Mvav 48,112,80
Rv 68,4,18432
Mvav 48,120,88
Mvav 52,116,80
Rv 72,4,21504
Mvav 52,124,88
WL 8
Mvav 40,128,92
Rv 76,4,19456
Mvav 40,136,100
buffer_load_dwordx4 v2,s[20:23],s43 offen offset:2048 sc1 lds
Mvav 44,132,92
K1_p264:
s_cbranch_vccnz K1_tr
Rv 80,4,22528
Mvav 44,140,100
Mvav 48,128,96
Rv 84,4,20480
Mvav 48,136,104
Mvav 52,132,96
Rv 88,4,23552
Mvav 52,140,104
s_waitcnt vmcnt(7) lgkmcnt(8)
s_barrier
Mvav 40,144,108
Rv 92,5,0
Mvav 40,152,116
s_add_u32 s43,s16,s9
s_add_u32 m0,s41,122880
Mvav 44,148,108
Rv 96,5,3072
Mvav 44,156,116
buffer_load_dwordx4 v1,s[20:23],s43 offen offset:0 sc1 lds
Mvav 48,144,112
Rv 100,5,1024
Mvav 48,152,120
Mvav 52,148,112
Rv 104,5,4096
Mvav 52,156,120
WL 8
Mvav 40,160,60
Rv 108,5,2048
Mvav 40,168,68
buffer_load_dwordx4 v1,s[20:23],s43 offen offset:1024 sc1 lds
Mvav 44,164,60
Rv 112,5,5120
Mvav 44,172,68
Mvav 48,160,64
K1_p265:
s_cbranch_vccnz K1_tr
Rv 116,5,6144
Mvav 48,168,72
Mvav 52,164,64
Rv 120,5,9216
Mvav 52,172,72
WL 8
Mvav 40,176,76
Rv 60,5,7168
Mvav 40,184,84
buffer_load_dwordx4 v1,s[20:23],s43 offen offset:2048 sc1 lds
Mvav 44,180,76
Rv 64,5,10240
Mvav 44,188,84
Mvav 48,176,80
Rv 68,5,8192
Mvav 48,184,88
Mvav 52,180,80
Rv 72,5,11264
Mvav 52,188,88
WL 8
Mvav 40,192,92
Rv 76,5,12288
Mvav 40,200,100
s_add_u32 m0,s41,125952
Mvav 44,196,92
Rv 80,5,15360
Mvav 44,204,100
buffer_load_dwordx4 v2,s[20:23],s43 offen offset:0 sc1 lds
Mvav 48,192,96
Rv 84,5,13312
Mvav 48,200,104
Mvav 52,196,96
K1_p266:
s_cbranch_vccnz K1_tr
Rv 88,5,16384
Mvav 52,204,104
WL 8
Mvav 40,208,108
Rv 92,5,14336
Mvav 40,216,116
buffer_load_dwordx4 v2,s[20:23],s43 offen offset:1024 sc1 lds
Mvav 44,212,108
Rv 96,5,17408
Mvav 44,220,116
Mvav 48,208,112
Rv 100,5,18432
Mvav 48,216,120
Mvav 52,212,112
Rv 104,5,21504
Mvav 52,220,120
WL 8
Mvav 40,224,60
Rv 108,5,19456
Mvav 40,232,68
buffer_load_dwordx4 v2,s[20:23],s43 offen offset:2048 sc1 lds
Mvav 44,228,60
Rv 112,5,22528
Mvav 44,236,68
Mvav 48,224,64
Rv 116,5,20480
Mvav 48,232,72
Mvav 52,228,64
Rv 120,5,23552
Mvav 52,236,72
s_waitcnt vmcnt(6) lgkmcnt(8)
s_barrier
Mvav 40,240,76
Rv 60,4,24576
K1_p267:
s_cbranch_vccnz K1_tr
Mvav 40,248,84
s_add_u32 s43,s16,s12
s_add_u32 m0,s41,49152
Mvav 44,244,76
Rv 64,4,27648
Mvav 44,252,84
buffer_load_dwordx4 v1,s[20:23],s43 offen offset:0 sc1 lds
Mvav 48,240,80
Rv 68,4,25600
Mvav 48,248,88
Mvav 52,244,80
Rv 72,4,28672
Mvav 52,252,88
WL 8
Mvvv 40,220,92
Rv 76,4,26624
Mvvv 40,228,100
buffer_load_dwordx4 v1,s[20:23],s43 offen offset:1024 sc1 lds
Mvvv 44,224,92
Rv 80,4,29696
Mvvv 44,232,100
Mvvv 48,220,96
Rv 84,4,30720
Mvvv 48,228,104
Mvvv 52,224,96
Rv 88,4,33792
Mvvv 52,232,104
WL 8
Mvvv 40,236,108
Rv 92,4,31744
Mvvv 40,244,116
buffer_load_dwordx4 v1,s[20:23],s43 offen offset:2048 sc1 lds
Mvvv 44,240,108
K1_p268:
s_cbranch_vccnz K1_tr
Rv 96,4,34816
Mvvv 44,248,116
Mvvv 48,236,112
Rv 100,4,32768
Mvvv 48,244,120
Mvvv 52,240,112
Rv 104,4,35840
Mvvv 52,248,120
WL 8
MvvvZ 24,124,60
Rv 108,4,36864
Mvvv 24,132,68
s_xor_b32 s17,s42,393216
s_add_u32 s17,s17,10240
buffer_store_dwordx4 v[40:43],v8,s[24:27],s17 offen offset:3072 sc1
MvvvZ 28,128,60
Rv 112,4,39936
Mvvv 28,136,68
buffer_store_dwordx4 v[44:47],v8,s[24:27],s17 offen offset:2048 sc1
MvvvZ 32,124,64
Rv 116,4,37888
Mvvv 32,132,72
s_add_u32 m0,s41,52224
MvvvZ 36,128,64
Rv 120,4,40960
Mvvv 36,136,72
buffer_load_dwordx4 v2,s[20:23],s43 offen offset:0 sc1 lds
WL 8
Mvvv 24,140,76
Rv 60,4,38912
Mvvv 24,148,84
buffer_store_dwordx4 v[48:51],v8,s[24:27],s17 offen offset:1024 sc1
K1_p269:
s_cbranch_vccnz K1_tr
Mvvv 28,144,76
Rv 64,4,41984
Mvvv 28,152,84
buffer_store_dwordx4 v[52:55],v8,s[24:27],s17 offen offset:0 sc1
Mvvv 32,140,80
Rv 68,4,43008
Mvvv 32,148,88
buffer_load_dwordx4 v2,s[20:23],s43 offen offset:1024 sc1 lds
Mvvv 36,144,80
Rv 72,4,46080
Mvvv 36,152,88
WL 8
Mvvv 24,156,92
Rv 76,4,44032
Mvvv 24,164,100
buffer_load_dwordx4 v2,s[20:23],s43 offen offset:2048 sc1 lds
Mvvv 28,160,92
Rv 80,4,47104
Mvvv 28,168,100
Mvvv 32,156,96
Rv 84,4,45056
Mvvv 32,164,104
Mvvv 36,160,96
Rv 88,4,48128
Mvvv 36,168,104
s_waitcnt vmcnt(10) lgkmcnt(8)
s_barrier
Mvvv 24,172,108
Rv 92,5,24576
Mvvv 24,180,116
buffer_load_dword v16,v9,s[24:27],s42 offen sc1
Mvvv 28,176,108
Rv 96,5,27648
K1_p270:
s_cbranch_vccnz K1_tr
Mvvv 28,184,116
s_add_u32 s43,s16,s13
s_add_u32 m0,s41,98304
Mvvv 32,172,112
Rv 100,5,25600
Mvvv 32,180,120
buffer_load_dwordx4 v1,s[20:23],s43 offen offset:0 sc1 lds
Mvvv 36,176,112
Rv 104,5,28672
Mvvv 36,184,120
WL 8
Mvvv 24,188,60
Rv 108,5,26624
Mvvv 24,196,68
buffer_load_dwordx4 v1,s[20:23],s43 offen offset:1024 sc1 lds
Mvvv 28,192,60
Rv 112,5,29696
Mvvv 28,200,68
Mvvv 32,188,64
Rv 116,5,30720
Mvvv 32,196,72
Mvvv 36,192,64
Rv 120,5,33792
Mvvv 36,200,72
WL 8
Mvvv 24,204,76
Rv 60,5,31744
Mvvv 24,212,84
buffer_load_dwordx4 v1,s[20:23],s43 offen offset:2048 sc1 lds
Mvvv 28,208,76
Rv 64,5,34816
Mvvv 28,216,84
Mvvv 32,204,80
K1_p271:
s_cbranch_vccnz K1_tr
Rv 68,5,32768
Mvvv 32,212,88
Mvvv 36,208,80
Rv 72,5,35840
Mvvv 36,216,88
WL 8
Mvav 24,0,92
Rv 76,5,36864
Mvav 24,8,100
s_add_u32 m0,s41,101376
Mvav 28,4,92
Rv 80,5,39936
Mvav 28,12,100
buffer_load_dwordx4 v2,s[20:23],s43 offen offset:0 sc1 lds
Mvav 32,0,96
Rv 84,5,37888
Mvav 32,8,104
Mvav 36,4,96
Rv 88,5,40960
Mvav 36,12,104
WL 8
Mvav 24,16,108
Rv 92,5,38912
Mvav 24,24,116
buffer_load_dwordx4 v2,s[20:23],s43 offen offset:1024 sc1 lds
Mvav 28,20,108
Rv 96,5,41984
Mvav 28,28,116
Mvav 32,16,112
Rv 100,5,43008
Mvav 32,24,120
Mvav 36,20,112
Rv 104,5,46080
K1_p272:
s_cbranch_vccnz K1_tr
Mvav 36,28,120
s_waitcnt vmcnt(8) lgkmcnt(8)
Mvav 24,32,60
Rv 108,5,44032
Mvav 24,40,68
s_xor_b32 s17,s42,393216
buffer_store_dword v21,v17,s[24:27],s17 offen offset:256 sc1
Mvav 28,36,60
Rv 112,5,47104
Mvav 28,44,68
buffer_load_dwordx4 v2,s[20:23],s43 offen offset:2048 sc1 lds
Mvav 32,32,64
Rv 116,5,45056
Mvav 32,40,72
Mvav 36,36,64
Rv 120,5,48128
Mvav 36,44,72
s_waitcnt vmcnt(8) lgkmcnt(8)
s_barrier
Mvav 24,48,76
Rv 60,4,0
Mvav 24,56,84
Mvav 28,52,76
Rv 64,4,3072
Mvav 28,60,84
Mvav 32,48,80
Rv 68,4,1024
Mvav 32,56,88
Mvav 36,52,80
Rv 72,4,4096
Mvav 36,60,88
s_waitcnt vmcnt(7) lgkmcnt(8)
Mvav 24,64,92
K1_p273:
s_cbranch_vccnz K1_tr
Rv 76,4,2048
Mvav 24,72,100
v_cmp_ne_u32 s[100:101],s45,v16
Mvav 28,68,92
Rv 80,4,5120
Mvav 28,76,100
s_cmp_eq_u64 s[100:101],0
s_cbranch_scc0 KA_slow
KA_go:
Mvav 32,64,96
Rv 84,4,6144
Mvav 32,72,104
s_add_u32 s4,s42,0
s_add_u32 s5,s4,4096
buffer_load_dwordx4 v[124:127],v8,s[24:27],s4 offen offset:0 sc1
Mvav 36,68,96
Rv 88,4,9216
Mvav 36,76,104
buffer_load_dwordx4 v[128:131],v8,s[24:27],s4 offen offset:1024 sc1
WL 8
Mvav 24,80,108
Rv 92,4,7168
Mvav 24,88,116
buffer_load_dwordx4 v[132:135],v8,s[24:27],s4 offen offset:2048 sc1
Mvav 28,84,108
Rv 96,4,10240
Mvav 28,92,116
buffer_load_dwordx4 v[136:139],v8,s[24:27],s4 offen offset:3072 sc1
Mvav 32,80,112
Rv 100,4,8192
Mvav 32,88,120
buffer_load_dwordx4 v[140:143],v8,s[24:27],s5 offen offset:0 sc1
Mvav 36,84,112
Rv 104,4,11264
Mvav 36,92,120
K1_p274:
s_cbranch_vccnz K1_tr
s_add_u32 s4,s42,5120
s_add_u32 s5,s4,4096
buffer_load_dwordx4 v[144:147],v8,s[24:27],s4 offen offset:0 sc1
WL 8
Mvav 24,96,60
Rv 108,4,12288
Mvav 24,104,68
buffer_load_dword v16,v19,s[24:27],s42 offen offset:256 sc1
Mvav 28,100,60
Rv 112,4,15360
Mvav 28,108,68
buffer_load_dwordx4 v[148:151],v8,s[24:27],s4 offen offset:1024 sc1
Mvav 32,96,64
Rv 116,4,13312
Mvav 32,104,72
buffer_load_dwordx4 v[152:155],v8,s[24:27],s4 offen offset:2048 sc1
Mvav 36,100,64
Rv 120,4,16384
Mvav 36,108,72
buffer_load_dwordx4 v[156:159],v8,s[24:27],s4 offen offset:3072 sc1
WL 8
Mvav 24,112,76
Rv 60,4,14336
Mvav 24,120,84
buffer_load_dwordx4 v[160:163],v8,s[24:27],s5 offen offset:0 sc1
Mvav 28,116,76
Rv 64,4,17408
Mvav 28,124,84
s_lshr_b32 s8,s44,1
s_and_b32 s9,s44,1
Mvav 32,112,80
Rv 68,4,18432
Mvav 32,120,88
K1_p275:
s_cbranch_vccnz K1_tr
s_lshl_b32 s9,s9,5
s_mul_i32 s12,s44,40960
Mvav 36,116,80
Rv 72,4,21504
Mvav 36,124,88
s_mul_i32 s8,s8,20480
s_add_u32 s60,s8,s9
WL 8
Mvav 24,128,92
Rv 76,4,19456
Mvav 24,136,100
s_xor_b32 s10,s8,0
s_xor_b32 s11,s9,0
Mvav 28,132,92
Rv 80,4,22528
Mvav 28,140,100
s_add_u32 s10,s10,s11
s_add_u32 s56,s10,s12
Mvav 32,128,96
Rv 84,4,20480
Mvav 32,136,104
s_xor_b32 s10,s8,0
s_xor_b32 s11,s9,32
Mvav 36,132,96
Rv 88,4,23552
Mvav 36,140,104
s_add_u32 s10,s10,s11
s_add_u32 s57,s10,s12
s_waitcnt vmcnt(11) lgkmcnt(8)
s_barrier
Mvav 24,144,108
Rv 92,5,0
Mvav 24,152,116
s_xor_b32 s10,s8,20480
s_xor_b32 s11,s9,0
Mvav 28,148,108
Rv 96,5,3072
Mvav 28,156,116
s_add_u32 s10,s10,s11
K1_p276:
s_cbranch_vccnz K1_tr
s_add_u32 s58,s10,s12
Mvav 32,144,112
Rv 100,5,1024
Mvav 32,152,120
s_xor_b32 s10,s8,20480
s_xor_b32 s11,s9,32
Mvav 36,148,112
Rv 104,5,4096
Mvav 36,156,120
s_add_u32 s10,s10,s11
s_add_u32 s59,s10,s12
WL 8
Mvav 24,160,60
Rv 108,5,2048
Mvav 24,168,68
s_add_u32 s60,s60,163840
s_lshl_b32 s10,s40,6
Mvav 28,164,60
Rv 112,5,5120
Mvav 28,172,68
v_and_b32 v7,15,v0
v_mul_u32_u24 v7,1280,v7
Mvav 32,160,64
Rv 116,5,6144
Mvav 32,168,72
v_bfe_u32 v6,v0,4,2
v_lshl_add_u32 v7,v6,3,v7
Mvav 36,164,64
Rv 120,5,9216
Mvav 36,172,72
v_add_u32 v6,s10,v7
s_nop 0
WL 8
Mvav 24,176,76
Rv 60,5,7168
Mvav 24,184,84
Mvav 28,180,76
K1_p277:
s_cbranch_vccnz K1_tr
Rv 64,5,10240
Mvav 28,188,84
Mvav 32,176,80
Rv 68,5,8192
Mvav 32,184,88
Mvav 36,180,80
Rv 72,5,11264
Mvav 36,188,88
s_waitcnt vmcnt(4) lgkmcnt(8)
Mvav 24,192,92
Rv 76,5,12288
Mvav 24,200,100
v_cmp_ne_u32 s[100:101],s45,v16
Mvav 28,196,92
Rv 80,5,15360
Mvav 28,204,100
s_cmp_eq_u64 s[100:101],0
s_cbranch_scc0 KB_slow
KB_go:
Mvav 32,192,96
Rv 84,5,13312
Mvav 32,200,104
s_add_u32 s4,s42,10240
s_add_u32 s5,s4,4096
buffer_load_dwordx4 v[164:167],v8,s[24:27],s4 offen offset:0 sc1
Mvav 36,196,96
Rv 88,5,16384
Mvav 36,204,104
buffer_load_dwordx4 v[168:171],v8,s[24:27],s4 offen offset:1024 sc1
WL 8
Mvav 24,208,108
Rv 92,5,14336
Mvav 24,216,116
buffer_load_dwordx4 v[172:175],v8,s[24:27],s4 offen offset:2048 sc1
K1_p278:
s_cbranch_vccnz K1_tr
Mvav 28,212,108
Rv 96,5,17408
Mvav 28,220,116
buffer_load_dwordx4 v[176:179],v8,s[24:27],s4 offen offset:3072 sc1
Mvav 32,208,112
Rv 100,5,18432
Mvav 32,216,120
buffer_load_dwordx4 v[180:183],v8,s[24:27],s5 offen offset:0 sc1
Mvav 36,212,112
Rv 104,5,21504
Mvav 36,220,120
s_waitcnt vmcnt(5) lgkmcnt(8)
Mvav 24,224,60
Rv 108,5,19456
Mvav 24,232,68
v_add_f32 v124,v124,v144
v_add_f32 v125,v125,v145
Mvav 28,228,60
Rv 112,5,22528
Mvav 28,236,68
v_add_f32 v126,v126,v146
v_add_f32 v127,v127,v147
Mvav 32,224,64
Rv 116,5,20480
Mvav 32,232,72
v_add_f32 v128,v128,v148
v_add_f32 v129,v129,v149
Mvav 36,228,64
Rv 120,5,23552
Mvav 36,236,72
v_add_f32 v130,v130,v150
v_add_f32 v131,v131,v151
WL 8
Mvav 24,240,76
v_add_f32 v132,v132,v152
v_add_f32 v133,v133,v153
Mvav 24,248,84
v_add_f32 v134,v134,v154
K1_p279:
s_cbranch_vccnz K1_tr
v_add_f32 v135,v135,v155
Mvav 28,244,76
v_add_f32 v136,v136,v156
v_add_f32 v137,v137,v157
Mvav 28,252,84
v_add_f32 v138,v138,v158
v_add_f32 v139,v139,v159
Mvav 32,240,80
v_add_f32 v140,v140,v160
v_add_f32 v141,v141,v161
Mvav 32,248,88
v_add_f32 v142,v142,v162
v_add_f32 v143,v143,v163
Mvav 36,244,80
v_add_f32 v140,v140,v56
v_add_f32 v141,v141,v57
Mvav 36,252,88
v_add_f32 v142,v142,v58
v_add_f32 v143,v143,v59
WL 4
Mvvv 24,220,92
Mvvv 24,228,100
Mvvv 28,224,92
Mvvv 28,232,100
Mvvv 32,220,96
Mvvv 32,228,104
Mvvv 36,224,96
Mvvv 36,232,104
WL 0
Mvvv 24,236,108
Mvvv 24,244,116
Mvvv 28,240,108
Mvvv 28,248,116
Mvvv 32,236,112
Mvvv 32,244,120
Mvvv 36,240,112
Mvvv 36,248,120
s_nop 1
v_add_f32 v124,v124,v24
v_add_f32 v125,v125,v25
v_add_f32 v126,v126,v26
K1_p280:
s_cbranch_vccnz K1_tr
v_add_f32 v127,v127,v27
v_add_f32 v128,v128,v28
v_add_f32 v129,v129,v29
v_add_f32 v130,v130,v30
v_add_f32 v131,v131,v31
v_add_f32 v132,v132,v32
v_add_f32 v133,v133,v33
v_add_f32 v134,v134,v34
v_add_f32 v135,v135,v35
v_add_f32 v136,v136,v36
v_add_f32 v137,v137,v37
v_add_f32 v138,v138,v38
v_add_f32 v139,v139,v39
s_waitcnt vmcnt(4)
v_add_f32 v124,v124,v164
v_add_f32 v125,v125,v165
v_add_f32 v126,v126,v166
v_add_f32 v127,v127,v167
CV 124,124,125
CV 125,126,127
buffer_store_dwordx2 v[124:125],v6,s[28:31],s56 offen
s_waitcnt vmcnt(4)
v_add_f32 v128,v128,v168
v_add_f32 v129,v129,v169
v_add_f32 v130,v130,v170
v_add_f32 v131,v131,v171
CV 128,128,129
CV 129,130,131
buffer_store_dwordx2 v[128:129],v6,s[28:31],s57 offen
s_waitcnt vmcnt(4)
v_add_f32 v132,v132,v172
v_add_f32 v133,v133,v173
v_add_f32 v134,v134,v174
v_add_f32 v135,v135,v175
CV 132,132,133
CV 133,134,135
buffer_store_dwordx2 v[132:133],v6,s[28:31],s58 offen
s_waitcnt vmcnt(4)
v_add_f32 v136,v136,v176
v_add_f32 v137,v137,v177
v_add_f32 v138,v138,v178
v_add_f32 v139,v139,v179
CV 136,136,137
CV 137,138,139
buffer_store_dwordx2 v[136:137],v6,s[28:31],s59 offen
s_waitcnt vmcnt(4)
v_add_f32 v140,v140,v180
v_add_f32 v141,v141,v181
v_add_f32 v142,v142,v182
v_add_f32 v143,v143,v183
CV 140,140,141
K1_p281:
s_cbranch_vccnz K1_tr
CV 141,142,143
buffer_store_dwordx2 v[140:141],v6,s[28:31],s60 offen
K2_end:
s_endpgm
KA_slow:
s_mov_b32 s7,40000
KA_again:
buffer_load_dword v16,v9,s[24:27],s42 offen offset:0 sc1
s_waitcnt vmcnt(0)
v_cmp_ne_u32 s[100:101],s45,v16
s_nop 0
s_cmp_eq_u64 s[100:101],0
s_cbranch_scc1 KA_go
s_sub_u32 s7,s7,1
s_cbranch_scc0 KA_again
s_branch KA_go
KB_slow:
s_mov_b32 s7,40000
KB_again:
buffer_load_dword v16,v19,s[24:27],s42 offen offset:256 sc1
s_waitcnt vmcnt(0)
v_cmp_ne_u32 s[100:101],s45,v16
s_nop 0
s_cmp_eq_u64 s[100:101],0
s_cbranch_scc1 KB_go
s_sub_u32 s7,s7,1
s_cbranch_scc0 KB_again
s_branch KB_go
K2_st:
s_endpgm
K2_rest:
s_waitcnt vmcnt(0)
s_cmp_lg_u32 s2,240
s_cbranch_scc1 K2_end
s_cmp_lg_u32 s40,0
s_cbranch_scc1 K2_end
v_lshrrev_b32 v22,1,v0
v_lshlrev_b32 v22,10,v22
v_and_b32 v32,1,v0
v_lshl_add_u32 v22,v32,4,v22
s_mov_b32 s4,32768
K2_all:
buffer_load_dword v32,v22,s[52:55],0 offen sc1
buffer_load_dword v33,v22,s[52:55],0 offen offset:4 sc1
buffer_load_dword v34,v22,s[52:55],0 offen offset:8 sc1
buffer_load_dword v35,v22,s[52:55],0 offen offset:12 sc1
s_waitcnt vmcnt(0)
v_xor_b32 v32,s45,v32
v_xor_b32 v33,s45,v33
v_xor_b32 v34,s45,v34
v_xor_b32 v35,s45,v35
v_or_b32 v32,v32,v33
v_or3_b32 v32,v32,v34,v35
v_cmp_ne_u32 s[100:101],0,v32
s_nop 0
s_cmp_eq_u64 s[100:101],0
s_cbranch_scc1 K2_ret
s_sub_u32 s7,s7,1
s_cbranch_scc0 K2_all
K2_ret:
s_mov_b64 exec,1
buffer_store_dword v21,v22,s[52:55],s4 offen sc1
s_mov_b64 exec,-1
s_branch K2_end
K1_fb:
s_waitcnt vmcnt(0) lgkmcnt(0)
s_barrier
s_sub_u32 s6,s6,98304
s_sub_u32 s7,s7,98304
v_subrev_u32 v1,s6,v1
v_subrev_u32 v2,s6,v2
v_subrev_u32 v3,s7,v3
v_subrev_u32 v4,s7,v4
v_subrev_u32 v5,s7,v5
v_subrev_u32 v6,s7,v6
v_mov_b32 v12,0xff7fffff
v_mov_b32 v68,0
v_mov_b32 v69,0
v_mov_b32 v70,0
v_mov_b32 v71,0
v_mov_b32 v13,0xff7fffff
v_mov_b32 v76,0
v_mov_b32 v77,0
v_mov_b32 v78,0
v_mov_b32 v79,0
v_mov_b32 v14,0xff7fffff
v_mov_b32 v84,0
v_mov_b32 v85,0
v_mov_b32 v86,0
v_mov_b32 v87,0
v_mov_b32 v15,0xff7fffff
v_mov_b32 v92,0
v_mov_b32 v93,0
v_mov_b32 v94,0
v_mov_b32 v95,0
s_mov_b32 s4,0
K1_fb_pass:
s_mov_b32 s5,0
v_accvgpr_write_b32 a0,0
v_accvgpr_write_b32 a1,0
v_accvgpr_write_b32 a2,0
v_accvgpr_write_b32 a3,0
v_accvgpr_write_b32 a4,0
v_accvgpr_write_b32 a5,0
v_accvgpr_write_b32 a6,0
v_accvgpr_write_b32 a7,0
v_accvgpr_write_b32 a8,0
v_accvgpr_write_b32 a9,0
v_accvgpr_write_b32 a10,0
v_accvgpr_write_b32 a11,0
v_accvgpr_write_b32 a12,0
v_accvgpr_write_b32 a13,0
v_accvgpr_write_b32 a14,0
v_accvgpr_write_b32 a15,0
v_accvgpr_write_b32 a16,0
v_accvgpr_write_b32 a17,0
v_accvgpr_write_b32 a18,0
v_accvgpr_write_b32 a19,0
v_accvgpr_write_b32 a20,0
v_accvgpr_write_b32 a21,0
v_accvgpr_write_b32 a22,0
v_accvgpr_write_b32 a23,0
v_accvgpr_write_b32 a24,0
v_accvgpr_write_b32 a25,0
v_accvgpr_write_b32 a26,0
v_accvgpr_write_b32 a27,0
v_accvgpr_write_b32 a28,0
v_accvgpr_write_b32 a29,0
v_accvgpr_write_b32 a30,0
v_accvgpr_write_b32 a31,0
v_accvgpr_write_b32 a32,0
v_accvgpr_write_b32 a33,0
v_accvgpr_write_b32 a34,0
v_accvgpr_write_b32 a35,0
v_accvgpr_write_b32 a36,0
v_accvgpr_write_b32 a37,0
v_accvgpr_write_b32 a38,0
v_accvgpr_write_b32 a39,0
v_accvgpr_write_b32 a40,0
v_accvgpr_write_b32 a41,0
v_accvgpr_write_b32 a42,0
v_accvgpr_write_b32 a43,0
v_accvgpr_write_b32 a44,0
v_accvgpr_write_b32 a45,0
v_accvgpr_write_b32 a46,0
v_accvgpr_write_b32 a47,0
v_accvgpr_write_b32 a48,0
v_accvgpr_write_b32 a49,0
v_accvgpr_write_b32 a50,0
v_accvgpr_write_b32 a51,0
v_accvgpr_write_b32 a52,0
v_accvgpr_write_b32 a53,0
v_accvgpr_write_b32 a54,0
v_accvgpr_write_b32 a55,0
v_accvgpr_write_b32 a56,0
v_accvgpr_write_b32 a57,0
v_accvgpr_write_b32 a58,0
v_accvgpr_write_b32 a59,0
v_accvgpr_write_b32 a60,0
v_accvgpr_write_b32 a61,0
v_accvgpr_write_b32 a62,0
v_accvgpr_write_b32 a63,0
v_accvgpr_write_b32 a64,0
v_accvgpr_write_b32 a65,0
v_accvgpr_write_b32 a66,0
v_accvgpr_write_b32 a67,0
v_accvgpr_write_b32 a68,0
v_accvgpr_write_b32 a69,0
v_accvgpr_write_b32 a70,0
v_accvgpr_write_b32 a71,0
v_accvgpr_write_b32 a72,0
v_accvgpr_write_b32 a73,0
v_accvgpr_write_b32 a74,0
v_accvgpr_write_b32 a75,0
v_accvgpr_write_b32 a76,0
v_accvgpr_write_b32 a77,0
v_accvgpr_write_b32 a78,0
v_accvgpr_write_b32 a79,0
v_accvgpr_write_b32 a80,0
v_accvgpr_write_b32 a81,0
v_accvgpr_write_b32 a82,0
v_accvgpr_write_b32 a83,0
v_accvgpr_write_b32 a84,0
v_accvgpr_write_b32 a85,0
v_accvgpr_write_b32 a86,0
v_accvgpr_write_b32 a87,0
v_accvgpr_write_b32 a88,0
v_accvgpr_write_b32 a89,0
v_accvgpr_write_b32 a90,0
v_accvgpr_write_b32 a91,0
v_accvgpr_write_b32 a92,0
v_accvgpr_write_b32 a93,0
v_accvgpr_write_b32 a94,0
v_accvgpr_write_b32 a95,0
v_accvgpr_write_b32 a96,0
v_accvgpr_write_b32 a97,0
v_accvgpr_write_b32 a98,0
v_accvgpr_write_b32 a99,0
v_accvgpr_write_b32 a100,0
v_accvgpr_write_b32 a101,0
v_accvgpr_write_b32 a102,0
v_accvgpr_write_b32 a103,0
v_accvgpr_write_b32 a104,0
v_accvgpr_write_b32 a105,0
v_accvgpr_write_b32 a106,0
v_accvgpr_write_b32 a107,0
v_accvgpr_write_b32 a108,0
v_accvgpr_write_b32 a109,0
v_accvgpr_write_b32 a110,0
v_accvgpr_write_b32 a111,0
v_accvgpr_write_b32 a112,0
v_accvgpr_write_b32 a113,0
v_accvgpr_write_b32 a114,0
v_accvgpr_write_b32 a115,0
v_accvgpr_write_b32 a116,0
v_accvgpr_write_b32 a117,0
v_accvgpr_write_b32 a118,0
v_accvgpr_write_b32 a119,0
v_accvgpr_write_b32 a120,0
v_accvgpr_write_b32 a121,0
v_accvgpr_write_b32 a122,0
v_accvgpr_write_b32 a123,0
v_accvgpr_write_b32 a124,0
v_accvgpr_write_b32 a125,0
v_accvgpr_write_b32 a126,0
v_accvgpr_write_b32 a127,0
v_accvgpr_write_b32 a128,0
v_accvgpr_write_b32 a129,0
v_accvgpr_write_b32 a130,0
v_accvgpr_write_b32 a131,0
v_accvgpr_write_b32 a132,0
v_accvgpr_write_b32 a133,0
v_accvgpr_write_b32 a134,0
v_accvgpr_write_b32 a135,0
v_accvgpr_write_b32 a136,0
v_accvgpr_write_b32 a137,0
v_accvgpr_write_b32 a138,0
v_accvgpr_write_b32 a139,0
v_accvgpr_write_b32 a140,0
v_accvgpr_write_b32 a141,0
v_accvgpr_write_b32 a142,0
v_accvgpr_write_b32 a143,0
v_accvgpr_write_b32 a144,0
v_accvgpr_write_b32 a145,0
v_accvgpr_write_b32 a146,0
v_accvgpr_write_b32 a147,0
v_accvgpr_write_b32 a148,0
v_accvgpr_write_b32 a149,0
v_accvgpr_write_b32 a150,0
v_accvgpr_write_b32 a151,0
v_accvgpr_write_b32 a152,0
v_accvgpr_write_b32 a153,0
v_accvgpr_write_b32 a154,0
v_accvgpr_write_b32 a155,0
v_accvgpr_write_b32 a156,0
v_accvgpr_write_b32 a157,0
v_accvgpr_write_b32 a158,0
v_accvgpr_write_b32 a159,0
v_accvgpr_write_b32 a160,0
v_accvgpr_write_b32 a161,0
v_accvgpr_write_b32 a162,0
v_accvgpr_write_b32 a163,0
v_accvgpr_write_b32 a164,0
v_accvgpr_write_b32 a165,0
v_accvgpr_write_b32 a166,0
v_accvgpr_write_b32 a167,0
v_accvgpr_write_b32 a168,0
v_accvgpr_write_b32 a169,0
v_accvgpr_write_b32 a170,0
v_accvgpr_write_b32 a171,0
v_accvgpr_write_b32 a172,0
v_accvgpr_write_b32 a173,0
v_accvgpr_write_b32 a174,0
v_accvgpr_write_b32 a175,0
v_accvgpr_write_b32 a176,0
v_accvgpr_write_b32 a177,0
v_accvgpr_write_b32 a178,0
v_accvgpr_write_b32 a179,0
v_accvgpr_write_b32 a180,0
v_accvgpr_write_b32 a181,0
v_accvgpr_write_b32 a182,0
v_accvgpr_write_b32 a183,0
v_accvgpr_write_b32 a184,0
v_accvgpr_write_b32 a185,0
v_accvgpr_write_b32 a186,0
v_accvgpr_write_b32 a187,0
v_accvgpr_write_b32 a188,0
v_accvgpr_write_b32 a189,0
v_accvgpr_write_b32 a190,0
v_accvgpr_write_b32 a191,0
v_accvgpr_write_b32 a192,0
v_accvgpr_write_b32 a193,0
v_accvgpr_write_b32 a194,0
v_accvgpr_write_b32 a195,0
v_accvgpr_write_b32 a196,0
v_accvgpr_write_b32 a197,0
v_accvgpr_write_b32 a198,0
v_accvgpr_write_b32 a199,0
v_accvgpr_write_b32 a200,0
v_accvgpr_write_b32 a201,0
v_accvgpr_write_b32 a202,0
v_accvgpr_write_b32 a203,0
v_accvgpr_write_b32 a204,0
v_accvgpr_write_b32 a205,0
v_accvgpr_write_b32 a206,0
v_accvgpr_write_b32 a207,0
K1_fb_loop:
s_add_u32 m0,s41,98304
s_add_u32 s43,s5,0
buffer_load_dwordx4 v7,s[28:31],s43 offen offset:0 lds
buffer_load_dwordx4 v8,s[28:31],s43 offen offset:1024 lds
buffer_load_dwordx4 v9,s[28:31],s43 offen offset:2048 lds
s_add_u32 m0,s41,101376
s_add_u32 s43,s5,3072
buffer_load_dwordx4 v7,s[28:31],s43 offen offset:0 lds
buffer_load_dwordx4 v8,s[28:31],s43 offen offset:1024 lds
buffer_load_dwordx4 v9,s[28:31],s43 offen offset:2048 lds
s_waitcnt vmcnt(0)
s_barrier
Ra 208,1,0
Ra 212,2,0
Ra 216,1,128
Ra 220,2,128
Ra 224,1,256
Ra 228,2,256
WL 0
MvavC 32,208,64,68
Mvav 32,212,96
Mvav 32,216,128
Mvav 32,220,160
Mvav 32,224,192
Mvav 32,228,224
MvavC 36,208,72,76
Mvav 36,212,104
Mvav 36,216,136
Mvav 36,220,168
Mvav 36,224,200
Mvav 36,228,232
MvavC 40,208,80,84
Mvav 40,212,112
Mvav 40,216,144
Mvav 40,220,176
Mvav 40,224,208
Mvav 40,228,240
MvavC 44,208,88,92
Mvav 44,212,120
Mvav 44,216,152
Mvav 44,220,184
Mvav 44,224,216
Mvav 44,228,248
Ra 208,1,6144
Ra 212,2,6144
Ra 216,1,6272
Ra 220,2,6272
Ra 224,1,6400
Ra 228,2,6400
WL 0
MvavC 48,208,64,68
Mvav 48,212,96
Mvav 48,216,128
Mvav 48,220,160
Mvav 48,224,192
Mvav 48,228,224
MvavC 52,208,72,76
Mvav 52,212,104
Mvav 52,216,136
Mvav 52,220,168
Mvav 52,224,200
Mvav 52,228,232
MvavC 56,208,80,84
Mvav 56,212,112
Mvav 56,216,144
Mvav 56,220,176
Mvav 56,224,208
Mvav 56,228,240
MvavC 60,208,88,92
Mvav 60,212,120
Mvav 60,216,152
Mvav 60,220,184
Mvav 60,224,216
Mvav 60,228,248
Ra 208,1,12288
Ra 212,2,12288
Ra 216,1,12416
Ra 220,2,12416
Ra 224,1,12544
Ra 228,2,12544
WL 0
MvavC 100,208,64,68
Mvav 100,212,96
Mvav 100,216,128
Mvav 100,220,160
Mvav 100,224,192
Mvav 100,228,224
MvavC 108,208,72,76
Mvav 108,212,104
Mvav 108,216,136
Mvav 108,220,168
Mvav 108,224,200
Mvav 108,228,232
MvavC 116,208,80,84
Mvav 116,212,112
Mvav 116,216,144
Mvav 116,220,176
Mvav 116,224,208
Mvav 116,228,240
MvavC 124,208,88,92
Mvav 124,212,120
Mvav 124,216,152
Mvav 124,220,184
Mvav 124,224,216
Mvav 124,228,248
Ra 208,1,18432
Ra 212,2,18432
Ra 216,1,18560
Ra 220,2,18560
Ra 224,1,18688
Ra 228,2,18688
WL 0
MvavC 132,208,64,68
Mvav 132,212,96
Mvav 132,216,128
Mvav 132,220,160
Mvav 132,224,192
Mvav 132,228,224
MvavC 140,208,72,76
Mvav 140,212,104
Mvav 140,216,136
Mvav 140,220,168
Mvav 140,224,200
Mvav 140,228,232
MvavC 148,208,80,84
Mvav 148,212,112
Mvav 148,216,144
Mvav 148,220,176
Mvav 148,224,208
Mvav 148,228,240
MvavC 156,208,88,92
Mvav 156,212,120
Mvav 156,216,152
Mvav 156,220,184
Mvav 156,224,216
Mvav 156,228,248
s_nop 7
s_cmp_lg_u32 s4,0
s_cbranch_scc1 K1_fb_pv
v_max3_f32 v12,v12,v32,v33
v_max3_f32 v12,v12,v34,v35
v_max3_f32 v13,v13,v36,v37
v_max3_f32 v13,v13,v38,v39
v_max3_f32 v14,v14,v40,v41
v_max3_f32 v14,v14,v42,v43
v_max3_f32 v15,v15,v44,v45
v_max3_f32 v15,v15,v46,v47
v_max3_f32 v12,v12,v48,v49
v_max3_f32 v12,v12,v50,v51
v_max3_f32 v13,v13,v52,v53
v_max3_f32 v13,v13,v54,v55
v_max3_f32 v14,v14,v56,v57
v_max3_f32 v14,v14,v58,v59
v_max3_f32 v15,v15,v60,v61
v_max3_f32 v15,v15,v62,v63
v_max3_f32 v12,v12,v100,v101
v_max3_f32 v12,v12,v102,v103
v_max3_f32 v13,v13,v108,v109
v_max3_f32 v13,v13,v110,v111
v_max3_f32 v14,v14,v116,v117
v_max3_f32 v14,v14,v118,v119
v_max3_f32 v15,v15,v124,v125
v_max3_f32 v15,v15,v126,v127
v_max3_f32 v12,v12,v132,v133
v_max3_f32 v12,v12,v134,v135
v_max3_f32 v13,v13,v140,v141
v_max3_f32 v13,v13,v142,v143
v_max3_f32 v14,v14,v148,v149
v_max3_f32 v14,v14,v150,v151
v_max3_f32 v15,v15,v156,v157
v_max3_f32 v15,v15,v158,v159
s_branch K1_fb_next
K1_fb_pv:
s_barrier
s_add_u32 m0,s41,98304
s_add_u32 s43,s5,0
buffer_load_dwordx4 v7,s[32:35],s43 offen offset:0 lds
buffer_load_dwordx4 v8,s[32:35],s43 offen offset:1024 lds
buffer_load_dwordx4 v9,s[32:35],s43 offen offset:2048 lds
s_add_u32 m0,s41,101376
s_add_u32 s43,s5,3072
buffer_load_dwordx4 v7,s[32:35],s43 offen offset:0 lds
buffer_load_dwordx4 v8,s[32:35],s43 offen offset:1024 lds
buffer_load_dwordx4 v9,s[32:35],s43 offen offset:2048 lds
s_waitcnt vmcnt(0)
s_barrier
EX 32
EX 33
EX 34
EX 35
EX 36
EX 37
EX 38
EX 39
EX 40
EX 41
EX 42
EX 43
EX 44
EX 45
EX 46
EX 47
EX 48
EX 49
EX 50
EX 51
EX 52
EX 53
EX 54
EX 55
EX 56
EX 57
EX 58
EX 59
EX 60
EX 61
EX 62
EX 63
EX 100
EX 101
EX 102
EX 103
EX 108
EX 109
EX 110
EX 111
EX 116
EX 117
EX 118
EX 119
EX 124
EX 125
EX 126
EX 127
EX 132
EX 133
EX 134
EX 135
EX 140
EX 141
EX 142
EX 143
EX 148
EX 149
EX 150
EX 151
EX 156
EX 157
EX 158
EX 159
s_nop 0
CV 164,32,33
CV 165,34,35
CV 172,36,37
CV 173,38,39
CV 180,40,41
CV 181,42,43
CV 188,44,45
CV 189,46,47
CV 166,48,49
CV 167,50,51
CV 174,52,53
CV 175,54,55
CV 182,56,57
CV 183,58,59
CV 190,60,61
CV 191,62,63
CV 196,100,101
CV 197,102,103
CV 204,108,109
CV 205,110,111
CV 212,116,117
CV 213,118,119
CV 220,124,125
CV 221,126,127
CV 198,132,133
CV 199,134,135
CV 206,140,141
CV 207,142,143
CV 214,148,149
CV 215,150,151
CV 222,156,157
CV 223,158,159
s_nop 1
Maav 192,240,164
Maav 192,240,196
Maav 196,240,172
Maav 196,240,204
Maav 200,240,180
Maav 200,240,212
Maav 204,240,188
Maav 204,240,220
Ta 208,3,0
Ta 210,3,6144
Ta 212,3,12288
Ta 214,3,18432
WL 0
Maav 0,208,164
Maav 0,212,196
Maav 4,208,172
Maav 4,212,204
Maav 8,208,180
Maav 8,212,212
Maav 12,208,188
Maav 12,212,220
Ta 208,4,0
Ta 210,4,6144
Ta 212,4,12288
Ta 214,4,18432
WL 0
Maav 16,208,164
Maav 16,212,196
Maav 20,208,172
Maav 20,212,204
Maav 24,208,180
Maav 24,212,212
Maav 28,208,188
Maav 28,212,220
Ta 208,5,0
Ta 210,5,6144
Ta 212,5,12288
Ta 214,5,18432
WL 0
Maav 32,208,164
Maav 32,212,196
Maav 36,208,172
Maav 36,212,204
Maav 40,208,180
Maav 40,212,212
Maav 44,208,188
Maav 44,212,220
Ta 208,6,0
Ta 210,6,6144
Ta 212,6,12288
Ta 214,6,18432
WL 0
Maav 48,208,164
Maav 48,212,196
Maav 52,208,172
Maav 52,212,204
Maav 56,208,180
Maav 56,212,212
Maav 60,208,188
Maav 60,212,220
Ta 208,3,128
Ta 210,3,6272
Ta 212,3,12416
Ta 214,3,18560
WL 0
Maav 64,208,164
Maav 64,212,196
Maav 68,208,172
Maav 68,212,204
Maav 72,208,180
Maav 72,212,212
Maav 76,208,188
Maav 76,212,220
Ta 208,4,128
Ta 210,4,6272
Ta 212,4,12416
Ta 214,4,18560
WL 0
Maav 80,208,164
Maav 80,212,196
Maav 84,208,172
Maav 84,212,204
Maav 88,208,180
Maav 88,212,212
Maav 92,208,188
Maav 92,212,220
Ta 208,5,128
Ta 210,5,6272
Ta 212,5,12416
Ta 214,5,18560
WL 0
Maav 96,208,164
Maav 96,212,196
Maav 100,208,172
Maav 100,212,204
Maav 104,208,180
Maav 104,212,212
Maav 108,208,188
Maav 108,212,220
Ta 208,6,128
Ta 210,6,6272
Ta 212,6,12416
Ta 214,6,18560
WL 0
Maav 112,208,164
Maav 112,212,196
Maav 116,208,172
Maav 116,212,204
Maav 120,208,180
Maav 120,212,212
Maav 124,208,188
Maav 124,212,220
Ta 208,3,256
Ta 210,3,6400
Ta 212,3,12544
Ta 214,3,18688
WL 0
Maav 128,208,164
Maav 128,212,196
Maav 132,208,172
Maav 132,212,204
Maav 136,208,180
Maav 136,212,212
Maav 140,208,188
Maav 140,212,220
Ta 208,4,256
Ta 210,4,6400
Ta 212,4,12544
Ta 214,4,18688
WL 0
Maav 144,208,164
Maav 144,212,196
Maav 148,208,172
Maav 148,212,204
Maav 152,208,180
Maav 152,212,212
Maav 156,208,188
Maav 156,212,220
Ta 208,5,256
Ta 210,5,6400
Ta 212,5,12544
Ta 214,5,18688
WL 0
Maav 160,208,164
Maav 160,212,196
Maav 164,208,172
Maav 164,212,204
Maav 168,208,180
Maav 168,212,212
Maav 172,208,188
Maav 172,212,220
Ta 208,6,256
Ta 210,6,6400
Ta 212,6,12544
Ta 214,6,18688
WL 0
Maav 176,208,164
Maav 176,212,196
Maav 180,208,172
Maav 180,212,204
Maav 184,208,180
Maav 184,212,212
Maav 188,208,188
Maav 188,212,220
K1_fb_next:
s_nop 7
s_barrier
s_add_u32 s5,s5,24576
s_cmp_lt_u32 s5,393216
s_cbranch_scc1 K1_fb_loop
s_cmp_lg_u32 s4,0
s_cbranch_scc1 K1_fb_out
v_mov_b32 v164,v12
s_nop 1
v_permlane32_swap_b32 v12,v164
v_max_f32 v12,v12,v164
v_mov_b32 v164,v12
s_nop 1
v_permlane16_swap_b32 v12,v164
v_max_f32 v12,v12,v164
v_sub_f32 v68,0,v12
v_sub_f32 v69,0,v12
v_sub_f32 v70,0,v12
v_sub_f32 v71,0,v12
v_mov_b32 v164,v13
s_nop 1
v_permlane32_swap_b32 v13,v164
v_max_f32 v13,v13,v164
v_mov_b32 v164,v13
s_nop 1
v_permlane16_swap_b32 v13,v164
v_max_f32 v13,v13,v164
v_sub_f32 v76,0,v13
v_sub_f32 v77,0,v13
v_sub_f32 v78,0,v13
v_sub_f32 v79,0,v13
v_mov_b32 v164,v14
s_nop 1
v_permlane32_swap_b32 v14,v164
v_max_f32 v14,v14,v164
v_mov_b32 v164,v14
s_nop 1
v_permlane16_swap_b32 v14,v164
v_max_f32 v14,v14,v164
v_sub_f32 v84,0,v14
v_sub_f32 v85,0,v14
v_sub_f32 v86,0,v14
v_sub_f32 v87,0,v14
v_mov_b32 v164,v15
s_nop 1
v_permlane32_swap_b32 v15,v164
v_max_f32 v15,v15,v164
v_mov_b32 v164,v15
s_nop 1
v_permlane16_swap_b32 v15,v164
v_max_f32 v15,v15,v164
v_sub_f32 v92,0,v15
v_sub_f32 v93,0,v15
v_sub_f32 v94,0,v15
v_sub_f32 v95,0,v15
s_mov_b32 s4,1
s_branch K1_fb_pass
K1_fb_out:
v_accvgpr_read_b32 v11,a192
s_nop 0
v_rcp_f32 v11,v11
s_nop 0
v_accvgpr_read_b32 v16,a0
v_accvgpr_read_b32 v17,a1
v_accvgpr_read_b32 v18,a2
v_accvgpr_read_b32 v19,a3
v_accvgpr_read_b32 v20,a16
v_accvgpr_read_b32 v21,a17
v_accvgpr_read_b32 v22,a18
v_accvgpr_read_b32 v23,a19
v_mul_f32 v16,v16,v11
v_mul_f32 v17,v17,v11
v_mul_f32 v18,v18,v11
v_mul_f32 v19,v19,v11
v_mul_f32 v20,v20,v11
v_mul_f32 v21,v21,v11
v_mul_f32 v22,v22,v11
v_mul_f32 v23,v23,v11
CV 16,16,17
CV 17,18,19
CV 18,20,21
CV 19,22,23
buffer_store_dwordx4 v[16:19],v10,s[36:39],s56 offen offset:0 sc1
v_accvgpr_read_b32 v24,a32
v_accvgpr_read_b32 v25,a33
v_accvgpr_read_b32 v26,a34
v_accvgpr_read_b32 v27,a35
v_accvgpr_read_b32 v28,a48
v_accvgpr_read_b32 v29,a49
v_accvgpr_read_b32 v30,a50
v_accvgpr_read_b32 v31,a51
v_mul_f32 v24,v24,v11
v_mul_f32 v25,v25,v11
v_mul_f32 v26,v26,v11
v_mul_f32 v27,v27,v11
v_mul_f32 v28,v28,v11
v_mul_f32 v29,v29,v11
v_mul_f32 v30,v30,v11
v_mul_f32 v31,v31,v11
CV 24,24,25
CV 25,26,27
CV 26,28,29
CV 27,30,31
buffer_store_dwordx4 v[24:27],v10,s[36:39],s56 offen offset:1024 sc1
v_accvgpr_read_b32 v16,a64
v_accvgpr_read_b32 v17,a65
v_accvgpr_read_b32 v18,a66
v_accvgpr_read_b32 v19,a67
v_accvgpr_read_b32 v20,a80
v_accvgpr_read_b32 v21,a81
v_accvgpr_read_b32 v22,a82
v_accvgpr_read_b32 v23,a83
v_mul_f32 v16,v16,v11
v_mul_f32 v17,v17,v11
v_mul_f32 v18,v18,v11
v_mul_f32 v19,v19,v11
v_mul_f32 v20,v20,v11
v_mul_f32 v21,v21,v11
v_mul_f32 v22,v22,v11
v_mul_f32 v23,v23,v11
CV 16,16,17
CV 17,18,19
CV 18,20,21
CV 19,22,23
buffer_store_dwordx4 v[16:19],v10,s[36:39],s56 offen offset:2048 sc1
v_accvgpr_read_b32 v24,a96
v_accvgpr_read_b32 v25,a97
v_accvgpr_read_b32 v26,a98
v_accvgpr_read_b32 v27,a99
v_accvgpr_read_b32 v28,a112
v_accvgpr_read_b32 v29,a113
v_accvgpr_read_b32 v30,a114
v_accvgpr_read_b32 v31,a115
v_mul_f32 v24,v24,v11
v_mul_f32 v25,v25,v11
v_mul_f32 v26,v26,v11
v_mul_f32 v27,v27,v11
v_mul_f32 v28,v28,v11
v_mul_f32 v29,v29,v11
v_mul_f32 v30,v30,v11
v_mul_f32 v31,v31,v11
CV 24,24,25
CV 25,26,27
CV 26,28,29
CV 27,30,31
buffer_store_dwordx4 v[24:27],v10,s[36:39],s56 offen offset:3072 sc1
v_accvgpr_read_b32 v16,a128
v_accvgpr_read_b32 v17,a129
v_accvgpr_read_b32 v18,a130
v_accvgpr_read_b32 v19,a131
v_accvgpr_read_b32 v20,a144
v_accvgpr_read_b32 v21,a145
v_accvgpr_read_b32 v22,a146
v_accvgpr_read_b32 v23,a147
v_mul_f32 v16,v16,v11
v_mul_f32 v17,v17,v11
v_mul_f32 v18,v18,v11
v_mul_f32 v19,v19,v11
v_mul_f32 v20,v20,v11
v_mul_f32 v21,v21,v11
v_mul_f32 v22,v22,v11
v_mul_f32 v23,v23,v11
CV 32,16,17
CV 33,18,19
CV 34,20,21
CV 35,22,23
v_accvgpr_read_b32 v24,a160
v_accvgpr_read_b32 v25,a161
v_accvgpr_read_b32 v26,a162
v_accvgpr_read_b32 v27,a163
v_accvgpr_read_b32 v28,a176
v_accvgpr_read_b32 v29,a177
v_accvgpr_read_b32 v30,a178
v_accvgpr_read_b32 v31,a179
v_mul_f32 v24,v24,v11
v_mul_f32 v25,v25,v11
v_mul_f32 v26,v26,v11
v_mul_f32 v27,v27,v11
v_mul_f32 v28,v28,v11
v_mul_f32 v29,v29,v11
v_mul_f32 v30,v30,v11
v_mul_f32 v31,v31,v11
CV 48,24,25
CV 49,26,27
CV 50,28,29
CV 51,30,31
v_accvgpr_read_b32 v11,a196
s_nop 0
v_rcp_f32 v11,v11
s_nop 0
v_accvgpr_read_b32 v16,a4
v_accvgpr_read_b32 v17,a5
v_accvgpr_read_b32 v18,a6
v_accvgpr_read_b32 v19,a7
v_accvgpr_read_b32 v20,a20
v_accvgpr_read_b32 v21,a21
v_accvgpr_read_b32 v22,a22
v_accvgpr_read_b32 v23,a23
v_mul_f32 v16,v16,v11
v_mul_f32 v17,v17,v11
v_mul_f32 v18,v18,v11
v_mul_f32 v19,v19,v11
v_mul_f32 v20,v20,v11
v_mul_f32 v21,v21,v11
v_mul_f32 v22,v22,v11
v_mul_f32 v23,v23,v11
CV 16,16,17
CV 17,18,19
CV 18,20,21
CV 19,22,23
buffer_store_dwordx4 v[16:19],v10,s[36:39],s58 offen offset:0 sc1
v_accvgpr_read_b32 v24,a36
v_accvgpr_read_b32 v25,a37
v_accvgpr_read_b32 v26,a38
v_accvgpr_read_b32 v27,a39
v_accvgpr_read_b32 v28,a52
v_accvgpr_read_b32 v29,a53
v_accvgpr_read_b32 v30,a54
v_accvgpr_read_b32 v31,a55
v_mul_f32 v24,v24,v11
v_mul_f32 v25,v25,v11
v_mul_f32 v26,v26,v11
v_mul_f32 v27,v27,v11
v_mul_f32 v28,v28,v11
v_mul_f32 v29,v29,v11
v_mul_f32 v30,v30,v11
v_mul_f32 v31,v31,v11
CV 24,24,25
CV 25,26,27
CV 26,28,29
CV 27,30,31
buffer_store_dwordx4 v[24:27],v10,s[36:39],s58 offen offset:1024 sc1
v_accvgpr_read_b32 v16,a68
v_accvgpr_read_b32 v17,a69
v_accvgpr_read_b32 v18,a70
v_accvgpr_read_b32 v19,a71
v_accvgpr_read_b32 v20,a84
v_accvgpr_read_b32 v21,a85
v_accvgpr_read_b32 v22,a86
v_accvgpr_read_b32 v23,a87
v_mul_f32 v16,v16,v11
v_mul_f32 v17,v17,v11
v_mul_f32 v18,v18,v11
v_mul_f32 v19,v19,v11
v_mul_f32 v20,v20,v11
v_mul_f32 v21,v21,v11
v_mul_f32 v22,v22,v11
v_mul_f32 v23,v23,v11
CV 16,16,17
CV 17,18,19
CV 18,20,21
CV 19,22,23
buffer_store_dwordx4 v[16:19],v10,s[36:39],s58 offen offset:2048 sc1
v_accvgpr_read_b32 v24,a100
v_accvgpr_read_b32 v25,a101
v_accvgpr_read_b32 v26,a102
v_accvgpr_read_b32 v27,a103
v_accvgpr_read_b32 v28,a116
v_accvgpr_read_b32 v29,a117
v_accvgpr_read_b32 v30,a118
v_accvgpr_read_b32 v31,a119
v_mul_f32 v24,v24,v11
v_mul_f32 v25,v25,v11
v_mul_f32 v26,v26,v11
v_mul_f32 v27,v27,v11
v_mul_f32 v28,v28,v11
v_mul_f32 v29,v29,v11
v_mul_f32 v30,v30,v11
v_mul_f32 v31,v31,v11
CV 24,24,25
CV 25,26,27
CV 26,28,29
CV 27,30,31
buffer_store_dwordx4 v[24:27],v10,s[36:39],s58 offen offset:3072 sc1
v_accvgpr_read_b32 v16,a132
v_accvgpr_read_b32 v17,a133
v_accvgpr_read_b32 v18,a134
v_accvgpr_read_b32 v19,a135
v_accvgpr_read_b32 v20,a148
v_accvgpr_read_b32 v21,a149
v_accvgpr_read_b32 v22,a150
v_accvgpr_read_b32 v23,a151
v_mul_f32 v16,v16,v11
v_mul_f32 v17,v17,v11
v_mul_f32 v18,v18,v11
v_mul_f32 v19,v19,v11
v_mul_f32 v20,v20,v11
v_mul_f32 v21,v21,v11
v_mul_f32 v22,v22,v11
v_mul_f32 v23,v23,v11
CV 36,16,17
CV 37,18,19
CV 38,20,21
CV 39,22,23
v_accvgpr_read_b32 v24,a164
v_accvgpr_read_b32 v25,a165
v_accvgpr_read_b32 v26,a166
v_accvgpr_read_b32 v27,a167
v_accvgpr_read_b32 v28,a180
v_accvgpr_read_b32 v29,a181
v_accvgpr_read_b32 v30,a182
v_accvgpr_read_b32 v31,a183
v_mul_f32 v24,v24,v11
v_mul_f32 v25,v25,v11
v_mul_f32 v26,v26,v11
v_mul_f32 v27,v27,v11
v_mul_f32 v28,v28,v11
v_mul_f32 v29,v29,v11
v_mul_f32 v30,v30,v11
v_mul_f32 v31,v31,v11
CV 52,24,25
CV 53,26,27
CV 54,28,29
CV 55,30,31
v_accvgpr_read_b32 v11,a200
s_nop 0
v_rcp_f32 v11,v11
s_nop 0
v_accvgpr_read_b32 v16,a8
v_accvgpr_read_b32 v17,a9
v_accvgpr_read_b32 v18,a10
v_accvgpr_read_b32 v19,a11
v_accvgpr_read_b32 v20,a24
v_accvgpr_read_b32 v21,a25
v_accvgpr_read_b32 v22,a26
v_accvgpr_read_b32 v23,a27
v_mul_f32 v16,v16,v11
v_mul_f32 v17,v17,v11
v_mul_f32 v18,v18,v11
v_mul_f32 v19,v19,v11
v_mul_f32 v20,v20,v11
v_mul_f32 v21,v21,v11
v_mul_f32 v22,v22,v11
v_mul_f32 v23,v23,v11
CV 16,16,17
CV 17,18,19
CV 18,20,21
CV 19,22,23
buffer_store_dwordx4 v[16:19],v10,s[36:39],s60 offen offset:0 sc1
v_accvgpr_read_b32 v24,a40
v_accvgpr_read_b32 v25,a41
v_accvgpr_read_b32 v26,a42
v_accvgpr_read_b32 v27,a43
v_accvgpr_read_b32 v28,a56
v_accvgpr_read_b32 v29,a57
v_accvgpr_read_b32 v30,a58
v_accvgpr_read_b32 v31,a59
v_mul_f32 v24,v24,v11
v_mul_f32 v25,v25,v11
v_mul_f32 v26,v26,v11
v_mul_f32 v27,v27,v11
v_mul_f32 v28,v28,v11
v_mul_f32 v29,v29,v11
v_mul_f32 v30,v30,v11
v_mul_f32 v31,v31,v11
CV 24,24,25
CV 25,26,27
CV 26,28,29
CV 27,30,31
buffer_store_dwordx4 v[24:27],v10,s[36:39],s60 offen offset:1024 sc1
v_accvgpr_read_b32 v16,a72
v_accvgpr_read_b32 v17,a73
v_accvgpr_read_b32 v18,a74
v_accvgpr_read_b32 v19,a75
v_accvgpr_read_b32 v20,a88
v_accvgpr_read_b32 v21,a89
v_accvgpr_read_b32 v22,a90
v_accvgpr_read_b32 v23,a91
v_mul_f32 v16,v16,v11
v_mul_f32 v17,v17,v11
v_mul_f32 v18,v18,v11
v_mul_f32 v19,v19,v11
v_mul_f32 v20,v20,v11
v_mul_f32 v21,v21,v11
v_mul_f32 v22,v22,v11
v_mul_f32 v23,v23,v11
CV 16,16,17
CV 17,18,19
CV 18,20,21
CV 19,22,23
buffer_store_dwordx4 v[16:19],v10,s[36:39],s60 offen offset:2048 sc1
v_accvgpr_read_b32 v24,a104
v_accvgpr_read_b32 v25,a105
v_accvgpr_read_b32 v26,a106
v_accvgpr_read_b32 v27,a107
v_accvgpr_read_b32 v28,a120
v_accvgpr_read_b32 v29,a121
v_accvgpr_read_b32 v30,a122
v_accvgpr_read_b32 v31,a123
v_mul_f32 v24,v24,v11
v_mul_f32 v25,v25,v11
v_mul_f32 v26,v26,v11
v_mul_f32 v27,v27,v11
v_mul_f32 v28,v28,v11
v_mul_f32 v29,v29,v11
v_mul_f32 v30,v30,v11
v_mul_f32 v31,v31,v11
CV 24,24,25
CV 25,26,27
CV 26,28,29
CV 27,30,31
buffer_store_dwordx4 v[24:27],v10,s[36:39],s60 offen offset:3072 sc1
v_accvgpr_read_b32 v16,a136
v_accvgpr_read_b32 v17,a137
v_accvgpr_read_b32 v18,a138
v_accvgpr_read_b32 v19,a139
v_accvgpr_read_b32 v20,a152
v_accvgpr_read_b32 v21,a153
v_accvgpr_read_b32 v22,a154
v_accvgpr_read_b32 v23,a155
v_mul_f32 v16,v16,v11
v_mul_f32 v17,v17,v11
v_mul_f32 v18,v18,v11
v_mul_f32 v19,v19,v11
v_mul_f32 v20,v20,v11
v_mul_f32 v21,v21,v11
v_mul_f32 v22,v22,v11
v_mul_f32 v23,v23,v11
CV 40,16,17
CV 41,18,19
CV 42,20,21
CV 43,22,23
v_accvgpr_read_b32 v24,a168
v_accvgpr_read_b32 v25,a169
v_accvgpr_read_b32 v26,a170
v_accvgpr_read_b32 v27,a171
v_accvgpr_read_b32 v28,a184
v_accvgpr_read_b32 v29,a185
v_accvgpr_read_b32 v30,a186
v_accvgpr_read_b32 v31,a187
v_mul_f32 v24,v24,v11
v_mul_f32 v25,v25,v11
v_mul_f32 v26,v26,v11
v_mul_f32 v27,v27,v11
v_mul_f32 v28,v28,v11
v_mul_f32 v29,v29,v11
v_mul_f32 v30,v30,v11
v_mul_f32 v31,v31,v11
CV 56,24,25
CV 57,26,27
CV 58,28,29
CV 59,30,31
v_accvgpr_read_b32 v11,a204
s_nop 0
v_rcp_f32 v11,v11
s_nop 0
v_accvgpr_read_b32 v16,a12
v_accvgpr_read_b32 v17,a13
v_accvgpr_read_b32 v18,a14
v_accvgpr_read_b32 v19,a15
v_accvgpr_read_b32 v20,a28
v_accvgpr_read_b32 v21,a29
v_accvgpr_read_b32 v22,a30
v_accvgpr_read_b32 v23,a31
v_mul_f32 v16,v16,v11
v_mul_f32 v17,v17,v11
v_mul_f32 v18,v18,v11
v_mul_f32 v19,v19,v11
v_mul_f32 v20,v20,v11
v_mul_f32 v21,v21,v11
v_mul_f32 v22,v22,v11
v_mul_f32 v23,v23,v11
CV 16,16,17
CV 17,18,19
CV 18,20,21
CV 19,22,23
buffer_store_dwordx4 v[16:19],v10,s[36:39],s62 offen offset:0 sc1
v_accvgpr_read_b32 v24,a44
v_accvgpr_read_b32 v25,a45
v_accvgpr_read_b32 v26,a46
v_accvgpr_read_b32 v27,a47
v_accvgpr_read_b32 v28,a60
v_accvgpr_read_b32 v29,a61
v_accvgpr_read_b32 v30,a62
v_accvgpr_read_b32 v31,a63
v_mul_f32 v24,v24,v11
v_mul_f32 v25,v25,v11
v_mul_f32 v26,v26,v11
v_mul_f32 v27,v27,v11
v_mul_f32 v28,v28,v11
v_mul_f32 v29,v29,v11
v_mul_f32 v30,v30,v11
v_mul_f32 v31,v31,v11
CV 24,24,25
CV 25,26,27
CV 26,28,29
CV 27,30,31
buffer_store_dwordx4 v[24:27],v10,s[36:39],s62 offen offset:1024 sc1
v_accvgpr_read_b32 v16,a76
v_accvgpr_read_b32 v17,a77
v_accvgpr_read_b32 v18,a78
v_accvgpr_read_b32 v19,a79
v_accvgpr_read_b32 v20,a92
v_accvgpr_read_b32 v21,a93
v_accvgpr_read_b32 v22,a94
v_accvgpr_read_b32 v23,a95
v_mul_f32 v16,v16,v11
v_mul_f32 v17,v17,v11
v_mul_f32 v18,v18,v11
v_mul_f32 v19,v19,v11
v_mul_f32 v20,v20,v11
v_mul_f32 v21,v21,v11
v_mul_f32 v22,v22,v11
v_mul_f32 v23,v23,v11
CV 16,16,17
CV 17,18,19
CV 18,20,21
CV 19,22,23
buffer_store_dwordx4 v[16:19],v10,s[36:39],s62 offen offset:2048 sc1
v_accvgpr_read_b32 v24,a108
v_accvgpr_read_b32 v25,a109
v_accvgpr_read_b32 v26,a110
v_accvgpr_read_b32 v27,a111
v_accvgpr_read_b32 v28,a124
v_accvgpr_read_b32 v29,a125
v_accvgpr_read_b32 v30,a126
v_accvgpr_read_b32 v31,a127
v_mul_f32 v24,v24,v11
v_mul_f32 v25,v25,v11
v_mul_f32 v26,v26,v11
v_mul_f32 v27,v27,v11
v_mul_f32 v28,v28,v11
v_mul_f32 v29,v29,v11
v_mul_f32 v30,v30,v11
v_mul_f32 v31,v31,v11
CV 24,24,25
CV 25,26,27
CV 26,28,29
CV 27,30,31
buffer_store_dwordx4 v[24:27],v10,s[36:39],s62 offen offset:3072 sc1
v_accvgpr_read_b32 v16,a140
v_accvgpr_read_b32 v17,a141
v_accvgpr_read_b32 v18,a142
v_accvgpr_read_b32 v19,a143
v_accvgpr_read_b32 v20,a156
v_accvgpr_read_b32 v21,a157
v_accvgpr_read_b32 v22,a158
v_accvgpr_read_b32 v23,a159
v_mul_f32 v16,v16,v11
v_mul_f32 v17,v17,v11
v_mul_f32 v18,v18,v11
v_mul_f32 v19,v19,v11
v_mul_f32 v20,v20,v11
v_mul_f32 v21,v21,v11
v_mul_f32 v22,v22,v11
v_mul_f32 v23,v23,v11
CV 44,16,17
CV 45,18,19
CV 46,20,21
CV 47,22,23
v_accvgpr_read_b32 v24,a172
v_accvgpr_read_b32 v25,a173
v_accvgpr_read_b32 v26,a174
v_accvgpr_read_b32 v27,a175
v_accvgpr_read_b32 v28,a188
v_accvgpr_read_b32 v29,a189
v_accvgpr_read_b32 v30,a190
v_accvgpr_read_b32 v31,a191
v_mul_f32 v24,v24,v11
v_mul_f32 v25,v25,v11
v_mul_f32 v26,v26,v11
v_mul_f32 v27,v27,v11
v_mul_f32 v28,v28,v11
v_mul_f32 v29,v29,v11
v_mul_f32 v30,v30,v11
v_mul_f32 v31,v31,v11
CV 60,24,25
CV 61,26,27
CV 62,28,29
CV 63,30,31
s_waitcnt vmcnt(0)
s_branch K1_done
.section .rodata,"a"
.p2align 6
.amdhsa_kernel standalone__gqa_block_cached__near_ridge_kernel
  .amdhsa_next_free_vgpr 512
  .amdhsa_next_free_sgpr 102
  .amdhsa_accum_offset 256
  .amdhsa_group_segment_fixed_size 0
  .amdhsa_kernarg_size 64
  .amdhsa_user_sgpr_count 2
  .amdhsa_user_sgpr_kernarg_segment_ptr 1
  .amdhsa_system_sgpr_workgroup_id_x 1
.end_amdhsa_kernel
```
